```python
import torch

def _softmax(x, axis=-1):
    return torch.softmax(x, dim=axis)
def _gelu(x):
    return torch.nn.functional.gelu(x, approximate="tanh")
def _silu(x):
    return torch.nn.functional.silu(x)
def _sigmoid(x):
    return torch.sigmoid(x)
def _layernorm(x, axis=-1, eps=1e-5):
    m = x.mean(dim=axis, keepdim=True)
    v = x.var(dim=axis, keepdim=True, unbiased=False)
    return (x - m) / torch.sqrt(v + eps)
def _scatter_add(tgt, idx, src, axis=0):
    return tgt.clone().index_add_(axis, idx, src)
def _segment_sum(src, seg, n):
    out = torch.zeros((n,) + src.shape[1:], dtype=src.dtype)
    return out.index_add_(0, seg, src)
def _pad(x, pw):
    flat = tuple(v for pair in reversed(pw) for v in pair)
    return torch.nn.functional.pad(x, flat)

kernel_name = 'sequential_preLN__mha_block__geglu_ffn__prompt'

def setup_inputs():

    _w = (lambda a: (lambda t: t.to(torch.bfloat16) if t.is_floating_point() else t)(torch.as_tensor(a)))
    def _A_setup():
        B, S, D, H = 1, 2048, 640, 32
        return {
            "x": _w((lambda *s: torch.randn(*s, dtype=torch.bfloat16) * 0.05)(B, S, D)),
            "wqkv": _w((lambda *s: torch.randn(*s, dtype=torch.bfloat16) * 0.05)(D, 3 * D)),
            "wo": _w((lambda *s: torch.randn(*s, dtype=torch.bfloat16) * 0.05)(D, D)),
        }
    _A_in = _A_setup()

    def _B_setup():
        B, S, D, F = 1, 2048, 640, 1536
        return {
            "x": _w((lambda *s: torch.randn(*s, dtype=torch.bfloat16) * 0.05)(B, S, D)),
            "w_gate": _w((lambda *s: torch.randn(*s, dtype=torch.bfloat16) * 0.05)(D, F)),
            "w_up": _w((lambda *s: torch.randn(*s, dtype=torch.bfloat16) * 0.05)(D, F)),
            "w_down": _w((lambda *s: torch.randn(*s, dtype=torch.bfloat16) * 0.05)(F, D)),
        }
    _B_in = _B_setup()

    return {
        "A_x": _A_in["x"],
        "A_wqkv": _A_in["wqkv"],
        "A_wo": _A_in["wo"],
        "B_x": _B_in["x"],
        "B_w_gate": _B_in["w_gate"],
        "B_w_up": _B_in["w_up"],
        "B_w_down": _B_in["w_down"],
    }

def reference(A_x, A_wqkv, A_wo, B_x, B_w_gate, B_w_up, B_w_down):
    def _A_ref(x, wqkv, wo):
        B, S, D = x.shape
        H = 32
        Dh = D // H
        qkv = (lambda x, *d: x.permute(*d))((x @ wqkv).reshape(B, S, 3, H, Dh), 2, 0, 3, 1, 4)
        q, k, v = qkv[0], qkv[1], qkv[2]
        scores = torch.einsum("bhqd,bhkd->bhqk", q, k) * (Dh ** -0.5)
        p = _softmax(scores, axis=-1)
        o = torch.einsum("bhqk,bhkd->bhqd", p, v)
        return (lambda x, *d: x.permute(*d))(o, 0, 2, 1, 3).reshape(B, S, D) @ wo

    def _B_ref(x, w_gate, w_up, w_down):
        return (_gelu(x @ w_gate) * (x @ w_up)) @ w_down

    x = A_x
    h = x + _A_ref(_layernorm(x, axis=-1), A_wqkv, A_wo)
    h2 = h + _B_ref(_layernorm(h, axis=-1), B_w_gate, B_w_up, B_w_down)
    return h2
```

```asm
; @launch kernel=k1_kernel grid=(256,1,1) block=(512,1,1) lds=133120
; @launch kernel=m2_kernel grid=(256,1,1) block=(512,1,1) lds=163840
.amdgcn_target "amdgcn-amd-amdhsa--gfx950"
.text
.globl k1_kernel
.p2align 8
.type k1_kernel,@function
k1_kernel:
    s_cmp_ge_u32 s2, 240
    s_cbranch_scc1 k1_kernel_end
    s_load_dwordx4 s[4:7], s[0:1], 0
    s_load_dwordx2 s[10:11], s[0:1], 72
    v_and_b32 v1, 63, v0
    v_lshrrev_b32 v2, 6, v0
    s_nop 0
    v_readfirstlane_b32 s26, v2
    s_and_b32 s35, s2, 7
    s_lshr_b32 s36, s2, 3
    s_lshr_b32 s37, s35, 2
    s_mul_i32 s37, s37, 30
    s_add_u32 s37, s37, s36
    s_lshr_b32 s25, s37, 2
    s_and_b32 s24, s37, 3
    s_and_b32 s35, s35, 3
    s_lshl_b32 s35, s35, 2
    s_add_u32 s24, s24, s35
    s_add_u32 s33, s24, s25
    s_cmp_ge_u32 s33, 20
    s_cselect_b32 s34, 20, 0
    s_sub_u32 s33, s33, s34
    s_cmp_ge_u32 s33, 10
    s_cselect_b32 s34, 10, 0
    s_sub_u32 s33, s33, s34
    s_cmp_lt_u32 s26, 4
    s_cbranch_scc1 k1_kernel_comp
    s_sub_u32 s26, s26, 4
    v_lshrrev_b32 v3, 4, v1
    v_and_b32 v4, 7, v1
    v_xor_b32 v5, v4, v3
    v_xor_b32 v6, 4, v5
    v_lshrrev_b32 v2, 3, v1
    s_lshl_b32 s29, s26, 12
    s_add_u32 s30, s29, 65536
    s_lshl_b32 s34, s24, 7
    s_lshl_b32 s35, s26, 5
    s_add_u32 s34, s34, s35
    v_add_u32 v2, s34, v2
    s_movk_i32 s35, 1280
    v_mul_lo_u32 v2, v2, s35
    v_lshl_add_u32 v5, v5, 4, v2
    v_lshl_add_u32 v6, v6, 4, v2
    v_add_u32 v16, 0, v5
    v_add_u32 v17, 9216, v6
    v_add_u32 v18, 18432, v5
    v_add_u32 v19, 27648, v6
    s_lshl_b32 s34, s26, 4
    v_add_u32 v2, s34, v3
    s_movk_i32 s35, 3840
    v_mul_lo_u32 v2, v2, s35
    v_and_b32 v4, 15, v1
    v_lshlrev_b32 v5, 2, v3
    v_xor_b32 v4, v4, v5
    v_lshl_add_u32 v2, v4, 4, v2
    s_lshl_b32 s34, s25, 8
    v_add_u32 v2, s34, v2
    v_add_u32 v20, 0, v2
    v_add_u32 v21, 14336, v2
    v_add_u32 v22, 28672, v2
    v_add_u32 v23, 43008, v2
    s_waitcnt lgkmcnt(0)
    s_mov_b32 s12, s4
    s_mov_b32 s13, s5
    s_mov_b32 s14, 2621440
    s_mov_b32 s15, 0x00020000
    s_mov_b32 s16, s6
    s_mov_b32 s17, s7
    s_mov_b32 s18, 2457600
    s_mov_b32 s19, 0x00020000
    s_cmp_eq_u32 s26, 1
    s_cbranch_scc1 k1_kernel_roleA1
    s_cmp_eq_u32 s26, 2
    s_cbranch_scc1 k1_kernel_roleF
    s_cmp_eq_u32 s26, 3
    s_cbranch_scc1 k1_kernel_roleN
    s_lshl_b32 s31, s33, 7
    s_mul_i32 s32, s33, 245760
    s_add_u32 m0, s29, 0
    s_add_u32 s33, s33, 1
    buffer_load_dwordx4 v16, s[12:15], s31 offen offset:0 lds
    buffer_load_dwordx4 v17, s[12:15], s31 offen offset:1024 lds
    buffer_load_dwordx4 v18, s[12:15], s31 offen offset:2048 lds
    buffer_load_dwordx4 v19, s[12:15], s31 offen offset:3072 lds
    s_add_u32 m0, s30, 0
    s_cmp_eq_u32 s33, 10
    s_cselect_b32 s33, 0, s33
    buffer_load_dwordx4 v20, s[16:19], s32 offen offset:0 lds
    buffer_load_dwordx4 v21, s[16:19], s32 offen offset:1024 lds
    buffer_load_dwordx4 v22, s[16:19], s32 offen offset:2048 lds
    buffer_load_dwordx4 v23, s[16:19], s32 offen offset:3072 lds
    s_lshl_b32 s31, s33, 7
    s_mul_i32 s32, s33, 245760
    s_add_u32 m0, s29, 16384
    s_add_u32 s33, s33, 1
    buffer_load_dwordx4 v16, s[12:15], s31 offen offset:0 lds
    buffer_load_dwordx4 v17, s[12:15], s31 offen offset:1024 lds
    buffer_load_dwordx4 v18, s[12:15], s31 offen offset:2048 lds
    buffer_load_dwordx4 v19, s[12:15], s31 offen offset:3072 lds
    s_add_u32 m0, s30, 16384
    s_cmp_eq_u32 s33, 10
    s_cselect_b32 s33, 0, s33
    buffer_load_dwordx4 v20, s[16:19], s32 offen offset:0 lds
    buffer_load_dwordx4 v21, s[16:19], s32 offen offset:1024 lds
    buffer_load_dwordx4 v22, s[16:19], s32 offen offset:2048 lds
    buffer_load_dwordx4 v23, s[16:19], s32 offen offset:3072 lds
    s_add_u32 s44, s10, 19746816
    s_addc_u32 s45, s11, 0
    s_mov_b32 s46, 69632
    s_mov_b32 s47, 0x00020000
    s_add_u32 s34, s10, 19812352
    s_addc_u32 s35, s11, 0
    s_load_dword s58, s[34:35], 0
    s_add_u32 s48, s10, 26533888
    s_addc_u32 s49, s11, 0
    s_mov_b32 s50, 245760
    s_mov_b32 s51, 0x00020000
    v_subrev_u32 v8, 10, v1
    s_lshl_b32 s34, s24, 4
    v_add_u32 v9, s34, v1
    v_lshlrev_b32 v10, 4, v8
    v_add_u32 v10, s25, v10
    v_cmp_gt_u32 vcc, 10, v1
    s_nop 1
    v_cndmask_b32 v9, v10, v9, vcc
    v_cmp_gt_u32 vcc, 20, v1
    s_lshl_b32 s34, s24, 4
    v_mov_b32 v10, s34
    v_cndmask_b32 v9, v10, v9, vcc
    v_lshlrev_b32 v30, 7, v9
    v_lshlrev_b32 v31, 4, v1
    s_lshl_b32 s34, s24, 10
    v_add_u32 v31, s34, v31
    v_lshlrev_b32 v32, 3, v1
    s_lshl_b32 s34, s25, 9
    s_add_u32 s34, s34, 163840
    v_add_u32 v32, s34, v32
    v_lshlrev_b32 v33, 3, v1
    v_add_u32 v33, 131072, v33
    s_waitcnt vmcnt(8)
    s_barrier
    s_lshl_b32 s31, s33, 7
    s_mul_i32 s32, s33, 245760
    s_add_u32 m0, s29, 49152
    s_add_u32 s33, s33, 1
    buffer_load_dwordx4 v16, s[12:15], s31 offen offset:0 lds
    buffer_load_dwordx4 v17, s[12:15], s31 offen offset:1024 lds
    buffer_load_dwordx4 v18, s[12:15], s31 offen offset:2048 lds
    buffer_load_dwordx4 v19, s[12:15], s31 offen offset:3072 lds
    s_add_u32 m0, s30, 49152
    s_cmp_eq_u32 s33, 10
    s_cselect_b32 s33, 0, s33
    buffer_load_dwordx4 v20, s[16:19], s32 offen offset:0 lds
    buffer_load_dwordx4 v21, s[16:19], s32 offen offset:1024 lds
    buffer_load_dwordx4 v22, s[16:19], s32 offen offset:2048 lds
    buffer_load_dwordx4 v23, s[16:19], s32 offen offset:3072 lds
    s_lshl_b32 s31, s33, 7
    s_mul_i32 s32, s33, 245760
    s_add_u32 m0, s29, 32768
    s_add_u32 s33, s33, 1
    buffer_load_dwordx4 v16, s[12:15], s31 offen offset:0 lds
    buffer_load_dwordx4 v17, s[12:15], s31 offen offset:1024 lds
    buffer_load_dwordx4 v18, s[12:15], s31 offen offset:2048 lds
    buffer_load_dwordx4 v19, s[12:15], s31 offen offset:3072 lds
    s_add_u32 m0, s30, 32768
    s_cmp_eq_u32 s33, 10
    s_cselect_b32 s33, 0, s33
    buffer_load_dwordx4 v20, s[16:19], s32 offen offset:0 lds
    buffer_load_dwordx4 v21, s[16:19], s32 offen offset:1024 lds
    buffer_load_dwordx4 v22, s[16:19], s32 offen offset:2048 lds
    buffer_load_dwordx4 v23, s[16:19], s32 offen offset:3072 lds
    s_waitcnt vmcnt(16)
    s_barrier
    s_lshl_b32 s31, s33, 7
    s_mul_i32 s32, s33, 245760
    s_add_u32 m0, s29, 0
    s_add_u32 s33, s33, 1
    buffer_load_dwordx4 v16, s[12:15], s31 offen offset:0 lds
    buffer_load_dwordx4 v17, s[12:15], s31 offen offset:1024 lds
    buffer_load_dwordx4 v18, s[12:15], s31 offen offset:2048 lds
    buffer_load_dwordx4 v19, s[12:15], s31 offen offset:3072 lds
    s_add_u32 m0, s30, 0
    s_cmp_eq_u32 s33, 10
    s_cselect_b32 s33, 0, s33
    buffer_load_dwordx4 v20, s[16:19], s32 offen offset:0 lds
    buffer_load_dwordx4 v21, s[16:19], s32 offen offset:1024 lds
    buffer_load_dwordx4 v22, s[16:19], s32 offen offset:2048 lds
    buffer_load_dwordx4 v23, s[16:19], s32 offen offset:3072 lds
    s_waitcnt vmcnt(16)
    s_barrier
    s_lshl_b32 s31, s33, 7
    s_mul_i32 s32, s33, 245760
    s_add_u32 m0, s29, 16384
    s_add_u32 s33, s33, 1
    buffer_load_dwordx4 v16, s[12:15], s31 offen offset:0 lds
    buffer_load_dwordx4 v17, s[12:15], s31 offen offset:1024 lds
    buffer_load_dwordx4 v18, s[12:15], s31 offen offset:2048 lds
    buffer_load_dwordx4 v19, s[12:15], s31 offen offset:3072 lds
    s_add_u32 m0, s30, 16384
    s_cmp_eq_u32 s33, 10
    s_cselect_b32 s33, 0, s33
    buffer_load_dwordx4 v20, s[16:19], s32 offen offset:0 lds
    buffer_load_dwordx4 v21, s[16:19], s32 offen offset:1024 lds
    buffer_load_dwordx4 v22, s[16:19], s32 offen offset:2048 lds
    buffer_load_dwordx4 v23, s[16:19], s32 offen offset:3072 lds
    s_waitcnt vmcnt(16)
    s_barrier
    s_lshl_b32 s31, s33, 7
    s_mul_i32 s32, s33, 245760
    s_add_u32 m0, s29, 49152
    s_add_u32 s33, s33, 1
    buffer_load_dwordx4 v16, s[12:15], s31 offen offset:0 lds
    buffer_load_dwordx4 v17, s[12:15], s31 offen offset:1024 lds
    buffer_load_dwordx4 v18, s[12:15], s31 offen offset:2048 lds
    buffer_load_dwordx4 v19, s[12:15], s31 offen offset:3072 lds
    s_add_u32 m0, s30, 49152
    s_cmp_eq_u32 s33, 10
    s_cselect_b32 s33, 0, s33
    buffer_load_dwordx4 v20, s[16:19], s32 offen offset:0 lds
    buffer_load_dwordx4 v21, s[16:19], s32 offen offset:1024 lds
    buffer_load_dwordx4 v22, s[16:19], s32 offen offset:2048 lds
    buffer_load_dwordx4 v23, s[16:19], s32 offen offset:3072 lds
    s_waitcnt vmcnt(16)
    s_barrier
    s_lshl_b32 s31, s33, 7
    s_mul_i32 s32, s33, 245760
    s_add_u32 m0, s29, 32768
    s_add_u32 s33, s33, 1
    buffer_load_dwordx4 v16, s[12:15], s31 offen offset:0 lds
    buffer_load_dwordx4 v17, s[12:15], s31 offen offset:1024 lds
    buffer_load_dwordx4 v18, s[12:15], s31 offen offset:2048 lds
    buffer_load_dwordx4 v19, s[12:15], s31 offen offset:3072 lds
    s_add_u32 m0, s30, 32768
    s_cmp_eq_u32 s33, 10
    s_cselect_b32 s33, 0, s33
    buffer_load_dwordx4 v20, s[16:19], s32 offen offset:0 lds
    buffer_load_dwordx4 v21, s[16:19], s32 offen offset:1024 lds
    buffer_load_dwordx4 v22, s[16:19], s32 offen offset:2048 lds
    buffer_load_dwordx4 v23, s[16:19], s32 offen offset:3072 lds
    s_waitcnt vmcnt(16)
    s_barrier
    s_lshl_b32 s31, s33, 7
    s_mul_i32 s32, s33, 245760
    s_add_u32 m0, s29, 0
    s_add_u32 s33, s33, 1
    buffer_load_dwordx4 v16, s[12:15], s31 offen offset:0 lds
    buffer_load_dwordx4 v17, s[12:15], s31 offen offset:1024 lds
    buffer_load_dwordx4 v18, s[12:15], s31 offen offset:2048 lds
    buffer_load_dwordx4 v19, s[12:15], s31 offen offset:3072 lds
    s_add_u32 m0, s30, 0
    s_cmp_eq_u32 s33, 10
    s_cselect_b32 s33, 0, s33
    buffer_load_dwordx4 v20, s[16:19], s32 offen offset:0 lds
    buffer_load_dwordx4 v21, s[16:19], s32 offen offset:1024 lds
    buffer_load_dwordx4 v22, s[16:19], s32 offen offset:2048 lds
    buffer_load_dwordx4 v23, s[16:19], s32 offen offset:3072 lds
    s_waitcnt vmcnt(16)
    s_barrier
    s_lshl_b32 s31, s33, 7
    s_mul_i32 s32, s33, 245760
    s_add_u32 m0, s29, 16384
    s_add_u32 s33, s33, 1
    buffer_load_dwordx4 v16, s[12:15], s31 offen offset:0 lds
    buffer_load_dwordx4 v17, s[12:15], s31 offen offset:1024 lds
    buffer_load_dwordx4 v18, s[12:15], s31 offen offset:2048 lds
    buffer_load_dwordx4 v19, s[12:15], s31 offen offset:3072 lds
    s_add_u32 m0, s30, 16384
    s_cmp_eq_u32 s33, 10
    s_cselect_b32 s33, 0, s33
    buffer_load_dwordx4 v20, s[16:19], s32 offen offset:0 lds
    buffer_load_dwordx4 v21, s[16:19], s32 offen offset:1024 lds
    buffer_load_dwordx4 v22, s[16:19], s32 offen offset:2048 lds
    buffer_load_dwordx4 v23, s[16:19], s32 offen offset:3072 lds
    buffer_load_dword v13, v30, s[44:47], 0 offen sc1
    s_waitcnt vmcnt(17)
    s_barrier
    s_waitcnt vmcnt(9)
    s_barrier
    s_waitcnt vmcnt(0)
    s_waitcnt lgkmcnt(0)
    s_add_u32 s34, s58, 2654435761
    s_mov_b32 s38, 0
k1_kernel_A0_poll:
    v_cmp_ne_u32 vcc, s34, v13
    s_cbranch_vccz k1_kernel_A0_pollok
    s_add_u32 s38, s38, 1
    s_cmp_ge_u32 s38, 100000
    s_cbranch_scc1 k1_kernel_A0_pollok
    s_sleep 1
    buffer_load_dword v13, v30, s[44:47], 0 offen sc1
    s_waitcnt vmcnt(0)
    s_branch k1_kernel_A0_poll
k1_kernel_A0_pollok:
    s_mov_b32 s35, 0
    buffer_load_dwordx4 v[64:67], v31, s[48:51], s35 offen sc1
    s_mov_b32 s36, 0
    buffer_load_dwordx2 v[104:105], v32, s[48:51], s36 offen sc1
    s_mov_b32 s35, 16384
    buffer_load_dwordx4 v[68:71], v31, s[48:51], s35 offen sc1
    s_mov_b32 s36, 8192
    buffer_load_dwordx2 v[106:107], v32, s[48:51], s36 offen sc1
    s_mov_b32 s35, 32768
    buffer_load_dwordx4 v[72:75], v31, s[48:51], s35 offen sc1
    s_mov_b32 s36, 16384
    buffer_load_dwordx2 v[108:109], v32, s[48:51], s36 offen sc1
    s_mov_b32 s35, 49152
    buffer_load_dwordx4 v[76:79], v31, s[48:51], s35 offen sc1
    s_mov_b32 s36, 24576
    buffer_load_dwordx2 v[110:111], v32, s[48:51], s36 offen sc1
    s_mov_b32 s35, 65536
    buffer_load_dwordx4 v[80:83], v31, s[48:51], s35 offen sc1
    s_mov_b32 s36, 32768
    buffer_load_dwordx2 v[112:113], v32, s[48:51], s36 offen sc1
    s_mov_b32 s35, 81920
    buffer_load_dwordx4 v[84:87], v31, s[48:51], s35 offen sc1
    s_mov_b32 s36, 40960
    buffer_load_dwordx2 v[114:115], v32, s[48:51], s36 offen sc1
    s_mov_b32 s35, 98304
    buffer_load_dwordx4 v[88:91], v31, s[48:51], s35 offen sc1
    s_mov_b32 s36, 49152
    buffer_load_dwordx2 v[116:117], v32, s[48:51], s36 offen sc1
    s_mov_b32 s35, 114688
    buffer_load_dwordx4 v[92:95], v31, s[48:51], s35 offen sc1
    s_mov_b32 s36, 57344
    buffer_load_dwordx2 v[118:119], v32, s[48:51], s36 offen sc1
    s_mov_b32 s35, 131072
    buffer_load_dwordx4 v[96:99], v31, s[48:51], s35 offen sc1
    s_mov_b32 s36, 65536
    buffer_load_dwordx2 v[120:121], v32, s[48:51], s36 offen sc1
    s_mov_b32 s35, 147456
    buffer_load_dwordx4 v[100:103], v31, s[48:51], s35 offen sc1
    s_mov_b32 s36, 73728
    buffer_load_dwordx2 v[122:123], v32, s[48:51], s36 offen sc1
    s_barrier
    s_waitcnt vmcnt(0)
    v_pk_add_f32 v[64:65], v[64:65], v[68:69]
    v_pk_add_f32 v[66:67], v[66:67], v[70:71]
    v_pk_add_f32 v[104:105], v[104:105], v[106:107]
    v_pk_add_f32 v[64:65], v[64:65], v[72:73]
    v_pk_add_f32 v[66:67], v[66:67], v[74:75]
    v_pk_add_f32 v[104:105], v[104:105], v[108:109]
    v_pk_add_f32 v[64:65], v[64:65], v[76:77]
    v_pk_add_f32 v[66:67], v[66:67], v[78:79]
    v_pk_add_f32 v[104:105], v[104:105], v[110:111]
    v_pk_add_f32 v[64:65], v[64:65], v[80:81]
    v_pk_add_f32 v[66:67], v[66:67], v[82:83]
    v_pk_add_f32 v[104:105], v[104:105], v[112:113]
    v_pk_add_f32 v[64:65], v[64:65], v[84:85]
    v_pk_add_f32 v[66:67], v[66:67], v[86:87]
    v_pk_add_f32 v[104:105], v[104:105], v[114:115]
    v_pk_add_f32 v[64:65], v[64:65], v[88:89]
    v_pk_add_f32 v[66:67], v[66:67], v[90:91]
    v_pk_add_f32 v[104:105], v[104:105], v[116:117]
    v_pk_add_f32 v[64:65], v[64:65], v[92:93]
    v_pk_add_f32 v[66:67], v[66:67], v[94:95]
    v_pk_add_f32 v[104:105], v[104:105], v[118:119]
    v_pk_add_f32 v[64:65], v[64:65], v[96:97]
    v_pk_add_f32 v[66:67], v[66:67], v[98:99]
    v_pk_add_f32 v[104:105], v[104:105], v[120:121]
    v_pk_add_f32 v[64:65], v[64:65], v[100:101]
    v_pk_add_f32 v[66:67], v[66:67], v[102:103]
    v_pk_add_f32 v[104:105], v[104:105], v[122:123]
    v_mul_f32 v64, 0x3acccccd, v64
    v_mul_f32 v65, 0x3acccccd, v65
    v_fma_f32 v65, -v64, v64, v65
    v_max_f32 v65, 0, v65
    v_add_f32 v65, 0x3727c5ac, v65
    v_rsq_f32 v65, v65
    s_nop 0
    v_mul_f32 v64, v64, v65
    v_mul_f32 v66, 0x3acccccd, v66
    v_mul_f32 v67, 0x3acccccd, v67
    v_fma_f32 v67, -v66, v66, v67
    v_max_f32 v67, 0, v67
    v_add_f32 v67, 0x3727c5ac, v67
    v_rsq_f32 v67, v67
    s_nop 0
    v_mul_f32 v66, v66, v67
    v_mov_b32 v68, v65
    v_mov_b32 v69, v67
    v_mov_b32 v70, v64
    v_mov_b32 v71, v66
    ds_write_b64 v33, v[68:69]
    ds_write_b64 v33, v[70:71] offset:512
    ds_write_b64 v33, v[104:105] offset:1024
    s_waitcnt lgkmcnt(0)
    s_barrier
    s_cmp_lg_u32 s2, 0
    s_cbranch_scc1 k1_kernel_end
    v_and_b32 v20, 15, v1
    v_cmp_eq_u32 vcc, 15, v20
    v_subrev_u32 v21, 1, v1
    s_nop 0
    v_cndmask_b32 v20, v1, v21, vcc
    v_lshlrev_b32 v20, 7, v20
    v_add_u32 v21, 8192, v20
    v_add_u32 v22, 16384, v20
    v_add_u32 v23, 24576, v20
    s_mov_b32 s38, 0
k1_kernel_A0_pall:
    buffer_load_dword v24, v20, s[44:47], 0 offen sc1
    buffer_load_dword v25, v21, s[44:47], 0 offen sc1
    buffer_load_dword v26, v22, s[44:47], 0 offen sc1
    buffer_load_dword v27, v23, s[44:47], 0 offen sc1
    s_waitcnt vmcnt(0)
    v_cmp_ne_u32 vcc, s34, v24
    v_cmp_ne_u32 s[36:37], s34, v25
    s_nop 3
    s_or_b64 vcc, vcc, s[36:37]
    v_cmp_ne_u32 s[36:37], s34, v26
    s_nop 3
    s_or_b64 vcc, vcc, s[36:37]
    v_cmp_ne_u32 s[36:37], s34, v27
    s_nop 3
    s_or_b64 vcc, vcc, s[36:37]
    s_cbranch_vccz k1_kernel_A0_pallok
    s_add_u32 s38, s38, 1
    s_cmp_ge_u32 s38, 100000
    s_cbranch_scc1 k1_kernel_A0_pallok
    s_sleep 1
    s_branch k1_kernel_A0_pall
k1_kernel_A0_pallok:
    v_mov_b32 v20, 0
    v_mov_b32 v21, s34
    s_mov_b32 s35, 65536
    v_cmp_eq_u32 vcc, 0, v1
    s_nop 3
    s_and_saveexec_b64 s[42:43], vcc
    buffer_store_dword v21, v20, s[44:47], s35 offen sc1
    s_mov_b64 exec, s[42:43]
    s_branch k1_kernel_end
k1_kernel_roleA1:
    s_lshl_b32 s31, s33, 7
    s_mul_i32 s32, s33, 245760
    s_add_u32 m0, s29, 0
    s_add_u32 s33, s33, 1
    buffer_load_dwordx4 v16, s[12:15], s31 offen offset:0 lds
    buffer_load_dwordx4 v17, s[12:15], s31 offen offset:1024 lds
    buffer_load_dwordx4 v18, s[12:15], s31 offen offset:2048 lds
    buffer_load_dwordx4 v19, s[12:15], s31 offen offset:3072 lds
    s_add_u32 m0, s30, 0
    s_cmp_eq_u32 s33, 10
    s_cselect_b32 s33, 0, s33
    buffer_load_dwordx4 v20, s[16:19], s32 offen offset:0 lds
    buffer_load_dwordx4 v21, s[16:19], s32 offen offset:1024 lds
    buffer_load_dwordx4 v22, s[16:19], s32 offen offset:2048 lds
    buffer_load_dwordx4 v23, s[16:19], s32 offen offset:3072 lds
    s_lshl_b32 s31, s33, 7
    s_mul_i32 s32, s33, 245760
    s_add_u32 m0, s29, 16384
    s_add_u32 s33, s33, 1
    buffer_load_dwordx4 v16, s[12:15], s31 offen offset:0 lds
    buffer_load_dwordx4 v17, s[12:15], s31 offen offset:1024 lds
    buffer_load_dwordx4 v18, s[12:15], s31 offen offset:2048 lds
    buffer_load_dwordx4 v19, s[12:15], s31 offen offset:3072 lds
    s_add_u32 m0, s30, 16384
    s_cmp_eq_u32 s33, 10
    s_cselect_b32 s33, 0, s33
    buffer_load_dwordx4 v20, s[16:19], s32 offen offset:0 lds
    buffer_load_dwordx4 v21, s[16:19], s32 offen offset:1024 lds
    buffer_load_dwordx4 v22, s[16:19], s32 offen offset:2048 lds
    buffer_load_dwordx4 v23, s[16:19], s32 offen offset:3072 lds
    s_waitcnt vmcnt(8)
    s_barrier
    s_lshl_b32 s31, s33, 7
    s_mul_i32 s32, s33, 245760
    s_add_u32 m0, s29, 49152
    s_add_u32 s33, s33, 1
    buffer_load_dwordx4 v16, s[12:15], s31 offen offset:0 lds
    buffer_load_dwordx4 v17, s[12:15], s31 offen offset:1024 lds
    buffer_load_dwordx4 v18, s[12:15], s31 offen offset:2048 lds
    buffer_load_dwordx4 v19, s[12:15], s31 offen offset:3072 lds
    s_add_u32 m0, s30, 49152
    s_cmp_eq_u32 s33, 10
    s_cselect_b32 s33, 0, s33
    buffer_load_dwordx4 v20, s[16:19], s32 offen offset:0 lds
    buffer_load_dwordx4 v21, s[16:19], s32 offen offset:1024 lds
    buffer_load_dwordx4 v22, s[16:19], s32 offen offset:2048 lds
    buffer_load_dwordx4 v23, s[16:19], s32 offen offset:3072 lds
    s_lshl_b32 s31, s33, 7
    s_mul_i32 s32, s33, 245760
    s_add_u32 m0, s29, 32768
    s_add_u32 s33, s33, 1
    buffer_load_dwordx4 v16, s[12:15], s31 offen offset:0 lds
    buffer_load_dwordx4 v17, s[12:15], s31 offen offset:1024 lds
    buffer_load_dwordx4 v18, s[12:15], s31 offen offset:2048 lds
    buffer_load_dwordx4 v19, s[12:15], s31 offen offset:3072 lds
    s_add_u32 m0, s30, 32768
    s_cmp_eq_u32 s33, 10
    s_cselect_b32 s33, 0, s33
    buffer_load_dwordx4 v20, s[16:19], s32 offen offset:0 lds
    buffer_load_dwordx4 v21, s[16:19], s32 offen offset:1024 lds
    buffer_load_dwordx4 v22, s[16:19], s32 offen offset:2048 lds
    buffer_load_dwordx4 v23, s[16:19], s32 offen offset:3072 lds
    s_waitcnt vmcnt(16)
    s_barrier
    s_lshl_b32 s31, s33, 7
    s_mul_i32 s32, s33, 245760
    s_add_u32 m0, s29, 0
    s_add_u32 s33, s33, 1
    buffer_load_dwordx4 v16, s[12:15], s31 offen offset:0 lds
    buffer_load_dwordx4 v17, s[12:15], s31 offen offset:1024 lds
    buffer_load_dwordx4 v18, s[12:15], s31 offen offset:2048 lds
    buffer_load_dwordx4 v19, s[12:15], s31 offen offset:3072 lds
    s_add_u32 m0, s30, 0
    s_cmp_eq_u32 s33, 10
    s_cselect_b32 s33, 0, s33
    buffer_load_dwordx4 v20, s[16:19], s32 offen offset:0 lds
    buffer_load_dwordx4 v21, s[16:19], s32 offen offset:1024 lds
    buffer_load_dwordx4 v22, s[16:19], s32 offen offset:2048 lds
    buffer_load_dwordx4 v23, s[16:19], s32 offen offset:3072 lds
    s_waitcnt vmcnt(16)
    s_barrier
    s_lshl_b32 s31, s33, 7
    s_mul_i32 s32, s33, 245760
    s_add_u32 m0, s29, 16384
    s_add_u32 s33, s33, 1
    buffer_load_dwordx4 v16, s[12:15], s31 offen offset:0 lds
    buffer_load_dwordx4 v17, s[12:15], s31 offen offset:1024 lds
    buffer_load_dwordx4 v18, s[12:15], s31 offen offset:2048 lds
    buffer_load_dwordx4 v19, s[12:15], s31 offen offset:3072 lds
    s_add_u32 m0, s30, 16384
    s_cmp_eq_u32 s33, 10
    s_cselect_b32 s33, 0, s33
    buffer_load_dwordx4 v20, s[16:19], s32 offen offset:0 lds
    buffer_load_dwordx4 v21, s[16:19], s32 offen offset:1024 lds
    buffer_load_dwordx4 v22, s[16:19], s32 offen offset:2048 lds
    buffer_load_dwordx4 v23, s[16:19], s32 offen offset:3072 lds
    s_waitcnt vmcnt(16)
    s_barrier
    s_lshl_b32 s31, s33, 7
    s_mul_i32 s32, s33, 245760
    s_add_u32 m0, s29, 49152
    s_add_u32 s33, s33, 1
    buffer_load_dwordx4 v16, s[12:15], s31 offen offset:0 lds
    buffer_load_dwordx4 v17, s[12:15], s31 offen offset:1024 lds
    buffer_load_dwordx4 v18, s[12:15], s31 offen offset:2048 lds
    buffer_load_dwordx4 v19, s[12:15], s31 offen offset:3072 lds
    s_add_u32 m0, s30, 49152
    s_cmp_eq_u32 s33, 10
    s_cselect_b32 s33, 0, s33
    buffer_load_dwordx4 v20, s[16:19], s32 offen offset:0 lds
    buffer_load_dwordx4 v21, s[16:19], s32 offen offset:1024 lds
    buffer_load_dwordx4 v22, s[16:19], s32 offen offset:2048 lds
    buffer_load_dwordx4 v23, s[16:19], s32 offen offset:3072 lds
    s_waitcnt vmcnt(16)
    s_barrier
    s_lshl_b32 s31, s33, 7
    s_mul_i32 s32, s33, 245760
    s_add_u32 m0, s29, 32768
    s_add_u32 s33, s33, 1
    buffer_load_dwordx4 v16, s[12:15], s31 offen offset:0 lds
    buffer_load_dwordx4 v17, s[12:15], s31 offen offset:1024 lds
    buffer_load_dwordx4 v18, s[12:15], s31 offen offset:2048 lds
    buffer_load_dwordx4 v19, s[12:15], s31 offen offset:3072 lds
    s_add_u32 m0, s30, 32768
    s_cmp_eq_u32 s33, 10
    s_cselect_b32 s33, 0, s33
    buffer_load_dwordx4 v20, s[16:19], s32 offen offset:0 lds
    buffer_load_dwordx4 v21, s[16:19], s32 offen offset:1024 lds
    buffer_load_dwordx4 v22, s[16:19], s32 offen offset:2048 lds
    buffer_load_dwordx4 v23, s[16:19], s32 offen offset:3072 lds
    s_waitcnt vmcnt(16)
    s_barrier
    s_lshl_b32 s31, s33, 7
    s_mul_i32 s32, s33, 245760
    s_add_u32 m0, s29, 0
    s_add_u32 s33, s33, 1
    buffer_load_dwordx4 v16, s[12:15], s31 offen offset:0 lds
    buffer_load_dwordx4 v17, s[12:15], s31 offen offset:1024 lds
    buffer_load_dwordx4 v18, s[12:15], s31 offen offset:2048 lds
    buffer_load_dwordx4 v19, s[12:15], s31 offen offset:3072 lds
    s_add_u32 m0, s30, 0
    s_cmp_eq_u32 s33, 10
    s_cselect_b32 s33, 0, s33
    buffer_load_dwordx4 v20, s[16:19], s32 offen offset:0 lds
    buffer_load_dwordx4 v21, s[16:19], s32 offen offset:1024 lds
    buffer_load_dwordx4 v22, s[16:19], s32 offen offset:2048 lds
    buffer_load_dwordx4 v23, s[16:19], s32 offen offset:3072 lds
    s_waitcnt vmcnt(16)
    s_barrier
    s_lshl_b32 s31, s33, 7
    s_mul_i32 s32, s33, 245760
    s_add_u32 m0, s29, 16384
    s_add_u32 s33, s33, 1
    buffer_load_dwordx4 v16, s[12:15], s31 offen offset:0 lds
    buffer_load_dwordx4 v17, s[12:15], s31 offen offset:1024 lds
    buffer_load_dwordx4 v18, s[12:15], s31 offen offset:2048 lds
    buffer_load_dwordx4 v19, s[12:15], s31 offen offset:3072 lds
    s_add_u32 m0, s30, 16384
    s_cmp_eq_u32 s33, 10
    s_cselect_b32 s33, 0, s33
    buffer_load_dwordx4 v20, s[16:19], s32 offen offset:0 lds
    buffer_load_dwordx4 v21, s[16:19], s32 offen offset:1024 lds
    buffer_load_dwordx4 v22, s[16:19], s32 offen offset:2048 lds
    buffer_load_dwordx4 v23, s[16:19], s32 offen offset:3072 lds
    s_waitcnt vmcnt(16)
    s_barrier
    s_waitcnt vmcnt(8)
    s_barrier
    s_waitcnt vmcnt(0)
    s_barrier
    s_add_u32 s60, s10, 19660800
    s_addc_u32 s61, s11, 0
    s_mov_b32 s62, 86016
    s_mov_b32 s63, 0x00020000
    s_barrier
    s_mov_b32 s40, 0xffff0000
    s_load_dwordx4 s[36:39], s[0:1], 32
    s_mov_b32 s34, s2
    s_mul_i32 s35, s34, 1366
    s_lshr_b32 s35, s35, 16
    s_mul_i32 s33, s35, 48
    s_sub_u32 s33, s34, s33
    s_cmp_ge_u32 s33, 24
    s_cselect_b32 s41, 24, 0
    s_sub_u32 s41, s33, s41
    s_lshl_b32 s41, s41, 7
    v_and_b32 v8, 7, v1
    v_lshrrev_b32 v9, 3, v1
    s_lshl_b32 s42, s35, 7
    v_add_u32 v9, s42, v9
    v_mul_u32_u24 v9, 3072, v9
    v_lshl_add_u32 v9, v8, 4, v9
    v_add_u32 v61, s41, v9
    s_mul_i32 s57, s35, 12288
    s_lshl_b32 s41, s33, 8
    s_add_u32 s57, s57, s41
    s_add_u32 s57, s57, 24576
    s_waitcnt lgkmcnt(0)
    s_cmp_ge_u32 s33, 24
    s_cselect_b32 s36, s38, s36
    s_cselect_b32 s37, s39, s37
    s_mov_b32 s44, s36
    s_mov_b32 s45, s37
    s_mov_b32 s46, 1966080
    s_mov_b32 s47, 0x00020000
    s_mov_b32 s34, 0
    buffer_load_dwordx4 v[64:67], v61, s[44:47], s34 offen
    s_mov_b32 s34, 24576
    buffer_load_dwordx4 v[68:71], v61, s[44:47], s34 offen
    s_mov_b32 s34, 49152
    buffer_load_dwordx4 v[72:75], v61, s[44:47], s34 offen
    s_mov_b32 s34, 73728
    buffer_load_dwordx4 v[76:79], v61, s[44:47], s34 offen
    s_mov_b32 s34, 98304
    buffer_load_dwordx4 v[80:83], v61, s[44:47], s34 offen
    s_mov_b32 s34, 122880
    buffer_load_dwordx4 v[84:87], v61, s[44:47], s34 offen
    s_mov_b32 s34, 147456
    buffer_load_dwordx4 v[88:91], v61, s[44:47], s34 offen
    s_mov_b32 s34, 172032
    buffer_load_dwordx4 v[92:95], v61, s[44:47], s34 offen
    s_mov_b32 s34, 196608
    buffer_load_dwordx4 v[96:99], v61, s[44:47], s34 offen
    s_mov_b32 s34, 221184
    buffer_load_dwordx4 v[100:103], v61, s[44:47], s34 offen
    s_mov_b32 s34, 245760
    buffer_load_dwordx4 v[104:107], v61, s[44:47], s34 offen
    s_mov_b32 s34, 270336
    buffer_load_dwordx4 v[108:111], v61, s[44:47], s34 offen
    s_mov_b32 s34, 294912
    buffer_load_dwordx4 v[112:115], v61, s[44:47], s34 offen
    s_mov_b32 s34, 319488
    buffer_load_dwordx4 v[116:119], v61, s[44:47], s34 offen
    s_mov_b32 s34, 344064
    buffer_load_dwordx4 v[120:123], v61, s[44:47], s34 offen
    s_mov_b32 s34, 368640
    buffer_load_dwordx4 v[124:127], v61, s[44:47], s34 offen
    v_mov_b32 v24, 0
    v_mov_b32 v25, 0
    v_mov_b32 v26, 0
    v_mov_b32 v27, 0
    v_mov_b32 v28, 0
    v_mov_b32 v29, 0
    v_mov_b32 v30, 0
    v_mov_b32 v31, 0
    s_waitcnt vmcnt(15)
    v_lshlrev_b32 v10, 16, v64
    v_and_b32 v11, s40, v64
    v_pk_add_f32 v[24:25], v[24:25], v[10:11]
    v_lshlrev_b32 v10, 16, v65
    v_and_b32 v11, s40, v65
    v_pk_add_f32 v[26:27], v[26:27], v[10:11]
    v_lshlrev_b32 v10, 16, v66
    v_and_b32 v11, s40, v66
    v_pk_add_f32 v[28:29], v[28:29], v[10:11]
    v_lshlrev_b32 v10, 16, v67
    v_and_b32 v11, s40, v67
    v_pk_add_f32 v[30:31], v[30:31], v[10:11]
    s_waitcnt vmcnt(14)
    v_lshlrev_b32 v10, 16, v68
    v_and_b32 v11, s40, v68
    v_pk_add_f32 v[24:25], v[24:25], v[10:11]
    v_lshlrev_b32 v10, 16, v69
    v_and_b32 v11, s40, v69
    v_pk_add_f32 v[26:27], v[26:27], v[10:11]
    v_lshlrev_b32 v10, 16, v70
    v_and_b32 v11, s40, v70
    v_pk_add_f32 v[28:29], v[28:29], v[10:11]
    v_lshlrev_b32 v10, 16, v71
    v_and_b32 v11, s40, v71
    v_pk_add_f32 v[30:31], v[30:31], v[10:11]
    s_waitcnt vmcnt(13)
    v_lshlrev_b32 v10, 16, v72
    v_and_b32 v11, s40, v72
    v_pk_add_f32 v[24:25], v[24:25], v[10:11]
    v_lshlrev_b32 v10, 16, v73
    v_and_b32 v11, s40, v73
    v_pk_add_f32 v[26:27], v[26:27], v[10:11]
    v_lshlrev_b32 v10, 16, v74
    v_and_b32 v11, s40, v74
    v_pk_add_f32 v[28:29], v[28:29], v[10:11]
    v_lshlrev_b32 v10, 16, v75
    v_and_b32 v11, s40, v75
    v_pk_add_f32 v[30:31], v[30:31], v[10:11]
    s_waitcnt vmcnt(12)
    v_lshlrev_b32 v10, 16, v76
    v_and_b32 v11, s40, v76
    v_pk_add_f32 v[24:25], v[24:25], v[10:11]
    v_lshlrev_b32 v10, 16, v77
    v_and_b32 v11, s40, v77
    v_pk_add_f32 v[26:27], v[26:27], v[10:11]
    v_lshlrev_b32 v10, 16, v78
    v_and_b32 v11, s40, v78
    v_pk_add_f32 v[28:29], v[28:29], v[10:11]
    v_lshlrev_b32 v10, 16, v79
    v_and_b32 v11, s40, v79
    v_pk_add_f32 v[30:31], v[30:31], v[10:11]
    s_waitcnt vmcnt(11)
    v_lshlrev_b32 v10, 16, v80
    v_and_b32 v11, s40, v80
    v_pk_add_f32 v[24:25], v[24:25], v[10:11]
    v_lshlrev_b32 v10, 16, v81
    v_and_b32 v11, s40, v81
    v_pk_add_f32 v[26:27], v[26:27], v[10:11]
    v_lshlrev_b32 v10, 16, v82
    v_and_b32 v11, s40, v82
    v_pk_add_f32 v[28:29], v[28:29], v[10:11]
    v_lshlrev_b32 v10, 16, v83
    v_and_b32 v11, s40, v83
    v_pk_add_f32 v[30:31], v[30:31], v[10:11]
    s_waitcnt vmcnt(10)
    v_lshlrev_b32 v10, 16, v84
    v_and_b32 v11, s40, v84
    v_pk_add_f32 v[24:25], v[24:25], v[10:11]
    v_lshlrev_b32 v10, 16, v85
    v_and_b32 v11, s40, v85
    v_pk_add_f32 v[26:27], v[26:27], v[10:11]
    v_lshlrev_b32 v10, 16, v86
    v_and_b32 v11, s40, v86
    v_pk_add_f32 v[28:29], v[28:29], v[10:11]
    v_lshlrev_b32 v10, 16, v87
    v_and_b32 v11, s40, v87
    v_pk_add_f32 v[30:31], v[30:31], v[10:11]
    s_waitcnt vmcnt(9)
    v_lshlrev_b32 v10, 16, v88
    v_and_b32 v11, s40, v88
    v_pk_add_f32 v[24:25], v[24:25], v[10:11]
    v_lshlrev_b32 v10, 16, v89
    v_and_b32 v11, s40, v89
    v_pk_add_f32 v[26:27], v[26:27], v[10:11]
    v_lshlrev_b32 v10, 16, v90
    v_and_b32 v11, s40, v90
    v_pk_add_f32 v[28:29], v[28:29], v[10:11]
    v_lshlrev_b32 v10, 16, v91
    v_and_b32 v11, s40, v91
    v_pk_add_f32 v[30:31], v[30:31], v[10:11]
    s_waitcnt vmcnt(8)
    v_lshlrev_b32 v10, 16, v92
    v_and_b32 v11, s40, v92
    v_pk_add_f32 v[24:25], v[24:25], v[10:11]
    v_lshlrev_b32 v10, 16, v93
    v_and_b32 v11, s40, v93
    v_pk_add_f32 v[26:27], v[26:27], v[10:11]
    v_lshlrev_b32 v10, 16, v94
    v_and_b32 v11, s40, v94
    v_pk_add_f32 v[28:29], v[28:29], v[10:11]
    v_lshlrev_b32 v10, 16, v95
    v_and_b32 v11, s40, v95
    v_pk_add_f32 v[30:31], v[30:31], v[10:11]
    s_waitcnt vmcnt(7)
    v_lshlrev_b32 v10, 16, v96
    v_and_b32 v11, s40, v96
    v_pk_add_f32 v[24:25], v[24:25], v[10:11]
    v_lshlrev_b32 v10, 16, v97
    v_and_b32 v11, s40, v97
    v_pk_add_f32 v[26:27], v[26:27], v[10:11]
    v_lshlrev_b32 v10, 16, v98
    v_and_b32 v11, s40, v98
    v_pk_add_f32 v[28:29], v[28:29], v[10:11]
    v_lshlrev_b32 v10, 16, v99
    v_and_b32 v11, s40, v99
    v_pk_add_f32 v[30:31], v[30:31], v[10:11]
    s_waitcnt vmcnt(6)
    v_lshlrev_b32 v10, 16, v100
    v_and_b32 v11, s40, v100
    v_pk_add_f32 v[24:25], v[24:25], v[10:11]
    v_lshlrev_b32 v10, 16, v101
    v_and_b32 v11, s40, v101
    v_pk_add_f32 v[26:27], v[26:27], v[10:11]
    v_lshlrev_b32 v10, 16, v102
    v_and_b32 v11, s40, v102
    v_pk_add_f32 v[28:29], v[28:29], v[10:11]
    v_lshlrev_b32 v10, 16, v103
    v_and_b32 v11, s40, v103
    v_pk_add_f32 v[30:31], v[30:31], v[10:11]
    s_waitcnt vmcnt(5)
    v_lshlrev_b32 v10, 16, v104
    v_and_b32 v11, s40, v104
    v_pk_add_f32 v[24:25], v[24:25], v[10:11]
    v_lshlrev_b32 v10, 16, v105
    v_and_b32 v11, s40, v105
    v_pk_add_f32 v[26:27], v[26:27], v[10:11]
    v_lshlrev_b32 v10, 16, v106
    v_and_b32 v11, s40, v106
    v_pk_add_f32 v[28:29], v[28:29], v[10:11]
    v_lshlrev_b32 v10, 16, v107
    v_and_b32 v11, s40, v107
    v_pk_add_f32 v[30:31], v[30:31], v[10:11]
    s_waitcnt vmcnt(4)
    v_lshlrev_b32 v10, 16, v108
    v_and_b32 v11, s40, v108
    v_pk_add_f32 v[24:25], v[24:25], v[10:11]
    v_lshlrev_b32 v10, 16, v109
    v_and_b32 v11, s40, v109
    v_pk_add_f32 v[26:27], v[26:27], v[10:11]
    v_lshlrev_b32 v10, 16, v110
    v_and_b32 v11, s40, v110
    v_pk_add_f32 v[28:29], v[28:29], v[10:11]
    v_lshlrev_b32 v10, 16, v111
    v_and_b32 v11, s40, v111
    v_pk_add_f32 v[30:31], v[30:31], v[10:11]
    s_waitcnt vmcnt(3)
    v_lshlrev_b32 v10, 16, v112
    v_and_b32 v11, s40, v112
    v_pk_add_f32 v[24:25], v[24:25], v[10:11]
    v_lshlrev_b32 v10, 16, v113
    v_and_b32 v11, s40, v113
    v_pk_add_f32 v[26:27], v[26:27], v[10:11]
    v_lshlrev_b32 v10, 16, v114
    v_and_b32 v11, s40, v114
    v_pk_add_f32 v[28:29], v[28:29], v[10:11]
    v_lshlrev_b32 v10, 16, v115
    v_and_b32 v11, s40, v115
    v_pk_add_f32 v[30:31], v[30:31], v[10:11]
    s_waitcnt vmcnt(2)
    v_lshlrev_b32 v10, 16, v116
    v_and_b32 v11, s40, v116
    v_pk_add_f32 v[24:25], v[24:25], v[10:11]
    v_lshlrev_b32 v10, 16, v117
    v_and_b32 v11, s40, v117
    v_pk_add_f32 v[26:27], v[26:27], v[10:11]
    v_lshlrev_b32 v10, 16, v118
    v_and_b32 v11, s40, v118
    v_pk_add_f32 v[28:29], v[28:29], v[10:11]
    v_lshlrev_b32 v10, 16, v119
    v_and_b32 v11, s40, v119
    v_pk_add_f32 v[30:31], v[30:31], v[10:11]
    s_waitcnt vmcnt(1)
    v_lshlrev_b32 v10, 16, v120
    v_and_b32 v11, s40, v120
    v_pk_add_f32 v[24:25], v[24:25], v[10:11]
    v_lshlrev_b32 v10, 16, v121
    v_and_b32 v11, s40, v121
    v_pk_add_f32 v[26:27], v[26:27], v[10:11]
    v_lshlrev_b32 v10, 16, v122
    v_and_b32 v11, s40, v122
    v_pk_add_f32 v[28:29], v[28:29], v[10:11]
    v_lshlrev_b32 v10, 16, v123
    v_and_b32 v11, s40, v123
    v_pk_add_f32 v[30:31], v[30:31], v[10:11]
    s_waitcnt vmcnt(0)
    v_lshlrev_b32 v10, 16, v124
    v_and_b32 v11, s40, v124
    v_pk_add_f32 v[24:25], v[24:25], v[10:11]
    v_lshlrev_b32 v10, 16, v125
    v_and_b32 v11, s40, v125
    v_pk_add_f32 v[26:27], v[26:27], v[10:11]
    v_lshlrev_b32 v10, 16, v126
    v_and_b32 v11, s40, v126
    v_pk_add_f32 v[28:29], v[28:29], v[10:11]
    v_lshlrev_b32 v10, 16, v127
    v_and_b32 v11, s40, v127
    v_pk_add_f32 v[30:31], v[30:31], v[10:11]
    v_add_f32_dpp v24, v24, v24 row_ror:8 row_mask:0xf bank_mask:0xf
    v_add_f32_dpp v25, v25, v25 row_ror:8 row_mask:0xf bank_mask:0xf
    v_add_f32_dpp v26, v26, v26 row_ror:8 row_mask:0xf bank_mask:0xf
    v_add_f32_dpp v27, v27, v27 row_ror:8 row_mask:0xf bank_mask:0xf
    v_add_f32_dpp v28, v28, v28 row_ror:8 row_mask:0xf bank_mask:0xf
    v_add_f32_dpp v29, v29, v29 row_ror:8 row_mask:0xf bank_mask:0xf
    v_add_f32_dpp v30, v30, v30 row_ror:8 row_mask:0xf bank_mask:0xf
    v_add_f32_dpp v31, v31, v31 row_ror:8 row_mask:0xf bank_mask:0xf
    v_mov_b32 v40, v24
    v_mov_b32 v41, v25
    v_mov_b32 v42, v26
    v_mov_b32 v43, v27
    v_mov_b32 v44, v28
    v_mov_b32 v45, v29
    v_mov_b32 v46, v30
    v_mov_b32 v47, v31
    v_permlane16_swap_b32 v40, v24
    v_permlane16_swap_b32 v41, v25
    v_permlane16_swap_b32 v42, v26
    v_permlane16_swap_b32 v43, v27
    v_permlane16_swap_b32 v44, v28
    v_permlane16_swap_b32 v45, v29
    v_permlane16_swap_b32 v46, v30
    v_permlane16_swap_b32 v47, v31
    v_add_f32 v24, v24, v40
    v_add_f32 v25, v25, v41
    v_add_f32 v26, v26, v42
    v_add_f32 v27, v27, v43
    v_add_f32 v28, v28, v44
    v_add_f32 v29, v29, v45
    v_add_f32 v30, v30, v46
    v_add_f32 v31, v31, v47
    v_mov_b32 v40, v24
    v_mov_b32 v41, v25
    v_mov_b32 v42, v26
    v_mov_b32 v43, v27
    v_mov_b32 v44, v28
    v_mov_b32 v45, v29
    v_mov_b32 v46, v30
    v_mov_b32 v47, v31
    v_permlane32_swap_b32 v40, v24
    v_permlane32_swap_b32 v41, v25
    v_permlane32_swap_b32 v42, v26
    v_permlane32_swap_b32 v43, v27
    v_permlane32_swap_b32 v44, v28
    v_permlane32_swap_b32 v45, v29
    v_permlane32_swap_b32 v46, v30
    v_permlane32_swap_b32 v47, v31
    v_add_f32 v24, v24, v40
    v_add_f32 v25, v25, v41
    v_add_f32 v26, v26, v42
    v_add_f32 v27, v27, v43
    v_add_f32 v28, v28, v44
    v_add_f32 v29, v29, v45
    v_add_f32 v30, v30, v46
    v_add_f32 v31, v31, v47
    v_cmp_gt_u32 vcc, 8, v1
    s_nop 3
    s_and_saveexec_b64 s[42:43], vcc
    v_lshlrev_b32 v10, 5, v1
    buffer_store_dwordx4 v[24:27], v10, s[60:63], s57 offen
    buffer_store_dwordx4 v[28:31], v10, s[60:63], s57 offen offset:16
    s_branch k1_kernel_end
k1_kernel_roleF:
    s_lshl_b32 s31, s33, 7
    s_mul_i32 s32, s33, 245760
    s_add_u32 m0, s29, 0
    s_add_u32 s33, s33, 1
    buffer_load_dwordx4 v16, s[12:15], s31 offen offset:0 lds
    buffer_load_dwordx4 v17, s[12:15], s31 offen offset:1024 lds
    buffer_load_dwordx4 v18, s[12:15], s31 offen offset:2048 lds
    buffer_load_dwordx4 v19, s[12:15], s31 offen offset:3072 lds
    s_add_u32 m0, s30, 0
    s_cmp_eq_u32 s33, 10
    s_cselect_b32 s33, 0, s33
    buffer_load_dwordx4 v20, s[16:19], s32 offen offset:0 lds
    buffer_load_dwordx4 v21, s[16:19], s32 offen offset:1024 lds
    buffer_load_dwordx4 v22, s[16:19], s32 offen offset:2048 lds
    buffer_load_dwordx4 v23, s[16:19], s32 offen offset:3072 lds
    s_lshl_b32 s31, s33, 7
    s_mul_i32 s32, s33, 245760
    s_add_u32 m0, s29, 16384
    s_add_u32 s33, s33, 1
    buffer_load_dwordx4 v16, s[12:15], s31 offen offset:0 lds
    buffer_load_dwordx4 v17, s[12:15], s31 offen offset:1024 lds
    buffer_load_dwordx4 v18, s[12:15], s31 offen offset:2048 lds
    buffer_load_dwordx4 v19, s[12:15], s31 offen offset:3072 lds
    s_add_u32 m0, s30, 16384
    s_cmp_eq_u32 s33, 10
    s_cselect_b32 s33, 0, s33
    buffer_load_dwordx4 v20, s[16:19], s32 offen offset:0 lds
    buffer_load_dwordx4 v21, s[16:19], s32 offen offset:1024 lds
    buffer_load_dwordx4 v22, s[16:19], s32 offen offset:2048 lds
    buffer_load_dwordx4 v23, s[16:19], s32 offen offset:3072 lds
    s_add_u32 s44, s10, 19746816
    s_addc_u32 s45, s11, 0
    s_mov_b32 s46, 69632
    s_mov_b32 s47, 0x00020000
    s_add_u32 s34, s10, 19812352
    s_addc_u32 s35, s11, 0
    s_load_dword s58, s[34:35], 0
    s_waitcnt vmcnt(8)
    s_barrier
    s_lshl_b32 s31, s33, 7
    s_mul_i32 s32, s33, 245760
    s_add_u32 m0, s29, 49152
    s_add_u32 s33, s33, 1
    buffer_load_dwordx4 v16, s[12:15], s31 offen offset:0 lds
    buffer_load_dwordx4 v17, s[12:15], s31 offen offset:1024 lds
    buffer_load_dwordx4 v18, s[12:15], s31 offen offset:2048 lds
    buffer_load_dwordx4 v19, s[12:15], s31 offen offset:3072 lds
    s_add_u32 m0, s30, 49152
    s_cmp_eq_u32 s33, 10
    s_cselect_b32 s33, 0, s33
    buffer_load_dwordx4 v20, s[16:19], s32 offen offset:0 lds
    buffer_load_dwordx4 v21, s[16:19], s32 offen offset:1024 lds
    buffer_load_dwordx4 v22, s[16:19], s32 offen offset:2048 lds
    buffer_load_dwordx4 v23, s[16:19], s32 offen offset:3072 lds
    s_lshl_b32 s31, s33, 7
    s_mul_i32 s32, s33, 245760
    s_add_u32 m0, s29, 32768
    s_add_u32 s33, s33, 1
    buffer_load_dwordx4 v16, s[12:15], s31 offen offset:0 lds
    buffer_load_dwordx4 v17, s[12:15], s31 offen offset:1024 lds
    buffer_load_dwordx4 v18, s[12:15], s31 offen offset:2048 lds
    buffer_load_dwordx4 v19, s[12:15], s31 offen offset:3072 lds
    s_add_u32 m0, s30, 32768
    s_cmp_eq_u32 s33, 10
    s_cselect_b32 s33, 0, s33
    buffer_load_dwordx4 v20, s[16:19], s32 offen offset:0 lds
    buffer_load_dwordx4 v21, s[16:19], s32 offen offset:1024 lds
    buffer_load_dwordx4 v22, s[16:19], s32 offen offset:2048 lds
    buffer_load_dwordx4 v23, s[16:19], s32 offen offset:3072 lds
    s_waitcnt vmcnt(16)
    s_barrier
    s_lshl_b32 s31, s33, 7
    s_mul_i32 s32, s33, 245760
    s_add_u32 m0, s29, 0
    s_add_u32 s33, s33, 1
    buffer_load_dwordx4 v16, s[12:15], s31 offen offset:0 lds
    buffer_load_dwordx4 v17, s[12:15], s31 offen offset:1024 lds
    buffer_load_dwordx4 v18, s[12:15], s31 offen offset:2048 lds
    buffer_load_dwordx4 v19, s[12:15], s31 offen offset:3072 lds
    s_add_u32 m0, s30, 0
    s_cmp_eq_u32 s33, 10
    s_cselect_b32 s33, 0, s33
    buffer_load_dwordx4 v20, s[16:19], s32 offen offset:0 lds
    buffer_load_dwordx4 v21, s[16:19], s32 offen offset:1024 lds
    buffer_load_dwordx4 v22, s[16:19], s32 offen offset:2048 lds
    buffer_load_dwordx4 v23, s[16:19], s32 offen offset:3072 lds
    s_waitcnt vmcnt(16)
    s_barrier
    s_lshl_b32 s31, s33, 7
    s_mul_i32 s32, s33, 245760
    s_add_u32 m0, s29, 16384
    s_add_u32 s33, s33, 1
    buffer_load_dwordx4 v16, s[12:15], s31 offen offset:0 lds
    buffer_load_dwordx4 v17, s[12:15], s31 offen offset:1024 lds
    buffer_load_dwordx4 v18, s[12:15], s31 offen offset:2048 lds
    buffer_load_dwordx4 v19, s[12:15], s31 offen offset:3072 lds
    s_add_u32 m0, s30, 16384
    s_cmp_eq_u32 s33, 10
    s_cselect_b32 s33, 0, s33
    buffer_load_dwordx4 v20, s[16:19], s32 offen offset:0 lds
    buffer_load_dwordx4 v21, s[16:19], s32 offen offset:1024 lds
    buffer_load_dwordx4 v22, s[16:19], s32 offen offset:2048 lds
    buffer_load_dwordx4 v23, s[16:19], s32 offen offset:3072 lds
    s_waitcnt vmcnt(16)
    s_barrier
    s_waitcnt lgkmcnt(0)
    s_add_u32 s34, s58, 2654435761
    v_mov_b32 v8, 0
    v_mov_b32 v9, s34
    s_lshl_b32 s35, s24, 4
    s_add_u32 s35, s35, s25
    s_lshl_b32 s35, s35, 7
    v_cmp_eq_u32 vcc, 0, v1
    s_nop 3
    s_and_saveexec_b64 s[42:43], vcc
    buffer_store_dword v9, v8, s[44:47], s35 offen sc1
    s_mov_b64 exec, s[42:43]
    s_lshl_b32 s31, s33, 7
    s_mul_i32 s32, s33, 245760
    s_add_u32 m0, s29, 49152
    s_add_u32 s33, s33, 1
    buffer_load_dwordx4 v16, s[12:15], s31 offen offset:0 lds
    buffer_load_dwordx4 v17, s[12:15], s31 offen offset:1024 lds
    buffer_load_dwordx4 v18, s[12:15], s31 offen offset:2048 lds
    buffer_load_dwordx4 v19, s[12:15], s31 offen offset:3072 lds
    s_add_u32 m0, s30, 49152
    s_cmp_eq_u32 s33, 10
    s_cselect_b32 s33, 0, s33
    buffer_load_dwordx4 v20, s[16:19], s32 offen offset:0 lds
    buffer_load_dwordx4 v21, s[16:19], s32 offen offset:1024 lds
    buffer_load_dwordx4 v22, s[16:19], s32 offen offset:2048 lds
    buffer_load_dwordx4 v23, s[16:19], s32 offen offset:3072 lds
    s_waitcnt vmcnt(17)
    s_barrier
    s_lshl_b32 s31, s33, 7
    s_mul_i32 s32, s33, 245760
    s_add_u32 m0, s29, 32768
    s_add_u32 s33, s33, 1
    buffer_load_dwordx4 v16, s[12:15], s31 offen offset:0 lds
    buffer_load_dwordx4 v17, s[12:15], s31 offen offset:1024 lds
    buffer_load_dwordx4 v18, s[12:15], s31 offen offset:2048 lds
    buffer_load_dwordx4 v19, s[12:15], s31 offen offset:3072 lds
    s_add_u32 m0, s30, 32768
    s_cmp_eq_u32 s33, 10
    s_cselect_b32 s33, 0, s33
    buffer_load_dwordx4 v20, s[16:19], s32 offen offset:0 lds
    buffer_load_dwordx4 v21, s[16:19], s32 offen offset:1024 lds
    buffer_load_dwordx4 v22, s[16:19], s32 offen offset:2048 lds
    buffer_load_dwordx4 v23, s[16:19], s32 offen offset:3072 lds
    s_waitcnt vmcnt(17)
    s_barrier
    s_lshl_b32 s31, s33, 7
    s_mul_i32 s32, s33, 245760
    s_add_u32 m0, s29, 0
    s_add_u32 s33, s33, 1
    buffer_load_dwordx4 v16, s[12:15], s31 offen offset:0 lds
    buffer_load_dwordx4 v17, s[12:15], s31 offen offset:1024 lds
    buffer_load_dwordx4 v18, s[12:15], s31 offen offset:2048 lds
    buffer_load_dwordx4 v19, s[12:15], s31 offen offset:3072 lds
    s_add_u32 m0, s30, 0
    s_cmp_eq_u32 s33, 10
    s_cselect_b32 s33, 0, s33
    buffer_load_dwordx4 v20, s[16:19], s32 offen offset:0 lds
    buffer_load_dwordx4 v21, s[16:19], s32 offen offset:1024 lds
    buffer_load_dwordx4 v22, s[16:19], s32 offen offset:2048 lds
    buffer_load_dwordx4 v23, s[16:19], s32 offen offset:3072 lds
    s_waitcnt vmcnt(16)
    s_barrier
    s_lshl_b32 s31, s33, 7
    s_mul_i32 s32, s33, 245760
    s_add_u32 m0, s29, 16384
    s_add_u32 s33, s33, 1
    buffer_load_dwordx4 v16, s[12:15], s31 offen offset:0 lds
    buffer_load_dwordx4 v17, s[12:15], s31 offen offset:1024 lds
    buffer_load_dwordx4 v18, s[12:15], s31 offen offset:2048 lds
    buffer_load_dwordx4 v19, s[12:15], s31 offen offset:3072 lds
    s_add_u32 m0, s30, 16384
    s_cmp_eq_u32 s33, 10
    s_cselect_b32 s33, 0, s33
    buffer_load_dwordx4 v20, s[16:19], s32 offen offset:0 lds
    buffer_load_dwordx4 v21, s[16:19], s32 offen offset:1024 lds
    buffer_load_dwordx4 v22, s[16:19], s32 offen offset:2048 lds
    buffer_load_dwordx4 v23, s[16:19], s32 offen offset:3072 lds
    s_waitcnt vmcnt(16)
    s_barrier
    s_waitcnt vmcnt(8)
    s_barrier
    s_waitcnt vmcnt(0)
    s_barrier
    s_branch k1_kernel_end
k1_kernel_roleN:
    s_lshl_b32 s31, s33, 7
    s_mul_i32 s32, s33, 245760
    s_add_u32 m0, s29, 0
    s_add_u32 s33, s33, 1
    buffer_load_dwordx4 v16, s[12:15], s31 offen offset:0 lds
    buffer_load_dwordx4 v17, s[12:15], s31 offen offset:1024 lds
    buffer_load_dwordx4 v18, s[12:15], s31 offen offset:2048 lds
    buffer_load_dwordx4 v19, s[12:15], s31 offen offset:3072 lds
    s_add_u32 m0, s30, 0
    s_cmp_eq_u32 s33, 10
    s_cselect_b32 s33, 0, s33
    buffer_load_dwordx4 v20, s[16:19], s32 offen offset:0 lds
    buffer_load_dwordx4 v21, s[16:19], s32 offen offset:1024 lds
    buffer_load_dwordx4 v22, s[16:19], s32 offen offset:2048 lds
    buffer_load_dwordx4 v23, s[16:19], s32 offen offset:3072 lds
    s_lshl_b32 s31, s33, 7
    s_mul_i32 s32, s33, 245760
    s_add_u32 m0, s29, 16384
    s_add_u32 s33, s33, 1
    buffer_load_dwordx4 v16, s[12:15], s31 offen offset:0 lds
    buffer_load_dwordx4 v17, s[12:15], s31 offen offset:1024 lds
    buffer_load_dwordx4 v18, s[12:15], s31 offen offset:2048 lds
    buffer_load_dwordx4 v19, s[12:15], s31 offen offset:3072 lds
    s_add_u32 m0, s30, 16384
    s_cmp_eq_u32 s33, 10
    s_cselect_b32 s33, 0, s33
    buffer_load_dwordx4 v20, s[16:19], s32 offen offset:0 lds
    buffer_load_dwordx4 v21, s[16:19], s32 offen offset:1024 lds
    buffer_load_dwordx4 v22, s[16:19], s32 offen offset:2048 lds
    buffer_load_dwordx4 v23, s[16:19], s32 offen offset:3072 lds
    s_waitcnt vmcnt(8)
    s_barrier
    s_lshl_b32 s31, s33, 7
    s_mul_i32 s32, s33, 245760
    s_add_u32 m0, s29, 49152
    s_add_u32 s33, s33, 1
    buffer_load_dwordx4 v16, s[12:15], s31 offen offset:0 lds
    buffer_load_dwordx4 v17, s[12:15], s31 offen offset:1024 lds
    buffer_load_dwordx4 v18, s[12:15], s31 offen offset:2048 lds
    buffer_load_dwordx4 v19, s[12:15], s31 offen offset:3072 lds
    s_add_u32 m0, s30, 49152
    s_cmp_eq_u32 s33, 10
    s_cselect_b32 s33, 0, s33
    buffer_load_dwordx4 v20, s[16:19], s32 offen offset:0 lds
    buffer_load_dwordx4 v21, s[16:19], s32 offen offset:1024 lds
    buffer_load_dwordx4 v22, s[16:19], s32 offen offset:2048 lds
    buffer_load_dwordx4 v23, s[16:19], s32 offen offset:3072 lds
    s_lshl_b32 s31, s33, 7
    s_mul_i32 s32, s33, 245760
    s_add_u32 m0, s29, 32768
    s_add_u32 s33, s33, 1
    buffer_load_dwordx4 v16, s[12:15], s31 offen offset:0 lds
    buffer_load_dwordx4 v17, s[12:15], s31 offen offset:1024 lds
    buffer_load_dwordx4 v18, s[12:15], s31 offen offset:2048 lds
    buffer_load_dwordx4 v19, s[12:15], s31 offen offset:3072 lds
    s_add_u32 m0, s30, 32768
    s_cmp_eq_u32 s33, 10
    s_cselect_b32 s33, 0, s33
    buffer_load_dwordx4 v20, s[16:19], s32 offen offset:0 lds
    buffer_load_dwordx4 v21, s[16:19], s32 offen offset:1024 lds
    buffer_load_dwordx4 v22, s[16:19], s32 offen offset:2048 lds
    buffer_load_dwordx4 v23, s[16:19], s32 offen offset:3072 lds
    s_waitcnt vmcnt(16)
    s_barrier
    s_lshl_b32 s31, s33, 7
    s_mul_i32 s32, s33, 245760
    s_add_u32 m0, s29, 0
    s_add_u32 s33, s33, 1
    buffer_load_dwordx4 v16, s[12:15], s31 offen offset:0 lds
    buffer_load_dwordx4 v17, s[12:15], s31 offen offset:1024 lds
    buffer_load_dwordx4 v18, s[12:15], s31 offen offset:2048 lds
    buffer_load_dwordx4 v19, s[12:15], s31 offen offset:3072 lds
    s_add_u32 m0, s30, 0
    s_cmp_eq_u32 s33, 10
    s_cselect_b32 s33, 0, s33
    buffer_load_dwordx4 v20, s[16:19], s32 offen offset:0 lds
    buffer_load_dwordx4 v21, s[16:19], s32 offen offset:1024 lds
    buffer_load_dwordx4 v22, s[16:19], s32 offen offset:2048 lds
    buffer_load_dwordx4 v23, s[16:19], s32 offen offset:3072 lds
    s_waitcnt vmcnt(16)
    s_barrier
    s_lshl_b32 s31, s33, 7
    s_mul_i32 s32, s33, 245760
    s_add_u32 m0, s29, 16384
    s_add_u32 s33, s33, 1
    buffer_load_dwordx4 v16, s[12:15], s31 offen offset:0 lds
    buffer_load_dwordx4 v17, s[12:15], s31 offen offset:1024 lds
    buffer_load_dwordx4 v18, s[12:15], s31 offen offset:2048 lds
    buffer_load_dwordx4 v19, s[12:15], s31 offen offset:3072 lds
    s_add_u32 m0, s30, 16384
    s_cmp_eq_u32 s33, 10
    s_cselect_b32 s33, 0, s33
    buffer_load_dwordx4 v20, s[16:19], s32 offen offset:0 lds
    buffer_load_dwordx4 v21, s[16:19], s32 offen offset:1024 lds
    buffer_load_dwordx4 v22, s[16:19], s32 offen offset:2048 lds
    buffer_load_dwordx4 v23, s[16:19], s32 offen offset:3072 lds
    s_waitcnt vmcnt(16)
    s_barrier
    s_lshl_b32 s31, s33, 7
    s_mul_i32 s32, s33, 245760
    s_add_u32 m0, s29, 49152
    s_add_u32 s33, s33, 1
    buffer_load_dwordx4 v16, s[12:15], s31 offen offset:0 lds
    buffer_load_dwordx4 v17, s[12:15], s31 offen offset:1024 lds
    buffer_load_dwordx4 v18, s[12:15], s31 offen offset:2048 lds
    buffer_load_dwordx4 v19, s[12:15], s31 offen offset:3072 lds
    s_add_u32 m0, s30, 49152
    s_cmp_eq_u32 s33, 10
    s_cselect_b32 s33, 0, s33
    buffer_load_dwordx4 v20, s[16:19], s32 offen offset:0 lds
    buffer_load_dwordx4 v21, s[16:19], s32 offen offset:1024 lds
    buffer_load_dwordx4 v22, s[16:19], s32 offen offset:2048 lds
    buffer_load_dwordx4 v23, s[16:19], s32 offen offset:3072 lds
    s_waitcnt vmcnt(16)
    s_barrier
    s_lshl_b32 s31, s33, 7
    s_mul_i32 s32, s33, 245760
    s_add_u32 m0, s29, 32768
    s_add_u32 s33, s33, 1
    buffer_load_dwordx4 v16, s[12:15], s31 offen offset:0 lds
    buffer_load_dwordx4 v17, s[12:15], s31 offen offset:1024 lds
    buffer_load_dwordx4 v18, s[12:15], s31 offen offset:2048 lds
    buffer_load_dwordx4 v19, s[12:15], s31 offen offset:3072 lds
    s_add_u32 m0, s30, 32768
    s_cmp_eq_u32 s33, 10
    s_cselect_b32 s33, 0, s33
    buffer_load_dwordx4 v20, s[16:19], s32 offen offset:0 lds
    buffer_load_dwordx4 v21, s[16:19], s32 offen offset:1024 lds
    buffer_load_dwordx4 v22, s[16:19], s32 offen offset:2048 lds
    buffer_load_dwordx4 v23, s[16:19], s32 offen offset:3072 lds
    s_waitcnt vmcnt(16)
    s_barrier
    s_lshl_b32 s31, s33, 7
    s_mul_i32 s32, s33, 245760
    s_add_u32 m0, s29, 0
    s_add_u32 s33, s33, 1
    buffer_load_dwordx4 v16, s[12:15], s31 offen offset:0 lds
    buffer_load_dwordx4 v17, s[12:15], s31 offen offset:1024 lds
    buffer_load_dwordx4 v18, s[12:15], s31 offen offset:2048 lds
    buffer_load_dwordx4 v19, s[12:15], s31 offen offset:3072 lds
    s_add_u32 m0, s30, 0
    s_cmp_eq_u32 s33, 10
    s_cselect_b32 s33, 0, s33
    buffer_load_dwordx4 v20, s[16:19], s32 offen offset:0 lds
    buffer_load_dwordx4 v21, s[16:19], s32 offen offset:1024 lds
    buffer_load_dwordx4 v22, s[16:19], s32 offen offset:2048 lds
    buffer_load_dwordx4 v23, s[16:19], s32 offen offset:3072 lds
    s_waitcnt vmcnt(16)
    s_barrier
    s_lshl_b32 s31, s33, 7
    s_mul_i32 s32, s33, 245760
    s_add_u32 m0, s29, 16384
    s_add_u32 s33, s33, 1
    buffer_load_dwordx4 v16, s[12:15], s31 offen offset:0 lds
    buffer_load_dwordx4 v17, s[12:15], s31 offen offset:1024 lds
    buffer_load_dwordx4 v18, s[12:15], s31 offen offset:2048 lds
    buffer_load_dwordx4 v19, s[12:15], s31 offen offset:3072 lds
    s_add_u32 m0, s30, 16384
    s_cmp_eq_u32 s33, 10
    s_cselect_b32 s33, 0, s33
    buffer_load_dwordx4 v20, s[16:19], s32 offen offset:0 lds
    buffer_load_dwordx4 v21, s[16:19], s32 offen offset:1024 lds
    buffer_load_dwordx4 v22, s[16:19], s32 offen offset:2048 lds
    buffer_load_dwordx4 v23, s[16:19], s32 offen offset:3072 lds
    s_waitcnt vmcnt(16)
    s_barrier
    s_waitcnt vmcnt(8)
    s_barrier
    s_waitcnt vmcnt(0)
    s_barrier
    s_branch k1_kernel_end
k1_kernel_comp:
    s_getpc_b64 s[48:49]
k1_kernel_pc:
    s_sub_u32 s48, s48, k1_kernel_pc-k1_kernel
    s_subb_u32 s49, s49, 0
    v_lshlrev_b32 v2, 7, v1
    s_mul_i32 s34, s26, 24576
    v_add_u32 v2, s34, v2
    v_add_u32 v3, 0, v2
    v_min_u32 v3, text_end-k1_kernel-4, v3
    global_load_dword v200, v3, s[48:49]
    v_add_u32 v3, 8192, v2
    v_min_u32 v3, text_end-k1_kernel-4, v3
    global_load_dword v201, v3, s[48:49]
    v_add_u32 v3, 16384, v2
    v_min_u32 v3, text_end-k1_kernel-4, v3
    global_load_dword v202, v3, s[48:49]
    s_lshr_b32 s27, s26, 1
    s_and_b32 s28, s26, 1
    v_and_b32 v2, 31, v1
    v_lshrrev_b32 v3, 5, v1
    s_lshl_b32 s36, s27, 6
    s_lshl_b32 s38, s28, 6
    v_add_u32 v4, s36, v2
    v_lshlrev_b32 v8, 2, v4
    v_add_u32 v148, 131072, v8
    s_lshl_b32 s34, s24, 7
    v_add_u32 v9, s34, v4
    v_lshlrev_b32 v152, 3, v9
    s_lshl_b32 s34, s33, 14
    v_add_u32 v152, s34, v152
    v_lshlrev_b32 v4, 7, v4
    v_bfe_u32 v5, v2, 1, 3
    v_add_u32 v10, s38, v2
    v_lshlrev_b32 v12, 2, v10
    v_add_u32 v149, 132096, v12
    s_lshl_b32 s34, s25, 9
    s_lshl_b32 s35, s33, 13
    s_add_u32 s34, s34, s35
    s_add_u32 s34, s34, 163840
    v_add_u32 v153, s34, v12
    v_add_u32 v6, 0, v3
    v_xor_b32 v6, v6, v5
    v_lshl_add_u32 v132, v6, 4, v4
    v_add_u32 v6, 2, v3
    v_xor_b32 v6, v6, v5
    v_lshl_add_u32 v133, v6, 4, v4
    v_add_u32 v6, 4, v3
    v_xor_b32 v6, v6, v5
    v_lshl_add_u32 v134, v6, 4, v4
    v_add_u32 v6, 6, v3
    v_xor_b32 v6, v6, v5
    v_lshl_add_u32 v135, v6, 4, v4
    v_bfe_u32 v13, v1, 2, 2
    v_and_b32 v4, 3, v1
    v_bfe_u32 v5, v1, 4, 1
    v_lshl_add_u32 v6, v3, 3, v13
    v_lshlrev_b32 v6, 8, v6
    v_add_u32 v6, 65536, v6
    v_and_b32 v7, 1, v4
    v_lshl_add_u32 v6, v7, 3, v6
    v_lshrrev_b32 v7, 1, v4
    v_lshl_add_u32 v7, v5, 1, v7
    v_lshl_add_u32 v6, v7, 4, v6
    s_lshl_b32 s34, s28, 1
    s_add_u32 s35, s34, 1
    v_xor_b32 v7, s34, v13
    v_lshl_add_u32 v28, v7, 6, v6
    v_xor_b32 v7, s35, v13
    v_lshl_add_u32 v29, v7, 6, v6
    s_lshl_b32 s42, s24, 2
    s_lshl_b32 s43, s27, 1
    s_add_u32 s42, s42, s43
    s_mul_i32 s53, s42, 1280
    s_add_u32 s54, s53, 1280
    s_mov_b32 s47, 81920
    s_mov_b32 s40, 0xffff0000
    s_cmp_lt_u32 s25, 5
    s_cselect_b32 s52, 0x3ea52b5c, 1.0
    s_mov_b32 s55, 0
    s_waitcnt lgkmcnt(0)
    s_mov_b32 s20, s10
    s_mov_b32 s21, s11
    s_mov_b32 s22, 7864320
    s_mov_b32 s23, 0x00020000
    s_add_u32 s48, s10, 26533888
    s_addc_u32 s49, s11, 0
    s_mov_b32 s50, 245760
    s_mov_b32 s51, 0x00020000
    v_lshlrev_b32 v204, 17, v1
    buffer_load_dword v205, v204, s[20:23], 0 offen
    v_mov_b32 v68, 0
    v_mov_b32 v69, 0
    v_mov_b32 v70, 0
    v_mov_b32 v71, 0
    v_mov_b32 v72, 0
    v_mov_b32 v73, 0
    v_mov_b32 v74, 0
    v_mov_b32 v75, 0
    v_mov_b32 v76, 0
    v_mov_b32 v77, 0
    v_mov_b32 v78, 0
    v_mov_b32 v79, 0
    v_mov_b32 v80, 0
    v_mov_b32 v81, 0
    v_mov_b32 v82, 0
    v_mov_b32 v83, 0
    v_mov_b32 v84, 0
    v_mov_b32 v85, 0
    v_mov_b32 v86, 0
    v_mov_b32 v87, 0
    v_mov_b32 v88, 0
    v_mov_b32 v89, 0
    v_mov_b32 v90, 0
    v_mov_b32 v91, 0
    v_mov_b32 v92, 0
    v_mov_b32 v93, 0
    v_mov_b32 v94, 0
    v_mov_b32 v95, 0
    v_mov_b32 v96, 0
    v_mov_b32 v97, 0
    v_mov_b32 v98, 0
    v_mov_b32 v99, 0
    v_mov_b32 v100, 0
    v_mov_b32 v101, 0
    v_mov_b32 v102, 0
    v_mov_b32 v103, 0
    v_mov_b32 v104, 0
    v_mov_b32 v105, 0
    v_mov_b32 v106, 0
    v_mov_b32 v107, 0
    v_mov_b32 v108, 0
    v_mov_b32 v109, 0
    v_mov_b32 v110, 0
    v_mov_b32 v111, 0
    v_mov_b32 v112, 0
    v_mov_b32 v113, 0
    v_mov_b32 v114, 0
    v_mov_b32 v115, 0
    v_mov_b32 v116, 0
    v_mov_b32 v117, 0
    v_mov_b32 v118, 0
    v_mov_b32 v119, 0
    v_mov_b32 v120, 0
    v_mov_b32 v121, 0
    v_mov_b32 v122, 0
    v_mov_b32 v123, 0
    v_mov_b32 v124, 0
    v_mov_b32 v125, 0
    v_mov_b32 v126, 0
    v_mov_b32 v127, 0
    v_mov_b32 v128, 0
    v_mov_b32 v129, 0
    v_mov_b32 v130, 0
    v_mov_b32 v131, 0
    v_mov_b32 v160, 0
    v_mov_b32 v161, 0
    v_mov_b32 v162, 0
    v_mov_b32 v163, 0
    v_mov_b32 v164, 0
    v_mov_b32 v165, 0
    v_mov_b32 v166, 0
    v_mov_b32 v167, 0
    v_mov_b32 v168, 0
    v_mov_b32 v169, 0
    v_mov_b32 v170, 0
    v_mov_b32 v171, 0
    s_cmp_ge_u32 s25, 10
    s_cbranch_scc1 k1_kernel_v
    v_lshlrev_b32 v6, 4, v3
    s_lshl_b32 s34, s38, 2
    v_add_u32 v7, s34, v6
    v_add_u32 v150, 132096, v7
    s_cmp_ge_u32 s25, 5
    s_cselect_b32 s40, 1, 0
    s_mul_i32 s41, s40, 5
    s_sub_u32 s41, s25, s41
    s_mul_i32 s40, s40, 2621440
    s_add_u32 s53, s53, s40
    s_add_u32 s54, s54, s40
    s_lshl_b32 s44, s41, 5
    s_lshr_b32 s45, s38, 2
    s_add_u32 s45, s45, s44
    s_add_u32 s46, s45, 8
    v_lshlrev_b32 v9, 4, v2
    v_lshlrev_b32 v10, 3, v2
    v_add_u32 v10, 1024, v10
    s_mov_b32 s40, 0xffff0000
    v_add_u32 v11, s45, v3
    v_add_u32 v11, 0, v11
    v_mul_u32_u24 v12, 205, v11
    v_lshrrev_b32 v12, 10, v12
    v_mul_u32_u24 v13, 5, v12
    v_sub_u32 v13, v11, v13
    v_lshrrev_b32 v14, 1, v13
    v_lshl_add_u32 v14, v14, 9, v9
    v_and_b32 v15, 1, v13
    v_lshl_add_u32 v14, v15, 3, v14
    v_cmp_eq_u32 vcc, 4, v13
    s_nop 1
    v_cndmask_b32 v14, v14, v10, vcc
    v_mul_lo_u32 v12, v12, s47
    v_add_u32 v140, v14, v12
    v_add_u32 v11, s45, v3
    v_add_u32 v11, 2, v11
    v_mul_u32_u24 v12, 205, v11
    v_lshrrev_b32 v12, 10, v12
    v_mul_u32_u24 v13, 5, v12
    v_sub_u32 v13, v11, v13
    v_lshrrev_b32 v14, 1, v13
    v_lshl_add_u32 v14, v14, 9, v9
    v_and_b32 v15, 1, v13
    v_lshl_add_u32 v14, v15, 3, v14
    v_cmp_eq_u32 vcc, 4, v13
    s_nop 1
    v_cndmask_b32 v14, v14, v10, vcc
    v_mul_lo_u32 v12, v12, s47
    v_add_u32 v141, v14, v12
    v_add_u32 v11, s45, v3
    v_add_u32 v11, 4, v11
    v_mul_u32_u24 v12, 205, v11
    v_lshrrev_b32 v12, 10, v12
    v_mul_u32_u24 v13, 5, v12
    v_sub_u32 v13, v11, v13
    v_lshrrev_b32 v14, 1, v13
    v_lshl_add_u32 v14, v14, 9, v9
    v_and_b32 v15, 1, v13
    v_lshl_add_u32 v14, v15, 3, v14
    v_cmp_eq_u32 vcc, 4, v13
    s_nop 1
    v_cndmask_b32 v14, v14, v10, vcc
    v_mul_lo_u32 v12, v12, s47
    v_add_u32 v142, v14, v12
    v_add_u32 v11, s45, v3
    v_add_u32 v11, 6, v11
    v_mul_u32_u24 v12, 205, v11
    v_lshrrev_b32 v12, 10, v12
    v_mul_u32_u24 v13, 5, v12
    v_sub_u32 v13, v11, v13
    v_lshrrev_b32 v14, 1, v13
    v_lshl_add_u32 v14, v14, 9, v9
    v_and_b32 v15, 1, v13
    v_lshl_add_u32 v14, v15, 3, v14
    v_cmp_eq_u32 vcc, 4, v13
    s_nop 1
    v_cndmask_b32 v14, v14, v10, vcc
    v_mul_lo_u32 v12, v12, s47
    v_add_u32 v143, v14, v12
    v_add_u32 v11, s46, v3
    v_add_u32 v11, 0, v11
    v_mul_u32_u24 v12, 205, v11
    v_lshrrev_b32 v12, 10, v12
    v_mul_u32_u24 v13, 5, v12
    v_sub_u32 v13, v11, v13
    v_lshrrev_b32 v14, 1, v13
    v_lshl_add_u32 v14, v14, 9, v9
    v_and_b32 v15, 1, v13
    v_lshl_add_u32 v14, v15, 3, v14
    v_cmp_eq_u32 vcc, 4, v13
    s_nop 1
    v_cndmask_b32 v14, v14, v10, vcc
    v_mul_lo_u32 v12, v12, s47
    v_add_u32 v144, v14, v12
    v_add_u32 v11, s46, v3
    v_add_u32 v11, 2, v11
    v_mul_u32_u24 v12, 205, v11
    v_lshrrev_b32 v12, 10, v12
    v_mul_u32_u24 v13, 5, v12
    v_sub_u32 v13, v11, v13
    v_lshrrev_b32 v14, 1, v13
    v_lshl_add_u32 v14, v14, 9, v9
    v_and_b32 v15, 1, v13
    v_lshl_add_u32 v14, v15, 3, v14
    v_cmp_eq_u32 vcc, 4, v13
    s_nop 1
    v_cndmask_b32 v14, v14, v10, vcc
    v_mul_lo_u32 v12, v12, s47
    v_add_u32 v145, v14, v12
    v_add_u32 v11, s46, v3
    v_add_u32 v11, 4, v11
    v_mul_u32_u24 v12, 205, v11
    v_lshrrev_b32 v12, 10, v12
    v_mul_u32_u24 v13, 5, v12
    v_sub_u32 v13, v11, v13
    v_lshrrev_b32 v14, 1, v13
    v_lshl_add_u32 v14, v14, 9, v9
    v_and_b32 v15, 1, v13
    v_lshl_add_u32 v14, v15, 3, v14
    v_cmp_eq_u32 vcc, 4, v13
    s_nop 1
    v_cndmask_b32 v14, v14, v10, vcc
    v_mul_lo_u32 v12, v12, s47
    v_add_u32 v146, v14, v12
    v_add_u32 v11, s46, v3
    v_add_u32 v11, 6, v11
    v_mul_u32_u24 v12, 205, v11
    v_lshrrev_b32 v12, 10, v12
    v_mul_u32_u24 v13, 5, v12
    v_sub_u32 v13, v11, v13
    v_lshrrev_b32 v14, 1, v13
    v_lshl_add_u32 v14, v14, 9, v9
    v_and_b32 v15, 1, v13
    v_lshl_add_u32 v14, v15, 3, v14
    v_cmp_eq_u32 vcc, 4, v13
    s_nop 1
    v_cndmask_b32 v14, v14, v10, vcc
    v_mul_lo_u32 v12, v12, s47
    v_add_u32 v147, v14, v12
    s_barrier
    ds_read_b128 v[36:39], v132 offset:0
    ds_read_b64_tr_b16 v[52:53], v28 offset:0
    ds_read_b64_tr_b16 v[54:55], v28 offset:1024
    ds_read_b128 v[40:43], v132 offset:4096
    ds_read_b64_tr_b16 v[56:57], v29 offset:0
    ds_read_b64_tr_b16 v[58:59], v29 offset:1024
    s_waitcnt lgkmcnt(0)
    v_mfma_f32_32x32x16_bf16 v[68:83], v[52:55], v[36:39], v[68:83]
    ds_read_b128 v[44:47], v133 offset:0
    ds_read_b64_tr_b16 v[60:61], v28 offset:4096
    ds_read_b64_tr_b16 v[62:63], v28 offset:5120
    v_lshlrev_b32 v172, 16, v36
    v_and_b32 v173, s40, v36
    v_pk_add_f32 v[160:161], v[160:161], v[172:173]
    v_pk_fma_f32 v[162:163], v[172:173], v[172:173], v[162:163]
    v_lshlrev_b32 v174, 16, v37
    v_and_b32 v175, s40, v37
    v_pk_add_f32 v[160:161], v[160:161], v[174:175]
    v_pk_fma_f32 v[162:163], v[174:175], v[174:175], v[162:163]
    v_lshlrev_b32 v176, 16, v38
    v_and_b32 v177, s40, v38
    v_pk_add_f32 v[160:161], v[160:161], v[176:177]
    v_pk_fma_f32 v[162:163], v[176:177], v[176:177], v[162:163]
    v_lshlrev_b32 v178, 16, v39
    v_and_b32 v179, s40, v39
    v_mfma_f32_32x32x16_bf16 v[84:99], v[52:55], v[40:43], v[84:99]
    ds_read_b128 v[48:51], v133 offset:4096
    ds_read_b64_tr_b16 v[64:65], v29 offset:4096
    ds_read_b64_tr_b16 v[66:67], v29 offset:5120
    v_pk_add_f32 v[160:161], v[160:161], v[178:179]
    v_pk_fma_f32 v[162:163], v[178:179], v[178:179], v[162:163]
    v_lshlrev_b32 v172, 16, v52
    v_and_b32 v173, s40, v52
    v_pk_add_f32 v[168:169], v[168:169], v[172:173]
    v_lshlrev_b32 v174, 16, v53
    v_and_b32 v175, s40, v53
    v_pk_add_f32 v[168:169], v[168:169], v[174:175]
    v_lshlrev_b32 v176, 16, v54
    v_and_b32 v177, s40, v54
    v_pk_add_f32 v[168:169], v[168:169], v[176:177]
    v_lshlrev_b32 v178, 16, v55
    v_and_b32 v179, s40, v55
    v_pk_add_f32 v[168:169], v[168:169], v[178:179]
    v_mfma_f32_32x32x16_bf16 v[100:115], v[56:59], v[36:39], v[100:115]
    v_lshlrev_b32 v172, 16, v40
    v_and_b32 v173, s40, v40
    v_pk_add_f32 v[164:165], v[164:165], v[172:173]
    v_pk_fma_f32 v[166:167], v[172:173], v[172:173], v[166:167]
    v_lshlrev_b32 v174, 16, v41
    v_and_b32 v175, s40, v41
    v_pk_add_f32 v[164:165], v[164:165], v[174:175]
    v_pk_fma_f32 v[166:167], v[174:175], v[174:175], v[166:167]
    v_lshlrev_b32 v176, 16, v42
    v_and_b32 v177, s40, v42
    v_pk_add_f32 v[164:165], v[164:165], v[176:177]
    v_pk_fma_f32 v[166:167], v[176:177], v[176:177], v[166:167]
    v_lshlrev_b32 v178, 16, v43
    v_and_b32 v179, s40, v43
    v_mfma_f32_32x32x16_bf16 v[116:131], v[56:59], v[40:43], v[116:131]
    v_pk_add_f32 v[164:165], v[164:165], v[178:179]
    v_pk_fma_f32 v[166:167], v[178:179], v[178:179], v[166:167]
    v_lshlrev_b32 v172, 16, v56
    v_and_b32 v173, s40, v56
    v_pk_add_f32 v[170:171], v[170:171], v[172:173]
    v_lshlrev_b32 v174, 16, v57
    v_and_b32 v175, s40, v57
    v_pk_add_f32 v[170:171], v[170:171], v[174:175]
    v_lshlrev_b32 v176, 16, v58
    v_and_b32 v177, s40, v58
    v_pk_add_f32 v[170:171], v[170:171], v[176:177]
    v_lshlrev_b32 v178, 16, v59
    v_and_b32 v179, s40, v59
    v_pk_add_f32 v[170:171], v[170:171], v[178:179]
    s_waitcnt lgkmcnt(0)
    v_mfma_f32_32x32x16_bf16 v[68:83], v[60:63], v[44:47], v[68:83]
    ds_read_b128 v[36:39], v134 offset:0
    ds_read_b64_tr_b16 v[52:53], v28 offset:8192
    ds_read_b64_tr_b16 v[54:55], v28 offset:9216
    v_lshlrev_b32 v172, 16, v44
    v_and_b32 v173, s40, v44
    v_pk_add_f32 v[160:161], v[160:161], v[172:173]
    v_pk_fma_f32 v[162:163], v[172:173], v[172:173], v[162:163]
    v_lshlrev_b32 v174, 16, v45
    v_and_b32 v175, s40, v45
    v_pk_add_f32 v[160:161], v[160:161], v[174:175]
    v_pk_fma_f32 v[162:163], v[174:175], v[174:175], v[162:163]
    v_lshlrev_b32 v176, 16, v46
    v_and_b32 v177, s40, v46
    v_pk_add_f32 v[160:161], v[160:161], v[176:177]
    v_pk_fma_f32 v[162:163], v[176:177], v[176:177], v[162:163]
    v_lshlrev_b32 v178, 16, v47
    v_and_b32 v179, s40, v47
    v_mfma_f32_32x32x16_bf16 v[84:99], v[60:63], v[48:51], v[84:99]
    ds_read_b128 v[40:43], v134 offset:4096
    ds_read_b64_tr_b16 v[56:57], v29 offset:8192
    ds_read_b64_tr_b16 v[58:59], v29 offset:9216
    v_pk_add_f32 v[160:161], v[160:161], v[178:179]
    v_pk_fma_f32 v[162:163], v[178:179], v[178:179], v[162:163]
    v_lshlrev_b32 v172, 16, v60
    v_and_b32 v173, s40, v60
    v_pk_add_f32 v[168:169], v[168:169], v[172:173]
    v_lshlrev_b32 v174, 16, v61
    v_and_b32 v175, s40, v61
    v_pk_add_f32 v[168:169], v[168:169], v[174:175]
    v_lshlrev_b32 v176, 16, v62
    v_and_b32 v177, s40, v62
    v_pk_add_f32 v[168:169], v[168:169], v[176:177]
    v_lshlrev_b32 v178, 16, v63
    v_and_b32 v179, s40, v63
    v_pk_add_f32 v[168:169], v[168:169], v[178:179]
    v_mfma_f32_32x32x16_bf16 v[100:115], v[64:67], v[44:47], v[100:115]
    v_lshlrev_b32 v172, 16, v48
    v_and_b32 v173, s40, v48
    v_pk_add_f32 v[164:165], v[164:165], v[172:173]
    v_pk_fma_f32 v[166:167], v[172:173], v[172:173], v[166:167]
    v_lshlrev_b32 v174, 16, v49
    v_and_b32 v175, s40, v49
    v_pk_add_f32 v[164:165], v[164:165], v[174:175]
    v_pk_fma_f32 v[166:167], v[174:175], v[174:175], v[166:167]
    v_lshlrev_b32 v176, 16, v50
    v_and_b32 v177, s40, v50
    v_pk_add_f32 v[164:165], v[164:165], v[176:177]
    v_pk_fma_f32 v[166:167], v[176:177], v[176:177], v[166:167]
    v_lshlrev_b32 v178, 16, v51
    v_and_b32 v179, s40, v51
    v_mfma_f32_32x32x16_bf16 v[116:131], v[64:67], v[48:51], v[116:131]
    v_pk_add_f32 v[164:165], v[164:165], v[178:179]
    v_pk_fma_f32 v[166:167], v[178:179], v[178:179], v[166:167]
    v_lshlrev_b32 v172, 16, v64
    v_and_b32 v173, s40, v64
    v_pk_add_f32 v[170:171], v[170:171], v[172:173]
    v_lshlrev_b32 v174, 16, v65
    v_and_b32 v175, s40, v65
    v_pk_add_f32 v[170:171], v[170:171], v[174:175]
    v_lshlrev_b32 v176, 16, v66
    v_and_b32 v177, s40, v66
    v_pk_add_f32 v[170:171], v[170:171], v[176:177]
    v_lshlrev_b32 v178, 16, v67
    v_and_b32 v179, s40, v67
    v_pk_add_f32 v[170:171], v[170:171], v[178:179]
    s_waitcnt lgkmcnt(0)
    v_mfma_f32_32x32x16_bf16 v[68:83], v[52:55], v[36:39], v[68:83]
    ds_read_b128 v[44:47], v135 offset:0
    ds_read_b64_tr_b16 v[60:61], v28 offset:12288
    ds_read_b64_tr_b16 v[62:63], v28 offset:13312
    v_lshlrev_b32 v172, 16, v36
    v_and_b32 v173, s40, v36
    v_pk_add_f32 v[160:161], v[160:161], v[172:173]
    v_pk_fma_f32 v[162:163], v[172:173], v[172:173], v[162:163]
    v_lshlrev_b32 v174, 16, v37
    v_and_b32 v175, s40, v37
    v_pk_add_f32 v[160:161], v[160:161], v[174:175]
    v_pk_fma_f32 v[162:163], v[174:175], v[174:175], v[162:163]
    v_lshlrev_b32 v176, 16, v38
    v_and_b32 v177, s40, v38
    v_pk_add_f32 v[160:161], v[160:161], v[176:177]
    v_pk_fma_f32 v[162:163], v[176:177], v[176:177], v[162:163]
    v_lshlrev_b32 v178, 16, v39
    v_and_b32 v179, s40, v39
    v_mfma_f32_32x32x16_bf16 v[84:99], v[52:55], v[40:43], v[84:99]
    ds_read_b128 v[48:51], v135 offset:4096
    ds_read_b64_tr_b16 v[64:65], v29 offset:12288
    ds_read_b64_tr_b16 v[66:67], v29 offset:13312
    v_pk_add_f32 v[160:161], v[160:161], v[178:179]
    v_pk_fma_f32 v[162:163], v[178:179], v[178:179], v[162:163]
    v_lshlrev_b32 v172, 16, v52
    v_and_b32 v173, s40, v52
    v_pk_add_f32 v[168:169], v[168:169], v[172:173]
    v_lshlrev_b32 v174, 16, v53
    v_and_b32 v175, s40, v53
    v_pk_add_f32 v[168:169], v[168:169], v[174:175]
    v_lshlrev_b32 v176, 16, v54
    v_and_b32 v177, s40, v54
    v_pk_add_f32 v[168:169], v[168:169], v[176:177]
    v_lshlrev_b32 v178, 16, v55
    v_and_b32 v179, s40, v55
    v_pk_add_f32 v[168:169], v[168:169], v[178:179]
    v_mfma_f32_32x32x16_bf16 v[100:115], v[56:59], v[36:39], v[100:115]
    v_lshlrev_b32 v172, 16, v40
    v_and_b32 v173, s40, v40
    v_pk_add_f32 v[164:165], v[164:165], v[172:173]
    v_pk_fma_f32 v[166:167], v[172:173], v[172:173], v[166:167]
    v_lshlrev_b32 v174, 16, v41
    v_and_b32 v175, s40, v41
    v_pk_add_f32 v[164:165], v[164:165], v[174:175]
    v_pk_fma_f32 v[166:167], v[174:175], v[174:175], v[166:167]
    v_lshlrev_b32 v176, 16, v42
    v_and_b32 v177, s40, v42
    v_pk_add_f32 v[164:165], v[164:165], v[176:177]
    v_pk_fma_f32 v[166:167], v[176:177], v[176:177], v[166:167]
    v_lshlrev_b32 v178, 16, v43
    v_and_b32 v179, s40, v43
    v_mfma_f32_32x32x16_bf16 v[116:131], v[56:59], v[40:43], v[116:131]
    v_pk_add_f32 v[164:165], v[164:165], v[178:179]
    v_pk_fma_f32 v[166:167], v[178:179], v[178:179], v[166:167]
    v_lshlrev_b32 v172, 16, v56
    v_and_b32 v173, s40, v56
    v_pk_add_f32 v[170:171], v[170:171], v[172:173]
    v_lshlrev_b32 v174, 16, v57
    v_and_b32 v175, s40, v57
    v_pk_add_f32 v[170:171], v[170:171], v[174:175]
    v_lshlrev_b32 v176, 16, v58
    v_and_b32 v177, s40, v58
    v_pk_add_f32 v[170:171], v[170:171], v[176:177]
    v_lshlrev_b32 v178, 16, v59
    v_and_b32 v179, s40, v59
    v_pk_add_f32 v[170:171], v[170:171], v[178:179]
    s_waitcnt lgkmcnt(0)
    s_barrier
    v_mfma_f32_32x32x16_bf16 v[68:83], v[60:63], v[44:47], v[68:83]
    v_xor_b32 v132, 16384, v132
    v_xor_b32 v133, 16384, v133
    v_xor_b32 v134, 16384, v134
    v_xor_b32 v135, 16384, v135
    v_xor_b32 v28, 16384, v28
    v_xor_b32 v29, 16384, v29
    ds_read_b128 v[36:39], v132 offset:0
    ds_read_b64_tr_b16 v[52:53], v28 offset:0
    ds_read_b64_tr_b16 v[54:55], v28 offset:1024
    v_lshlrev_b32 v172, 16, v44
    v_and_b32 v173, s40, v44
    v_pk_add_f32 v[160:161], v[160:161], v[172:173]
    v_pk_fma_f32 v[162:163], v[172:173], v[172:173], v[162:163]
    v_lshlrev_b32 v174, 16, v45
    v_and_b32 v175, s40, v45
    v_pk_add_f32 v[160:161], v[160:161], v[174:175]
    v_pk_fma_f32 v[162:163], v[174:175], v[174:175], v[162:163]
    v_lshlrev_b32 v176, 16, v46
    v_and_b32 v177, s40, v46
    v_pk_add_f32 v[160:161], v[160:161], v[176:177]
    v_pk_fma_f32 v[162:163], v[176:177], v[176:177], v[162:163]
    v_lshlrev_b32 v178, 16, v47
    v_and_b32 v179, s40, v47
    v_mfma_f32_32x32x16_bf16 v[84:99], v[60:63], v[48:51], v[84:99]
    ds_read_b128 v[40:43], v132 offset:4096
    ds_read_b64_tr_b16 v[56:57], v29 offset:0
    ds_read_b64_tr_b16 v[58:59], v29 offset:1024
    v_pk_add_f32 v[160:161], v[160:161], v[178:179]
    v_pk_fma_f32 v[162:163], v[178:179], v[178:179], v[162:163]
    v_lshlrev_b32 v172, 16, v60
    v_and_b32 v173, s40, v60
    v_pk_add_f32 v[168:169], v[168:169], v[172:173]
    v_lshlrev_b32 v174, 16, v61
    v_and_b32 v175, s40, v61
    v_pk_add_f32 v[168:169], v[168:169], v[174:175]
    v_lshlrev_b32 v176, 16, v62
    v_and_b32 v177, s40, v62
    v_pk_add_f32 v[168:169], v[168:169], v[176:177]
    v_lshlrev_b32 v178, 16, v63
    v_and_b32 v179, s40, v63
    v_pk_add_f32 v[168:169], v[168:169], v[178:179]
    v_mfma_f32_32x32x16_bf16 v[100:115], v[64:67], v[44:47], v[100:115]
    v_lshlrev_b32 v172, 16, v48
    v_and_b32 v173, s40, v48
    v_pk_add_f32 v[164:165], v[164:165], v[172:173]
    v_pk_fma_f32 v[166:167], v[172:173], v[172:173], v[166:167]
    v_lshlrev_b32 v174, 16, v49
    v_and_b32 v175, s40, v49
    v_pk_add_f32 v[164:165], v[164:165], v[174:175]
    v_pk_fma_f32 v[166:167], v[174:175], v[174:175], v[166:167]
    v_lshlrev_b32 v176, 16, v50
    v_and_b32 v177, s40, v50
    v_pk_add_f32 v[164:165], v[164:165], v[176:177]
    v_pk_fma_f32 v[166:167], v[176:177], v[176:177], v[166:167]
    v_lshlrev_b32 v178, 16, v51
    v_and_b32 v179, s40, v51
    v_mfma_f32_32x32x16_bf16 v[116:131], v[64:67], v[48:51], v[116:131]
    v_pk_add_f32 v[164:165], v[164:165], v[178:179]
    v_pk_fma_f32 v[166:167], v[178:179], v[178:179], v[166:167]
    v_lshlrev_b32 v172, 16, v64
    v_and_b32 v173, s40, v64
    v_pk_add_f32 v[170:171], v[170:171], v[172:173]
    v_lshlrev_b32 v174, 16, v65
    v_and_b32 v175, s40, v65
    v_pk_add_f32 v[170:171], v[170:171], v[174:175]
    v_lshlrev_b32 v176, 16, v66
    v_and_b32 v177, s40, v66
    v_pk_add_f32 v[170:171], v[170:171], v[176:177]
    v_lshlrev_b32 v178, 16, v67
    v_and_b32 v179, s40, v67
    v_pk_add_f32 v[170:171], v[170:171], v[178:179]
    v_add_f32 v160, v160, v161
    v_add_f32 v161, v162, v163
    v_add_f32 v168, v168, v169
    v_add_f32 v164, v164, v165
    v_add_f32 v165, v166, v167
    v_add_f32 v170, v170, v171
    v_mov_b32 v172, v160
    v_mov_b32 v173, v161
    v_mov_b32 v174, v164
    v_mov_b32 v175, v165
    v_mov_b32 v176, v168
    v_mov_b32 v177, v170
    v_permlane32_swap_b32 v172, v160
    v_permlane32_swap_b32 v173, v161
    v_permlane32_swap_b32 v174, v164
    v_permlane32_swap_b32 v175, v165
    v_permlane32_swap_b32 v176, v168
    v_permlane32_swap_b32 v177, v170
    v_add_f32 v160, v160, v172
    v_add_f32 v161, v161, v173
    v_add_f32 v164, v164, v174
    v_add_f32 v165, v165, v175
    v_add_f32 v168, v168, v176
    v_add_f32 v170, v170, v177
    v_cmp_gt_u32 vcc, 32, v1
    s_nop 3
    s_and_saveexec_b64 s[42:43], vcc
    buffer_store_dwordx2 v[160:161], v152, s[48:51], 0 offen sc1
    buffer_store_dwordx2 v[164:165], v152, s[48:51], 0 offen offset:256 sc1
    buffer_store_dword v168, v153, s[48:51], 0 offen sc1
    buffer_store_dword v170, v153, s[48:51], 0 offen offset:128 sc1
    s_mov_b64 exec, s[42:43]
    s_waitcnt lgkmcnt(3)
    v_mfma_f32_32x32x16_bf16 v[68:83], v[52:55], v[36:39], v[68:83]
    ds_read_b128 v[44:47], v133 offset:0
    ds_read_b64_tr_b16 v[60:61], v28 offset:4096
    ds_read_b64_tr_b16 v[62:63], v28 offset:5120
    s_waitcnt lgkmcnt(5)
    v_mfma_f32_32x32x16_bf16 v[84:99], v[52:55], v[40:43], v[84:99]
    ds_read_b128 v[48:51], v133 offset:4096
    ds_read_b64_tr_b16 v[64:65], v29 offset:4096
    ds_read_b64_tr_b16 v[66:67], v29 offset:5120
    s_waitcnt lgkmcnt(6)
    v_mfma_f32_32x32x16_bf16 v[100:115], v[56:59], v[36:39], v[100:115]
    v_mfma_f32_32x32x16_bf16 v[116:131], v[56:59], v[40:43], v[116:131]
    s_waitcnt lgkmcnt(3)
    v_mfma_f32_32x32x16_bf16 v[68:83], v[60:63], v[44:47], v[68:83]
    ds_read_b128 v[36:39], v134 offset:0
    ds_read_b64_tr_b16 v[52:53], v28 offset:8192
    ds_read_b64_tr_b16 v[54:55], v28 offset:9216
    s_waitcnt lgkmcnt(5)
    v_mfma_f32_32x32x16_bf16 v[84:99], v[60:63], v[48:51], v[84:99]
    ds_read_b128 v[40:43], v134 offset:4096
    ds_read_b64_tr_b16 v[56:57], v29 offset:8192
    ds_read_b64_tr_b16 v[58:59], v29 offset:9216
    s_waitcnt lgkmcnt(6)
    v_mfma_f32_32x32x16_bf16 v[100:115], v[64:67], v[44:47], v[100:115]
    v_mfma_f32_32x32x16_bf16 v[116:131], v[64:67], v[48:51], v[116:131]
    s_waitcnt lgkmcnt(3)
    v_mfma_f32_32x32x16_bf16 v[68:83], v[52:55], v[36:39], v[68:83]
    ds_read_b128 v[44:47], v135 offset:0
    ds_read_b64_tr_b16 v[60:61], v28 offset:12288
    ds_read_b64_tr_b16 v[62:63], v28 offset:13312
    s_waitcnt lgkmcnt(5)
    v_mfma_f32_32x32x16_bf16 v[84:99], v[52:55], v[40:43], v[84:99]
    ds_read_b128 v[48:51], v135 offset:4096
    ds_read_b64_tr_b16 v[64:65], v29 offset:12288
    ds_read_b64_tr_b16 v[66:67], v29 offset:13312
    s_waitcnt lgkmcnt(6)
    v_mfma_f32_32x32x16_bf16 v[100:115], v[56:59], v[36:39], v[100:115]
    v_mfma_f32_32x32x16_bf16 v[116:131], v[56:59], v[40:43], v[116:131]
    s_waitcnt lgkmcnt(0)
    s_barrier
    v_mfma_f32_32x32x16_bf16 v[68:83], v[60:63], v[44:47], v[68:83]
    v_xor_b32 v132, 32768, v132
    v_xor_b32 v133, 32768, v133
    v_xor_b32 v134, 32768, v134
    v_xor_b32 v135, 32768, v135
    v_xor_b32 v28, 32768, v28
    v_xor_b32 v29, 32768, v29
    ds_read_b128 v[36:39], v132 offset:0
    ds_read_b64_tr_b16 v[52:53], v28 offset:0
    ds_read_b64_tr_b16 v[54:55], v28 offset:1024
    v_mfma_f32_32x32x16_bf16 v[84:99], v[60:63], v[48:51], v[84:99]
    ds_read_b128 v[40:43], v132 offset:4096
    ds_read_b64_tr_b16 v[56:57], v29 offset:0
    ds_read_b64_tr_b16 v[58:59], v29 offset:1024
    v_mfma_f32_32x32x16_bf16 v[100:115], v[64:67], v[44:47], v[100:115]
    v_mfma_f32_32x32x16_bf16 v[116:131], v[64:67], v[48:51], v[116:131]
    s_waitcnt lgkmcnt(3)
    v_mfma_f32_32x32x16_bf16 v[68:83], v[52:55], v[36:39], v[68:83]
    ds_read_b128 v[44:47], v133 offset:0
    ds_read_b64_tr_b16 v[60:61], v28 offset:4096
    ds_read_b64_tr_b16 v[62:63], v28 offset:5120
    s_waitcnt lgkmcnt(5)
    v_mfma_f32_32x32x16_bf16 v[84:99], v[52:55], v[40:43], v[84:99]
    ds_read_b128 v[48:51], v133 offset:4096
    ds_read_b64_tr_b16 v[64:65], v29 offset:4096
    ds_read_b64_tr_b16 v[66:67], v29 offset:5120
    s_waitcnt lgkmcnt(6)
    v_mfma_f32_32x32x16_bf16 v[100:115], v[56:59], v[36:39], v[100:115]
    v_mfma_f32_32x32x16_bf16 v[116:131], v[56:59], v[40:43], v[116:131]
    s_waitcnt lgkmcnt(3)
    v_mfma_f32_32x32x16_bf16 v[68:83], v[60:63], v[44:47], v[68:83]
    ds_read_b128 v[36:39], v134 offset:0
    ds_read_b64_tr_b16 v[52:53], v28 offset:8192
    ds_read_b64_tr_b16 v[54:55], v28 offset:9216
    s_waitcnt lgkmcnt(5)
    v_mfma_f32_32x32x16_bf16 v[84:99], v[60:63], v[48:51], v[84:99]
    ds_read_b128 v[40:43], v134 offset:4096
    ds_read_b64_tr_b16 v[56:57], v29 offset:8192
    ds_read_b64_tr_b16 v[58:59], v29 offset:9216
    s_waitcnt lgkmcnt(6)
    v_mfma_f32_32x32x16_bf16 v[100:115], v[64:67], v[44:47], v[100:115]
    v_mfma_f32_32x32x16_bf16 v[116:131], v[64:67], v[48:51], v[116:131]
    s_waitcnt lgkmcnt(3)
    v_mfma_f32_32x32x16_bf16 v[68:83], v[52:55], v[36:39], v[68:83]
    ds_read_b128 v[44:47], v135 offset:0
    ds_read_b64_tr_b16 v[60:61], v28 offset:12288
    ds_read_b64_tr_b16 v[62:63], v28 offset:13312
    s_waitcnt lgkmcnt(5)
    v_mfma_f32_32x32x16_bf16 v[84:99], v[52:55], v[40:43], v[84:99]
    ds_read_b128 v[48:51], v135 offset:4096
    ds_read_b64_tr_b16 v[64:65], v29 offset:12288
    ds_read_b64_tr_b16 v[66:67], v29 offset:13312
    s_waitcnt lgkmcnt(6)
    v_mfma_f32_32x32x16_bf16 v[100:115], v[56:59], v[36:39], v[100:115]
    v_mfma_f32_32x32x16_bf16 v[116:131], v[56:59], v[40:43], v[116:131]
    s_waitcnt vmcnt(0) lgkmcnt(0)
    s_barrier
    v_mfma_f32_32x32x16_bf16 v[68:83], v[60:63], v[44:47], v[68:83]
    v_xor_b32 v132, 16384, v132
    v_xor_b32 v133, 16384, v133
    v_xor_b32 v134, 16384, v134
    v_xor_b32 v135, 16384, v135
    v_xor_b32 v28, 16384, v28
    v_xor_b32 v29, 16384, v29
    ds_read_b128 v[36:39], v132 offset:0
    ds_read_b64_tr_b16 v[52:53], v28 offset:0
    ds_read_b64_tr_b16 v[54:55], v28 offset:1024
    v_mfma_f32_32x32x16_bf16 v[84:99], v[60:63], v[48:51], v[84:99]
    ds_read_b128 v[40:43], v132 offset:4096
    ds_read_b64_tr_b16 v[56:57], v29 offset:0
    ds_read_b64_tr_b16 v[58:59], v29 offset:1024
    v_mfma_f32_32x32x16_bf16 v[100:115], v[64:67], v[44:47], v[100:115]
    v_mfma_f32_32x32x16_bf16 v[116:131], v[64:67], v[48:51], v[116:131]
k1_kernel_qk_loop:
    s_waitcnt lgkmcnt(3)
    v_mfma_f32_32x32x16_bf16 v[68:83], v[52:55], v[36:39], v[68:83]
    ds_read_b128 v[44:47], v133 offset:0
    ds_read_b64_tr_b16 v[60:61], v28 offset:4096
    ds_read_b64_tr_b16 v[62:63], v28 offset:5120
    s_waitcnt lgkmcnt(5)
    v_mfma_f32_32x32x16_bf16 v[84:99], v[52:55], v[40:43], v[84:99]
    ds_read_b128 v[48:51], v133 offset:4096
    ds_read_b64_tr_b16 v[64:65], v29 offset:4096
    ds_read_b64_tr_b16 v[66:67], v29 offset:5120
    s_waitcnt lgkmcnt(6)
    v_mfma_f32_32x32x16_bf16 v[100:115], v[56:59], v[36:39], v[100:115]
    v_mfma_f32_32x32x16_bf16 v[116:131], v[56:59], v[40:43], v[116:131]
    s_waitcnt lgkmcnt(3)
    v_mfma_f32_32x32x16_bf16 v[68:83], v[60:63], v[44:47], v[68:83]
    ds_read_b128 v[36:39], v134 offset:0
    ds_read_b64_tr_b16 v[52:53], v28 offset:8192
    ds_read_b64_tr_b16 v[54:55], v28 offset:9216
    s_waitcnt lgkmcnt(5)
    v_mfma_f32_32x32x16_bf16 v[84:99], v[60:63], v[48:51], v[84:99]
    ds_read_b128 v[40:43], v134 offset:4096
    ds_read_b64_tr_b16 v[56:57], v29 offset:8192
    ds_read_b64_tr_b16 v[58:59], v29 offset:9216
    s_waitcnt lgkmcnt(6)
    v_mfma_f32_32x32x16_bf16 v[100:115], v[64:67], v[44:47], v[100:115]
    v_mfma_f32_32x32x16_bf16 v[116:131], v[64:67], v[48:51], v[116:131]
    s_waitcnt lgkmcnt(3)
    v_mfma_f32_32x32x16_bf16 v[68:83], v[52:55], v[36:39], v[68:83]
    ds_read_b128 v[44:47], v135 offset:0
    ds_read_b64_tr_b16 v[60:61], v28 offset:12288
    ds_read_b64_tr_b16 v[62:63], v28 offset:13312
    s_waitcnt lgkmcnt(5)
    v_mfma_f32_32x32x16_bf16 v[84:99], v[52:55], v[40:43], v[84:99]
    ds_read_b128 v[48:51], v135 offset:4096
    ds_read_b64_tr_b16 v[64:65], v29 offset:12288
    ds_read_b64_tr_b16 v[66:67], v29 offset:13312
    s_waitcnt lgkmcnt(6)
    v_mfma_f32_32x32x16_bf16 v[100:115], v[56:59], v[36:39], v[100:115]
    v_mfma_f32_32x32x16_bf16 v[116:131], v[56:59], v[40:43], v[116:131]
    s_waitcnt lgkmcnt(0)
    s_barrier
    v_mfma_f32_32x32x16_bf16 v[68:83], v[60:63], v[44:47], v[68:83]
    v_xor_b32 v132, 32768, v132
    v_xor_b32 v133, 32768, v133
    v_xor_b32 v134, 32768, v134
    v_xor_b32 v135, 32768, v135
    v_xor_b32 v28, 32768, v28
    v_xor_b32 v29, 32768, v29
    ds_read_b128 v[36:39], v132 offset:0
    ds_read_b64_tr_b16 v[52:53], v28 offset:0
    ds_read_b64_tr_b16 v[54:55], v28 offset:1024
    v_mfma_f32_32x32x16_bf16 v[84:99], v[60:63], v[48:51], v[84:99]
    ds_read_b128 v[40:43], v132 offset:4096
    ds_read_b64_tr_b16 v[56:57], v29 offset:0
    ds_read_b64_tr_b16 v[58:59], v29 offset:1024
    v_mfma_f32_32x32x16_bf16 v[100:115], v[64:67], v[44:47], v[100:115]
    v_mfma_f32_32x32x16_bf16 v[116:131], v[64:67], v[48:51], v[116:131]
    s_waitcnt lgkmcnt(3)
    v_mfma_f32_32x32x16_bf16 v[68:83], v[52:55], v[36:39], v[68:83]
    ds_read_b128 v[44:47], v133 offset:0
    ds_read_b64_tr_b16 v[60:61], v28 offset:4096
    ds_read_b64_tr_b16 v[62:63], v28 offset:5120
    s_waitcnt lgkmcnt(5)
    v_mfma_f32_32x32x16_bf16 v[84:99], v[52:55], v[40:43], v[84:99]
    ds_read_b128 v[48:51], v133 offset:4096
    ds_read_b64_tr_b16 v[64:65], v29 offset:4096
    ds_read_b64_tr_b16 v[66:67], v29 offset:5120
    s_waitcnt lgkmcnt(6)
    v_mfma_f32_32x32x16_bf16 v[100:115], v[56:59], v[36:39], v[100:115]
    v_mfma_f32_32x32x16_bf16 v[116:131], v[56:59], v[40:43], v[116:131]
    s_waitcnt lgkmcnt(3)
    v_mfma_f32_32x32x16_bf16 v[68:83], v[60:63], v[44:47], v[68:83]
    ds_read_b128 v[36:39], v134 offset:0
    ds_read_b64_tr_b16 v[52:53], v28 offset:8192
    ds_read_b64_tr_b16 v[54:55], v28 offset:9216
    s_waitcnt lgkmcnt(5)
    v_mfma_f32_32x32x16_bf16 v[84:99], v[60:63], v[48:51], v[84:99]
    ds_read_b128 v[40:43], v134 offset:4096
    ds_read_b64_tr_b16 v[56:57], v29 offset:8192
    ds_read_b64_tr_b16 v[58:59], v29 offset:9216
    s_waitcnt lgkmcnt(6)
    v_mfma_f32_32x32x16_bf16 v[100:115], v[64:67], v[44:47], v[100:115]
    v_mfma_f32_32x32x16_bf16 v[116:131], v[64:67], v[48:51], v[116:131]
    s_waitcnt lgkmcnt(3)
    v_mfma_f32_32x32x16_bf16 v[68:83], v[52:55], v[36:39], v[68:83]
    ds_read_b128 v[44:47], v135 offset:0
    ds_read_b64_tr_b16 v[60:61], v28 offset:12288
    ds_read_b64_tr_b16 v[62:63], v28 offset:13312
    s_waitcnt lgkmcnt(5)
    v_mfma_f32_32x32x16_bf16 v[84:99], v[52:55], v[40:43], v[84:99]
    ds_read_b128 v[48:51], v135 offset:4096
    ds_read_b64_tr_b16 v[64:65], v29 offset:12288
    ds_read_b64_tr_b16 v[66:67], v29 offset:13312
    s_waitcnt lgkmcnt(6)
    v_mfma_f32_32x32x16_bf16 v[100:115], v[56:59], v[36:39], v[100:115]
    v_mfma_f32_32x32x16_bf16 v[116:131], v[56:59], v[40:43], v[116:131]
    s_waitcnt lgkmcnt(0)
    s_barrier
    v_mfma_f32_32x32x16_bf16 v[68:83], v[60:63], v[44:47], v[68:83]
    v_xor_b32 v132, 16384, v132
    v_xor_b32 v133, 16384, v133
    v_xor_b32 v134, 16384, v134
    v_xor_b32 v135, 16384, v135
    v_xor_b32 v28, 16384, v28
    v_xor_b32 v29, 16384, v29
    ds_read_b128 v[36:39], v132 offset:0
    ds_read_b64_tr_b16 v[52:53], v28 offset:0
    ds_read_b64_tr_b16 v[54:55], v28 offset:1024
    v_mfma_f32_32x32x16_bf16 v[84:99], v[60:63], v[48:51], v[84:99]
    ds_read_b128 v[40:43], v132 offset:4096
    ds_read_b64_tr_b16 v[56:57], v29 offset:0
    ds_read_b64_tr_b16 v[58:59], v29 offset:1024
    v_mfma_f32_32x32x16_bf16 v[100:115], v[64:67], v[44:47], v[100:115]
    v_mfma_f32_32x32x16_bf16 v[116:131], v[64:67], v[48:51], v[116:131]
    s_add_u32 s55, s55, 1
    s_cmp_lt_u32 s55, 3
    s_cbranch_scc1 k1_kernel_qk_loop
    s_waitcnt lgkmcnt(3)
    v_mfma_f32_32x32x16_bf16 v[68:83], v[52:55], v[36:39], v[68:83]
    ds_read_b128 v[44:47], v133 offset:0
    ds_read_b64_tr_b16 v[60:61], v28 offset:4096
    ds_read_b64_tr_b16 v[62:63], v28 offset:5120
    s_waitcnt lgkmcnt(5)
    v_mfma_f32_32x32x16_bf16 v[84:99], v[52:55], v[40:43], v[84:99]
    ds_read_b128 v[48:51], v133 offset:4096
    ds_read_b64_tr_b16 v[64:65], v29 offset:4096
    ds_read_b64_tr_b16 v[66:67], v29 offset:5120
    s_waitcnt lgkmcnt(6)
    v_mfma_f32_32x32x16_bf16 v[100:115], v[56:59], v[36:39], v[100:115]
    v_mfma_f32_32x32x16_bf16 v[116:131], v[56:59], v[40:43], v[116:131]
    s_waitcnt lgkmcnt(3)
    v_mfma_f32_32x32x16_bf16 v[68:83], v[60:63], v[44:47], v[68:83]
    ds_read_b128 v[36:39], v134 offset:0
    ds_read_b64_tr_b16 v[52:53], v28 offset:8192
    ds_read_b64_tr_b16 v[54:55], v28 offset:9216
    s_waitcnt lgkmcnt(5)
    v_mfma_f32_32x32x16_bf16 v[84:99], v[60:63], v[48:51], v[84:99]
    ds_read_b128 v[40:43], v134 offset:4096
    ds_read_b64_tr_b16 v[56:57], v29 offset:8192
    ds_read_b64_tr_b16 v[58:59], v29 offset:9216
    s_waitcnt lgkmcnt(6)
    v_mfma_f32_32x32x16_bf16 v[100:115], v[64:67], v[44:47], v[100:115]
    v_mfma_f32_32x32x16_bf16 v[116:131], v[64:67], v[48:51], v[116:131]
    s_waitcnt lgkmcnt(3)
    v_mfma_f32_32x32x16_bf16 v[68:83], v[52:55], v[36:39], v[68:83]
    ds_read_b128 v[44:47], v135 offset:0
    ds_read_b64_tr_b16 v[60:61], v28 offset:12288
    ds_read_b64_tr_b16 v[62:63], v28 offset:13312
    s_waitcnt lgkmcnt(5)
    v_mfma_f32_32x32x16_bf16 v[84:99], v[52:55], v[40:43], v[84:99]
    ds_read_b128 v[48:51], v135 offset:4096
    ds_read_b64_tr_b16 v[64:65], v29 offset:12288
    ds_read_b64_tr_b16 v[66:67], v29 offset:13312
    s_waitcnt lgkmcnt(6)
    v_mfma_f32_32x32x16_bf16 v[100:115], v[56:59], v[36:39], v[100:115]
    v_mfma_f32_32x32x16_bf16 v[116:131], v[56:59], v[40:43], v[116:131]
    s_waitcnt lgkmcnt(0)
    s_barrier
    v_mfma_f32_32x32x16_bf16 v[68:83], v[60:63], v[44:47], v[68:83]
    v_xor_b32 v132, 32768, v132
    v_xor_b32 v133, 32768, v133
    v_xor_b32 v134, 32768, v134
    v_xor_b32 v135, 32768, v135
    v_xor_b32 v28, 32768, v28
    v_xor_b32 v29, 32768, v29
    ds_read_b128 v[36:39], v132 offset:0
    ds_read_b64_tr_b16 v[52:53], v28 offset:0
    ds_read_b64_tr_b16 v[54:55], v28 offset:1024
    v_mfma_f32_32x32x16_bf16 v[84:99], v[60:63], v[48:51], v[84:99]
    ds_read_b128 v[40:43], v132 offset:4096
    ds_read_b64_tr_b16 v[56:57], v29 offset:0
    ds_read_b64_tr_b16 v[58:59], v29 offset:1024
    v_mfma_f32_32x32x16_bf16 v[100:115], v[64:67], v[44:47], v[100:115]
    v_mfma_f32_32x32x16_bf16 v[116:131], v[64:67], v[48:51], v[116:131]
    s_waitcnt lgkmcnt(0)
    ds_read_b32 v36, v148
    ds_read_b32 v40, v148 offset:512
    ds_read_b32 v38, v148 offset:128
    ds_read_b32 v42, v148 offset:640
    ds_read_b128 v[160:163], v150 offset:0
    ds_read_b128 v[164:167], v150 offset:32
    ds_read_b128 v[168:171], v150 offset:64
    ds_read_b128 v[172:175], v150 offset:96
    ds_read_b128 v[176:179], v150 offset:128
    ds_read_b128 v[180:183], v150 offset:160
    ds_read_b128 v[184:187], v150 offset:192
    ds_read_b128 v[188:191], v150 offset:224
    s_waitcnt lgkmcnt(8)
    v_mul_f32 v36, s52, v36
    v_mul_f32 v40, s52, v40
    v_mul_f32 v38, s52, v38
    v_mul_f32 v42, s52, v42
    s_waitcnt lgkmcnt(0)
    v_pk_mul_f32 v[68:69], v[68:69], v[36:37] op_sel_hi:[1,0]
    v_pk_fma_f32 v[68:69], v[40:41], v[160:161], v[68:69] op_sel_hi:[0,1,1] neg_lo:[1,0,0] neg_hi:[1,0,0]
    v_pk_mul_f32 v[70:71], v[70:71], v[36:37] op_sel_hi:[1,0]
    v_pk_fma_f32 v[70:71], v[40:41], v[162:163], v[70:71] op_sel_hi:[0,1,1] neg_lo:[1,0,0] neg_hi:[1,0,0]
    v_cvt_pk_bf16_f32 v68, v68, v69
    v_cvt_pk_bf16_f32 v69, v70, v71
    buffer_store_dwordx2 v[68:69], v140, s[20:23], s53 offen
    v_pk_mul_f32 v[84:85], v[84:85], v[38:39] op_sel_hi:[1,0]
    v_pk_fma_f32 v[84:85], v[42:43], v[160:161], v[84:85] op_sel_hi:[0,1,1] neg_lo:[1,0,0] neg_hi:[1,0,0]
    v_pk_mul_f32 v[86:87], v[86:87], v[38:39] op_sel_hi:[1,0]
    v_pk_fma_f32 v[86:87], v[42:43], v[162:163], v[86:87] op_sel_hi:[0,1,1] neg_lo:[1,0,0] neg_hi:[1,0,0]
    v_cvt_pk_bf16_f32 v84, v84, v85
    v_cvt_pk_bf16_f32 v85, v86, v87
    buffer_store_dwordx2 v[84:85], v140, s[20:23], s54 offen
    v_pk_mul_f32 v[72:73], v[72:73], v[36:37] op_sel_hi:[1,0]
    v_pk_fma_f32 v[72:73], v[40:41], v[164:165], v[72:73] op_sel_hi:[0,1,1] neg_lo:[1,0,0] neg_hi:[1,0,0]
    v_pk_mul_f32 v[74:75], v[74:75], v[36:37] op_sel_hi:[1,0]
    v_pk_fma_f32 v[74:75], v[40:41], v[166:167], v[74:75] op_sel_hi:[0,1,1] neg_lo:[1,0,0] neg_hi:[1,0,0]
    v_cvt_pk_bf16_f32 v72, v72, v73
    v_cvt_pk_bf16_f32 v73, v74, v75
    buffer_store_dwordx2 v[72:73], v141, s[20:23], s53 offen
    v_pk_mul_f32 v[88:89], v[88:89], v[38:39] op_sel_hi:[1,0]
    v_pk_fma_f32 v[88:89], v[42:43], v[164:165], v[88:89] op_sel_hi:[0,1,1] neg_lo:[1,0,0] neg_hi:[1,0,0]
    v_pk_mul_f32 v[90:91], v[90:91], v[38:39] op_sel_hi:[1,0]
    v_pk_fma_f32 v[90:91], v[42:43], v[166:167], v[90:91] op_sel_hi:[0,1,1] neg_lo:[1,0,0] neg_hi:[1,0,0]
    v_cvt_pk_bf16_f32 v88, v88, v89
    v_cvt_pk_bf16_f32 v89, v90, v91
    buffer_store_dwordx2 v[88:89], v141, s[20:23], s54 offen
    v_pk_mul_f32 v[76:77], v[76:77], v[36:37] op_sel_hi:[1,0]
    v_pk_fma_f32 v[76:77], v[40:41], v[168:169], v[76:77] op_sel_hi:[0,1,1] neg_lo:[1,0,0] neg_hi:[1,0,0]
    v_pk_mul_f32 v[78:79], v[78:79], v[36:37] op_sel_hi:[1,0]
    v_pk_fma_f32 v[78:79], v[40:41], v[170:171], v[78:79] op_sel_hi:[0,1,1] neg_lo:[1,0,0] neg_hi:[1,0,0]
    v_cvt_pk_bf16_f32 v76, v76, v77
    v_cvt_pk_bf16_f32 v77, v78, v79
    buffer_store_dwordx2 v[76:77], v142, s[20:23], s53 offen
    v_pk_mul_f32 v[92:93], v[92:93], v[38:39] op_sel_hi:[1,0]
    v_pk_fma_f32 v[92:93], v[42:43], v[168:169], v[92:93] op_sel_hi:[0,1,1] neg_lo:[1,0,0] neg_hi:[1,0,0]
    v_pk_mul_f32 v[94:95], v[94:95], v[38:39] op_sel_hi:[1,0]
    v_pk_fma_f32 v[94:95], v[42:43], v[170:171], v[94:95] op_sel_hi:[0,1,1] neg_lo:[1,0,0] neg_hi:[1,0,0]
    v_cvt_pk_bf16_f32 v92, v92, v93
    v_cvt_pk_bf16_f32 v93, v94, v95
    buffer_store_dwordx2 v[92:93], v142, s[20:23], s54 offen
    v_pk_mul_f32 v[80:81], v[80:81], v[36:37] op_sel_hi:[1,0]
    v_pk_fma_f32 v[80:81], v[40:41], v[172:173], v[80:81] op_sel_hi:[0,1,1] neg_lo:[1,0,0] neg_hi:[1,0,0]
    v_pk_mul_f32 v[82:83], v[82:83], v[36:37] op_sel_hi:[1,0]
    v_pk_fma_f32 v[82:83], v[40:41], v[174:175], v[82:83] op_sel_hi:[0,1,1] neg_lo:[1,0,0] neg_hi:[1,0,0]
    v_cvt_pk_bf16_f32 v80, v80, v81
    v_cvt_pk_bf16_f32 v81, v82, v83
    buffer_store_dwordx2 v[80:81], v143, s[20:23], s53 offen
    v_pk_mul_f32 v[96:97], v[96:97], v[38:39] op_sel_hi:[1,0]
    v_pk_fma_f32 v[96:97], v[42:43], v[172:173], v[96:97] op_sel_hi:[0,1,1] neg_lo:[1,0,0] neg_hi:[1,0,0]
    v_pk_mul_f32 v[98:99], v[98:99], v[38:39] op_sel_hi:[1,0]
    v_pk_fma_f32 v[98:99], v[42:43], v[174:175], v[98:99] op_sel_hi:[0,1,1] neg_lo:[1,0,0] neg_hi:[1,0,0]
    v_cvt_pk_bf16_f32 v96, v96, v97
    v_cvt_pk_bf16_f32 v97, v98, v99
    buffer_store_dwordx2 v[96:97], v143, s[20:23], s54 offen
    v_pk_mul_f32 v[100:101], v[100:101], v[36:37] op_sel_hi:[1,0]
    v_pk_fma_f32 v[100:101], v[40:41], v[176:177], v[100:101] op_sel_hi:[0,1,1] neg_lo:[1,0,0] neg_hi:[1,0,0]
    v_pk_mul_f32 v[102:103], v[102:103], v[36:37] op_sel_hi:[1,0]
    v_pk_fma_f32 v[102:103], v[40:41], v[178:179], v[102:103] op_sel_hi:[0,1,1] neg_lo:[1,0,0] neg_hi:[1,0,0]
    v_cvt_pk_bf16_f32 v100, v100, v101
    v_cvt_pk_bf16_f32 v101, v102, v103
    buffer_store_dwordx2 v[100:101], v144, s[20:23], s53 offen
    v_pk_mul_f32 v[116:117], v[116:117], v[38:39] op_sel_hi:[1,0]
    v_pk_fma_f32 v[116:117], v[42:43], v[176:177], v[116:117] op_sel_hi:[0,1,1] neg_lo:[1,0,0] neg_hi:[1,0,0]
    v_pk_mul_f32 v[118:119], v[118:119], v[38:39] op_sel_hi:[1,0]
    v_pk_fma_f32 v[118:119], v[42:43], v[178:179], v[118:119] op_sel_hi:[0,1,1] neg_lo:[1,0,0] neg_hi:[1,0,0]
    v_cvt_pk_bf16_f32 v116, v116, v117
    v_cvt_pk_bf16_f32 v117, v118, v119
    buffer_store_dwordx2 v[116:117], v144, s[20:23], s54 offen
    v_pk_mul_f32 v[104:105], v[104:105], v[36:37] op_sel_hi:[1,0]
    v_pk_fma_f32 v[104:105], v[40:41], v[180:181], v[104:105] op_sel_hi:[0,1,1] neg_lo:[1,0,0] neg_hi:[1,0,0]
    v_pk_mul_f32 v[106:107], v[106:107], v[36:37] op_sel_hi:[1,0]
    v_pk_fma_f32 v[106:107], v[40:41], v[182:183], v[106:107] op_sel_hi:[0,1,1] neg_lo:[1,0,0] neg_hi:[1,0,0]
    v_cvt_pk_bf16_f32 v104, v104, v105
    v_cvt_pk_bf16_f32 v105, v106, v107
    buffer_store_dwordx2 v[104:105], v145, s[20:23], s53 offen
    v_pk_mul_f32 v[120:121], v[120:121], v[38:39] op_sel_hi:[1,0]
    v_pk_fma_f32 v[120:121], v[42:43], v[180:181], v[120:121] op_sel_hi:[0,1,1] neg_lo:[1,0,0] neg_hi:[1,0,0]
    v_pk_mul_f32 v[122:123], v[122:123], v[38:39] op_sel_hi:[1,0]
    v_pk_fma_f32 v[122:123], v[42:43], v[182:183], v[122:123] op_sel_hi:[0,1,1] neg_lo:[1,0,0] neg_hi:[1,0,0]
    v_cvt_pk_bf16_f32 v120, v120, v121
    v_cvt_pk_bf16_f32 v121, v122, v123
    buffer_store_dwordx2 v[120:121], v145, s[20:23], s54 offen
    v_pk_mul_f32 v[108:109], v[108:109], v[36:37] op_sel_hi:[1,0]
    v_pk_fma_f32 v[108:109], v[40:41], v[184:185], v[108:109] op_sel_hi:[0,1,1] neg_lo:[1,0,0] neg_hi:[1,0,0]
    v_pk_mul_f32 v[110:111], v[110:111], v[36:37] op_sel_hi:[1,0]
    v_pk_fma_f32 v[110:111], v[40:41], v[186:187], v[110:111] op_sel_hi:[0,1,1] neg_lo:[1,0,0] neg_hi:[1,0,0]
    v_cvt_pk_bf16_f32 v108, v108, v109
    v_cvt_pk_bf16_f32 v109, v110, v111
    buffer_store_dwordx2 v[108:109], v146, s[20:23], s53 offen
    v_pk_mul_f32 v[124:125], v[124:125], v[38:39] op_sel_hi:[1,0]
    v_pk_fma_f32 v[124:125], v[42:43], v[184:185], v[124:125] op_sel_hi:[0,1,1] neg_lo:[1,0,0] neg_hi:[1,0,0]
    v_pk_mul_f32 v[126:127], v[126:127], v[38:39] op_sel_hi:[1,0]
    v_pk_fma_f32 v[126:127], v[42:43], v[186:187], v[126:127] op_sel_hi:[0,1,1] neg_lo:[1,0,0] neg_hi:[1,0,0]
    v_cvt_pk_bf16_f32 v124, v124, v125
    v_cvt_pk_bf16_f32 v125, v126, v127
    buffer_store_dwordx2 v[124:125], v146, s[20:23], s54 offen
    v_pk_mul_f32 v[112:113], v[112:113], v[36:37] op_sel_hi:[1,0]
    v_pk_fma_f32 v[112:113], v[40:41], v[188:189], v[112:113] op_sel_hi:[0,1,1] neg_lo:[1,0,0] neg_hi:[1,0,0]
    v_pk_mul_f32 v[114:115], v[114:115], v[36:37] op_sel_hi:[1,0]
    v_pk_fma_f32 v[114:115], v[40:41], v[190:191], v[114:115] op_sel_hi:[0,1,1] neg_lo:[1,0,0] neg_hi:[1,0,0]
    v_cvt_pk_bf16_f32 v112, v112, v113
    v_cvt_pk_bf16_f32 v113, v114, v115
    buffer_store_dwordx2 v[112:113], v147, s[20:23], s53 offen
    v_pk_mul_f32 v[128:129], v[128:129], v[38:39] op_sel_hi:[1,0]
    v_pk_fma_f32 v[128:129], v[42:43], v[188:189], v[128:129] op_sel_hi:[0,1,1] neg_lo:[1,0,0] neg_hi:[1,0,0]
    v_pk_mul_f32 v[130:131], v[130:131], v[38:39] op_sel_hi:[1,0]
    v_pk_fma_f32 v[130:131], v[42:43], v[190:191], v[130:131] op_sel_hi:[0,1,1] neg_lo:[1,0,0] neg_hi:[1,0,0]
    v_cvt_pk_bf16_f32 v128, v128, v129
    v_cvt_pk_bf16_f32 v129, v130, v131
    buffer_store_dwordx2 v[128:129], v147, s[20:23], s54 offen
    s_branch k1_kernel_fin
k1_kernel_v:
    s_lshl_b32 s36, s36, 2
    v_lshlrev_b32 v8, 4, v3
    v_add_u32 v9, s36, v8
    v_add_u32 v150, 131072, v9
    s_sub_u32 s41, s25, 10
    s_lshl_b32 s41, s41, 7
    s_add_u32 s53, s53, 5242880
    s_add_u32 s54, s54, 5242880
    v_mul_u32_u24 v8, 320, v3
    v_add_u32 v12, s41, v10
    v_add_u32 v12, 0, v12
    v_mul_u32_u24 v13, 3277, v12
    v_lshrrev_b32 v13, 16, v13
    v_mul_u32_u24 v14, 20, v13
    v_sub_u32 v14, v12, v14
    v_mul_lo_u32 v13, v13, s47
    v_lshl_add_u32 v14, v14, 4, v8
    v_add_u32 v140, v14, v13
    v_add_u32 v12, s41, v10
    v_add_u32 v12, 32, v12
    v_mul_u32_u24 v13, 3277, v12
    v_lshrrev_b32 v13, 16, v13
    v_mul_u32_u24 v14, 20, v13
    v_sub_u32 v14, v12, v14
    v_mul_lo_u32 v13, v13, s47
    v_lshl_add_u32 v14, v14, 4, v8
    v_add_u32 v141, v14, v13
    s_barrier
    ds_read_b128 v[36:39], v132 offset:0
    ds_read_b64_tr_b16 v[52:53], v28 offset:0
    ds_read_b64_tr_b16 v[54:55], v28 offset:1024
    ds_read_b128 v[40:43], v132 offset:4096
    ds_read_b64_tr_b16 v[56:57], v29 offset:0
    ds_read_b64_tr_b16 v[58:59], v29 offset:1024
    s_waitcnt lgkmcnt(0)
    v_mfma_f32_32x32x16_bf16 v[68:83], v[36:39], v[52:55], v[68:83]
    ds_read_b128 v[44:47], v133 offset:0
    ds_read_b64_tr_b16 v[60:61], v28 offset:4096
    ds_read_b64_tr_b16 v[62:63], v28 offset:5120
    v_lshlrev_b32 v172, 16, v36
    v_and_b32 v173, s40, v36
    v_pk_add_f32 v[160:161], v[160:161], v[172:173]
    v_pk_fma_f32 v[162:163], v[172:173], v[172:173], v[162:163]
    v_lshlrev_b32 v174, 16, v37
    v_and_b32 v175, s40, v37
    v_pk_add_f32 v[160:161], v[160:161], v[174:175]
    v_pk_fma_f32 v[162:163], v[174:175], v[174:175], v[162:163]
    v_lshlrev_b32 v176, 16, v38
    v_and_b32 v177, s40, v38
    v_pk_add_f32 v[160:161], v[160:161], v[176:177]
    v_pk_fma_f32 v[162:163], v[176:177], v[176:177], v[162:163]
    v_lshlrev_b32 v178, 16, v39
    v_and_b32 v179, s40, v39
    v_mfma_f32_32x32x16_bf16 v[100:115], v[40:43], v[52:55], v[100:115]
    ds_read_b128 v[48:51], v133 offset:4096
    ds_read_b64_tr_b16 v[64:65], v29 offset:4096
    ds_read_b64_tr_b16 v[66:67], v29 offset:5120
    v_pk_add_f32 v[160:161], v[160:161], v[178:179]
    v_pk_fma_f32 v[162:163], v[178:179], v[178:179], v[162:163]
    v_lshlrev_b32 v172, 16, v52
    v_and_b32 v173, s40, v52
    v_pk_add_f32 v[168:169], v[168:169], v[172:173]
    v_lshlrev_b32 v174, 16, v53
    v_and_b32 v175, s40, v53
    v_pk_add_f32 v[168:169], v[168:169], v[174:175]
    v_lshlrev_b32 v176, 16, v54
    v_and_b32 v177, s40, v54
    v_pk_add_f32 v[168:169], v[168:169], v[176:177]
    v_lshlrev_b32 v178, 16, v55
    v_and_b32 v179, s40, v55
    v_pk_add_f32 v[168:169], v[168:169], v[178:179]
    v_mfma_f32_32x32x16_bf16 v[84:99], v[36:39], v[56:59], v[84:99]
    v_lshlrev_b32 v172, 16, v40
    v_and_b32 v173, s40, v40
    v_pk_add_f32 v[164:165], v[164:165], v[172:173]
    v_pk_fma_f32 v[166:167], v[172:173], v[172:173], v[166:167]
    v_lshlrev_b32 v174, 16, v41
    v_and_b32 v175, s40, v41
    v_pk_add_f32 v[164:165], v[164:165], v[174:175]
    v_pk_fma_f32 v[166:167], v[174:175], v[174:175], v[166:167]
    v_lshlrev_b32 v176, 16, v42
    v_and_b32 v177, s40, v42
    v_pk_add_f32 v[164:165], v[164:165], v[176:177]
    v_pk_fma_f32 v[166:167], v[176:177], v[176:177], v[166:167]
    v_lshlrev_b32 v178, 16, v43
    v_and_b32 v179, s40, v43
    v_mfma_f32_32x32x16_bf16 v[116:131], v[40:43], v[56:59], v[116:131]
    v_pk_add_f32 v[164:165], v[164:165], v[178:179]
    v_pk_fma_f32 v[166:167], v[178:179], v[178:179], v[166:167]
    v_lshlrev_b32 v172, 16, v56
    v_and_b32 v173, s40, v56
    v_pk_add_f32 v[170:171], v[170:171], v[172:173]
    v_lshlrev_b32 v174, 16, v57
    v_and_b32 v175, s40, v57
    v_pk_add_f32 v[170:171], v[170:171], v[174:175]
    v_lshlrev_b32 v176, 16, v58
    v_and_b32 v177, s40, v58
    v_pk_add_f32 v[170:171], v[170:171], v[176:177]
    v_lshlrev_b32 v178, 16, v59
    v_and_b32 v179, s40, v59
    v_pk_add_f32 v[170:171], v[170:171], v[178:179]
    s_waitcnt lgkmcnt(0)
    v_mfma_f32_32x32x16_bf16 v[68:83], v[44:47], v[60:63], v[68:83]
    ds_read_b128 v[36:39], v134 offset:0
    ds_read_b64_tr_b16 v[52:53], v28 offset:8192
    ds_read_b64_tr_b16 v[54:55], v28 offset:9216
    v_lshlrev_b32 v172, 16, v44
    v_and_b32 v173, s40, v44
    v_pk_add_f32 v[160:161], v[160:161], v[172:173]
    v_pk_fma_f32 v[162:163], v[172:173], v[172:173], v[162:163]
    v_lshlrev_b32 v174, 16, v45
    v_and_b32 v175, s40, v45
    v_pk_add_f32 v[160:161], v[160:161], v[174:175]
    v_pk_fma_f32 v[162:163], v[174:175], v[174:175], v[162:163]
    v_lshlrev_b32 v176, 16, v46
    v_and_b32 v177, s40, v46
    v_pk_add_f32 v[160:161], v[160:161], v[176:177]
    v_pk_fma_f32 v[162:163], v[176:177], v[176:177], v[162:163]
    v_lshlrev_b32 v178, 16, v47
    v_and_b32 v179, s40, v47
    v_mfma_f32_32x32x16_bf16 v[100:115], v[48:51], v[60:63], v[100:115]
    ds_read_b128 v[40:43], v134 offset:4096
    ds_read_b64_tr_b16 v[56:57], v29 offset:8192
    ds_read_b64_tr_b16 v[58:59], v29 offset:9216
    v_pk_add_f32 v[160:161], v[160:161], v[178:179]
    v_pk_fma_f32 v[162:163], v[178:179], v[178:179], v[162:163]
    v_lshlrev_b32 v172, 16, v60
    v_and_b32 v173, s40, v60
    v_pk_add_f32 v[168:169], v[168:169], v[172:173]
    v_lshlrev_b32 v174, 16, v61
    v_and_b32 v175, s40, v61
    v_pk_add_f32 v[168:169], v[168:169], v[174:175]
    v_lshlrev_b32 v176, 16, v62
    v_and_b32 v177, s40, v62
    v_pk_add_f32 v[168:169], v[168:169], v[176:177]
    v_lshlrev_b32 v178, 16, v63
    v_and_b32 v179, s40, v63
    v_pk_add_f32 v[168:169], v[168:169], v[178:179]
    v_mfma_f32_32x32x16_bf16 v[84:99], v[44:47], v[64:67], v[84:99]
    v_lshlrev_b32 v172, 16, v48
    v_and_b32 v173, s40, v48
    v_pk_add_f32 v[164:165], v[164:165], v[172:173]
    v_pk_fma_f32 v[166:167], v[172:173], v[172:173], v[166:167]
    v_lshlrev_b32 v174, 16, v49
    v_and_b32 v175, s40, v49
    v_pk_add_f32 v[164:165], v[164:165], v[174:175]
    v_pk_fma_f32 v[166:167], v[174:175], v[174:175], v[166:167]
    v_lshlrev_b32 v176, 16, v50
    v_and_b32 v177, s40, v50
    v_pk_add_f32 v[164:165], v[164:165], v[176:177]
    v_pk_fma_f32 v[166:167], v[176:177], v[176:177], v[166:167]
    v_lshlrev_b32 v178, 16, v51
    v_and_b32 v179, s40, v51
    v_mfma_f32_32x32x16_bf16 v[116:131], v[48:51], v[64:67], v[116:131]
    v_pk_add_f32 v[164:165], v[164:165], v[178:179]
    v_pk_fma_f32 v[166:167], v[178:179], v[178:179], v[166:167]
    v_lshlrev_b32 v172, 16, v64
    v_and_b32 v173, s40, v64
    v_pk_add_f32 v[170:171], v[170:171], v[172:173]
    v_lshlrev_b32 v174, 16, v65
    v_and_b32 v175, s40, v65
    v_pk_add_f32 v[170:171], v[170:171], v[174:175]
    v_lshlrev_b32 v176, 16, v66
    v_and_b32 v177, s40, v66
    v_pk_add_f32 v[170:171], v[170:171], v[176:177]
    v_lshlrev_b32 v178, 16, v67
    v_and_b32 v179, s40, v67
    v_pk_add_f32 v[170:171], v[170:171], v[178:179]
    s_waitcnt lgkmcnt(0)
    v_mfma_f32_32x32x16_bf16 v[68:83], v[36:39], v[52:55], v[68:83]
    ds_read_b128 v[44:47], v135 offset:0
    ds_read_b64_tr_b16 v[60:61], v28 offset:12288
    ds_read_b64_tr_b16 v[62:63], v28 offset:13312
    v_lshlrev_b32 v172, 16, v36
    v_and_b32 v173, s40, v36
    v_pk_add_f32 v[160:161], v[160:161], v[172:173]
    v_pk_fma_f32 v[162:163], v[172:173], v[172:173], v[162:163]
    v_lshlrev_b32 v174, 16, v37
    v_and_b32 v175, s40, v37
    v_pk_add_f32 v[160:161], v[160:161], v[174:175]
    v_pk_fma_f32 v[162:163], v[174:175], v[174:175], v[162:163]
    v_lshlrev_b32 v176, 16, v38
    v_and_b32 v177, s40, v38
    v_pk_add_f32 v[160:161], v[160:161], v[176:177]
    v_pk_fma_f32 v[162:163], v[176:177], v[176:177], v[162:163]
    v_lshlrev_b32 v178, 16, v39
    v_and_b32 v179, s40, v39
    v_mfma_f32_32x32x16_bf16 v[100:115], v[40:43], v[52:55], v[100:115]
    ds_read_b128 v[48:51], v135 offset:4096
    ds_read_b64_tr_b16 v[64:65], v29 offset:12288
    ds_read_b64_tr_b16 v[66:67], v29 offset:13312
    v_pk_add_f32 v[160:161], v[160:161], v[178:179]
    v_pk_fma_f32 v[162:163], v[178:179], v[178:179], v[162:163]
    v_lshlrev_b32 v172, 16, v52
    v_and_b32 v173, s40, v52
    v_pk_add_f32 v[168:169], v[168:169], v[172:173]
    v_lshlrev_b32 v174, 16, v53
    v_and_b32 v175, s40, v53
    v_pk_add_f32 v[168:169], v[168:169], v[174:175]
    v_lshlrev_b32 v176, 16, v54
    v_and_b32 v177, s40, v54
    v_pk_add_f32 v[168:169], v[168:169], v[176:177]
    v_lshlrev_b32 v178, 16, v55
    v_and_b32 v179, s40, v55
    v_pk_add_f32 v[168:169], v[168:169], v[178:179]
    v_mfma_f32_32x32x16_bf16 v[84:99], v[36:39], v[56:59], v[84:99]
    v_lshlrev_b32 v172, 16, v40
    v_and_b32 v173, s40, v40
    v_pk_add_f32 v[164:165], v[164:165], v[172:173]
    v_pk_fma_f32 v[166:167], v[172:173], v[172:173], v[166:167]
    v_lshlrev_b32 v174, 16, v41
    v_and_b32 v175, s40, v41
    v_pk_add_f32 v[164:165], v[164:165], v[174:175]
    v_pk_fma_f32 v[166:167], v[174:175], v[174:175], v[166:167]
    v_lshlrev_b32 v176, 16, v42
    v_and_b32 v177, s40, v42
    v_pk_add_f32 v[164:165], v[164:165], v[176:177]
    v_pk_fma_f32 v[166:167], v[176:177], v[176:177], v[166:167]
    v_lshlrev_b32 v178, 16, v43
    v_and_b32 v179, s40, v43
    v_mfma_f32_32x32x16_bf16 v[116:131], v[40:43], v[56:59], v[116:131]
    v_pk_add_f32 v[164:165], v[164:165], v[178:179]
    v_pk_fma_f32 v[166:167], v[178:179], v[178:179], v[166:167]
    v_lshlrev_b32 v172, 16, v56
    v_and_b32 v173, s40, v56
    v_pk_add_f32 v[170:171], v[170:171], v[172:173]
    v_lshlrev_b32 v174, 16, v57
    v_and_b32 v175, s40, v57
    v_pk_add_f32 v[170:171], v[170:171], v[174:175]
    v_lshlrev_b32 v176, 16, v58
    v_and_b32 v177, s40, v58
    v_pk_add_f32 v[170:171], v[170:171], v[176:177]
    v_lshlrev_b32 v178, 16, v59
    v_and_b32 v179, s40, v59
    v_pk_add_f32 v[170:171], v[170:171], v[178:179]
    s_waitcnt lgkmcnt(0)
    s_barrier
    v_mfma_f32_32x32x16_bf16 v[68:83], v[44:47], v[60:63], v[68:83]
    v_xor_b32 v132, 16384, v132
    v_xor_b32 v133, 16384, v133
    v_xor_b32 v134, 16384, v134
    v_xor_b32 v135, 16384, v135
    v_xor_b32 v28, 16384, v28
    v_xor_b32 v29, 16384, v29
    ds_read_b128 v[36:39], v132 offset:0
    ds_read_b64_tr_b16 v[52:53], v28 offset:0
    ds_read_b64_tr_b16 v[54:55], v28 offset:1024
    v_lshlrev_b32 v172, 16, v44
    v_and_b32 v173, s40, v44
    v_pk_add_f32 v[160:161], v[160:161], v[172:173]
    v_pk_fma_f32 v[162:163], v[172:173], v[172:173], v[162:163]
    v_lshlrev_b32 v174, 16, v45
    v_and_b32 v175, s40, v45
    v_pk_add_f32 v[160:161], v[160:161], v[174:175]
    v_pk_fma_f32 v[162:163], v[174:175], v[174:175], v[162:163]
    v_lshlrev_b32 v176, 16, v46
    v_and_b32 v177, s40, v46
    v_pk_add_f32 v[160:161], v[160:161], v[176:177]
    v_pk_fma_f32 v[162:163], v[176:177], v[176:177], v[162:163]
    v_lshlrev_b32 v178, 16, v47
    v_and_b32 v179, s40, v47
    v_mfma_f32_32x32x16_bf16 v[100:115], v[48:51], v[60:63], v[100:115]
    ds_read_b128 v[40:43], v132 offset:4096
    ds_read_b64_tr_b16 v[56:57], v29 offset:0
    ds_read_b64_tr_b16 v[58:59], v29 offset:1024
    v_pk_add_f32 v[160:161], v[160:161], v[178:179]
    v_pk_fma_f32 v[162:163], v[178:179], v[178:179], v[162:163]
    v_lshlrev_b32 v172, 16, v60
    v_and_b32 v173, s40, v60
    v_pk_add_f32 v[168:169], v[168:169], v[172:173]
    v_lshlrev_b32 v174, 16, v61
    v_and_b32 v175, s40, v61
    v_pk_add_f32 v[168:169], v[168:169], v[174:175]
    v_lshlrev_b32 v176, 16, v62
    v_and_b32 v177, s40, v62
    v_pk_add_f32 v[168:169], v[168:169], v[176:177]
    v_lshlrev_b32 v178, 16, v63
    v_and_b32 v179, s40, v63
    v_pk_add_f32 v[168:169], v[168:169], v[178:179]
    v_mfma_f32_32x32x16_bf16 v[84:99], v[44:47], v[64:67], v[84:99]
    v_lshlrev_b32 v172, 16, v48
    v_and_b32 v173, s40, v48
    v_pk_add_f32 v[164:165], v[164:165], v[172:173]
    v_pk_fma_f32 v[166:167], v[172:173], v[172:173], v[166:167]
    v_lshlrev_b32 v174, 16, v49
    v_and_b32 v175, s40, v49
    v_pk_add_f32 v[164:165], v[164:165], v[174:175]
    v_pk_fma_f32 v[166:167], v[174:175], v[174:175], v[166:167]
    v_lshlrev_b32 v176, 16, v50
    v_and_b32 v177, s40, v50
    v_pk_add_f32 v[164:165], v[164:165], v[176:177]
    v_pk_fma_f32 v[166:167], v[176:177], v[176:177], v[166:167]
    v_lshlrev_b32 v178, 16, v51
    v_and_b32 v179, s40, v51
    v_mfma_f32_32x32x16_bf16 v[116:131], v[48:51], v[64:67], v[116:131]
    v_pk_add_f32 v[164:165], v[164:165], v[178:179]
    v_pk_fma_f32 v[166:167], v[178:179], v[178:179], v[166:167]
    v_lshlrev_b32 v172, 16, v64
    v_and_b32 v173, s40, v64
    v_pk_add_f32 v[170:171], v[170:171], v[172:173]
    v_lshlrev_b32 v174, 16, v65
    v_and_b32 v175, s40, v65
    v_pk_add_f32 v[170:171], v[170:171], v[174:175]
    v_lshlrev_b32 v176, 16, v66
    v_and_b32 v177, s40, v66
    v_pk_add_f32 v[170:171], v[170:171], v[176:177]
    v_lshlrev_b32 v178, 16, v67
    v_and_b32 v179, s40, v67
    v_pk_add_f32 v[170:171], v[170:171], v[178:179]
    v_add_f32 v160, v160, v161
    v_add_f32 v161, v162, v163
    v_add_f32 v168, v168, v169
    v_add_f32 v164, v164, v165
    v_add_f32 v165, v166, v167
    v_add_f32 v170, v170, v171
    v_mov_b32 v172, v160
    v_mov_b32 v173, v161
    v_mov_b32 v174, v164
    v_mov_b32 v175, v165
    v_mov_b32 v176, v168
    v_mov_b32 v177, v170
    v_permlane32_swap_b32 v172, v160
    v_permlane32_swap_b32 v173, v161
    v_permlane32_swap_b32 v174, v164
    v_permlane32_swap_b32 v175, v165
    v_permlane32_swap_b32 v176, v168
    v_permlane32_swap_b32 v177, v170
    v_add_f32 v160, v160, v172
    v_add_f32 v161, v161, v173
    v_add_f32 v164, v164, v174
    v_add_f32 v165, v165, v175
    v_add_f32 v168, v168, v176
    v_add_f32 v170, v170, v177
    v_cmp_gt_u32 vcc, 32, v1
    s_nop 3
    s_and_saveexec_b64 s[42:43], vcc
    buffer_store_dwordx2 v[160:161], v152, s[48:51], 0 offen sc1
    buffer_store_dwordx2 v[164:165], v152, s[48:51], 0 offen offset:256 sc1
    buffer_store_dword v168, v153, s[48:51], 0 offen sc1
    buffer_store_dword v170, v153, s[48:51], 0 offen offset:128 sc1
    s_mov_b64 exec, s[42:43]
    s_waitcnt lgkmcnt(3)
    v_mfma_f32_32x32x16_bf16 v[68:83], v[36:39], v[52:55], v[68:83]
    ds_read_b128 v[44:47], v133 offset:0
    ds_read_b64_tr_b16 v[60:61], v28 offset:4096
    ds_read_b64_tr_b16 v[62:63], v28 offset:5120
    s_waitcnt lgkmcnt(5)
    v_mfma_f32_32x32x16_bf16 v[100:115], v[40:43], v[52:55], v[100:115]
    ds_read_b128 v[48:51], v133 offset:4096
    ds_read_b64_tr_b16 v[64:65], v29 offset:4096
    ds_read_b64_tr_b16 v[66:67], v29 offset:5120
    s_waitcnt lgkmcnt(6)
    v_mfma_f32_32x32x16_bf16 v[84:99], v[36:39], v[56:59], v[84:99]
    v_mfma_f32_32x32x16_bf16 v[116:131], v[40:43], v[56:59], v[116:131]
    s_waitcnt lgkmcnt(3)
    v_mfma_f32_32x32x16_bf16 v[68:83], v[44:47], v[60:63], v[68:83]
    ds_read_b128 v[36:39], v134 offset:0
    ds_read_b64_tr_b16 v[52:53], v28 offset:8192
    ds_read_b64_tr_b16 v[54:55], v28 offset:9216
    s_waitcnt lgkmcnt(5)
    v_mfma_f32_32x32x16_bf16 v[100:115], v[48:51], v[60:63], v[100:115]
    ds_read_b128 v[40:43], v134 offset:4096
    ds_read_b64_tr_b16 v[56:57], v29 offset:8192
    ds_read_b64_tr_b16 v[58:59], v29 offset:9216
    s_waitcnt lgkmcnt(6)
    v_mfma_f32_32x32x16_bf16 v[84:99], v[44:47], v[64:67], v[84:99]
    v_mfma_f32_32x32x16_bf16 v[116:131], v[48:51], v[64:67], v[116:131]
    s_waitcnt lgkmcnt(3)
    v_mfma_f32_32x32x16_bf16 v[68:83], v[36:39], v[52:55], v[68:83]
    ds_read_b128 v[44:47], v135 offset:0
    ds_read_b64_tr_b16 v[60:61], v28 offset:12288
    ds_read_b64_tr_b16 v[62:63], v28 offset:13312
    s_waitcnt lgkmcnt(5)
    v_mfma_f32_32x32x16_bf16 v[100:115], v[40:43], v[52:55], v[100:115]
    ds_read_b128 v[48:51], v135 offset:4096
    ds_read_b64_tr_b16 v[64:65], v29 offset:12288
    ds_read_b64_tr_b16 v[66:67], v29 offset:13312
    s_waitcnt lgkmcnt(6)
    v_mfma_f32_32x32x16_bf16 v[84:99], v[36:39], v[56:59], v[84:99]
    v_mfma_f32_32x32x16_bf16 v[116:131], v[40:43], v[56:59], v[116:131]
    s_waitcnt lgkmcnt(0)
    s_barrier
    v_mfma_f32_32x32x16_bf16 v[68:83], v[44:47], v[60:63], v[68:83]
    v_xor_b32 v132, 32768, v132
    v_xor_b32 v133, 32768, v133
    v_xor_b32 v134, 32768, v134
    v_xor_b32 v135, 32768, v135
    v_xor_b32 v28, 32768, v28
    v_xor_b32 v29, 32768, v29
    ds_read_b128 v[36:39], v132 offset:0
    ds_read_b64_tr_b16 v[52:53], v28 offset:0
    ds_read_b64_tr_b16 v[54:55], v28 offset:1024
    v_mfma_f32_32x32x16_bf16 v[100:115], v[48:51], v[60:63], v[100:115]
    ds_read_b128 v[40:43], v132 offset:4096
    ds_read_b64_tr_b16 v[56:57], v29 offset:0
    ds_read_b64_tr_b16 v[58:59], v29 offset:1024
    v_mfma_f32_32x32x16_bf16 v[84:99], v[44:47], v[64:67], v[84:99]
    v_mfma_f32_32x32x16_bf16 v[116:131], v[48:51], v[64:67], v[116:131]
    s_waitcnt lgkmcnt(3)
    v_mfma_f32_32x32x16_bf16 v[68:83], v[36:39], v[52:55], v[68:83]
    ds_read_b128 v[44:47], v133 offset:0
    ds_read_b64_tr_b16 v[60:61], v28 offset:4096
    ds_read_b64_tr_b16 v[62:63], v28 offset:5120
    s_waitcnt lgkmcnt(5)
    v_mfma_f32_32x32x16_bf16 v[100:115], v[40:43], v[52:55], v[100:115]
    ds_read_b128 v[48:51], v133 offset:4096
    ds_read_b64_tr_b16 v[64:65], v29 offset:4096
    ds_read_b64_tr_b16 v[66:67], v29 offset:5120
    s_waitcnt lgkmcnt(6)
    v_mfma_f32_32x32x16_bf16 v[84:99], v[36:39], v[56:59], v[84:99]
    v_mfma_f32_32x32x16_bf16 v[116:131], v[40:43], v[56:59], v[116:131]
    s_waitcnt lgkmcnt(3)
    v_mfma_f32_32x32x16_bf16 v[68:83], v[44:47], v[60:63], v[68:83]
    ds_read_b128 v[36:39], v134 offset:0
    ds_read_b64_tr_b16 v[52:53], v28 offset:8192
    ds_read_b64_tr_b16 v[54:55], v28 offset:9216
    s_waitcnt lgkmcnt(5)
    v_mfma_f32_32x32x16_bf16 v[100:115], v[48:51], v[60:63], v[100:115]
    ds_read_b128 v[40:43], v134 offset:4096
    ds_read_b64_tr_b16 v[56:57], v29 offset:8192
    ds_read_b64_tr_b16 v[58:59], v29 offset:9216
    s_waitcnt lgkmcnt(6)
    v_mfma_f32_32x32x16_bf16 v[84:99], v[44:47], v[64:67], v[84:99]
    v_mfma_f32_32x32x16_bf16 v[116:131], v[48:51], v[64:67], v[116:131]
    s_waitcnt lgkmcnt(3)
    v_mfma_f32_32x32x16_bf16 v[68:83], v[36:39], v[52:55], v[68:83]
    ds_read_b128 v[44:47], v135 offset:0
    ds_read_b64_tr_b16 v[60:61], v28 offset:12288
    ds_read_b64_tr_b16 v[62:63], v28 offset:13312
    s_waitcnt lgkmcnt(5)
    v_mfma_f32_32x32x16_bf16 v[100:115], v[40:43], v[52:55], v[100:115]
    ds_read_b128 v[48:51], v135 offset:4096
    ds_read_b64_tr_b16 v[64:65], v29 offset:12288
    ds_read_b64_tr_b16 v[66:67], v29 offset:13312
    s_waitcnt lgkmcnt(6)
    v_mfma_f32_32x32x16_bf16 v[84:99], v[36:39], v[56:59], v[84:99]
    v_mfma_f32_32x32x16_bf16 v[116:131], v[40:43], v[56:59], v[116:131]
    s_waitcnt vmcnt(0) lgkmcnt(0)
    s_barrier
    v_mfma_f32_32x32x16_bf16 v[68:83], v[44:47], v[60:63], v[68:83]
    v_xor_b32 v132, 16384, v132
    v_xor_b32 v133, 16384, v133
    v_xor_b32 v134, 16384, v134
    v_xor_b32 v135, 16384, v135
    v_xor_b32 v28, 16384, v28
    v_xor_b32 v29, 16384, v29
    ds_read_b128 v[36:39], v132 offset:0
    ds_read_b64_tr_b16 v[52:53], v28 offset:0
    ds_read_b64_tr_b16 v[54:55], v28 offset:1024
    v_mfma_f32_32x32x16_bf16 v[100:115], v[48:51], v[60:63], v[100:115]
    ds_read_b128 v[40:43], v132 offset:4096
    ds_read_b64_tr_b16 v[56:57], v29 offset:0
    ds_read_b64_tr_b16 v[58:59], v29 offset:1024
    v_mfma_f32_32x32x16_bf16 v[84:99], v[44:47], v[64:67], v[84:99]
    v_mfma_f32_32x32x16_bf16 v[116:131], v[48:51], v[64:67], v[116:131]
k1_kernel_v_loop:
    s_waitcnt lgkmcnt(3)
    v_mfma_f32_32x32x16_bf16 v[68:83], v[36:39], v[52:55], v[68:83]
    ds_read_b128 v[44:47], v133 offset:0
    ds_read_b64_tr_b16 v[60:61], v28 offset:4096
    ds_read_b64_tr_b16 v[62:63], v28 offset:5120
    s_waitcnt lgkmcnt(5)
    v_mfma_f32_32x32x16_bf16 v[100:115], v[40:43], v[52:55], v[100:115]
    ds_read_b128 v[48:51], v133 offset:4096
    ds_read_b64_tr_b16 v[64:65], v29 offset:4096
    ds_read_b64_tr_b16 v[66:67], v29 offset:5120
    s_waitcnt lgkmcnt(6)
    v_mfma_f32_32x32x16_bf16 v[84:99], v[36:39], v[56:59], v[84:99]
    v_mfma_f32_32x32x16_bf16 v[116:131], v[40:43], v[56:59], v[116:131]
    s_waitcnt lgkmcnt(3)
    v_mfma_f32_32x32x16_bf16 v[68:83], v[44:47], v[60:63], v[68:83]
    ds_read_b128 v[36:39], v134 offset:0
    ds_read_b64_tr_b16 v[52:53], v28 offset:8192
    ds_read_b64_tr_b16 v[54:55], v28 offset:9216
    s_waitcnt lgkmcnt(5)
    v_mfma_f32_32x32x16_bf16 v[100:115], v[48:51], v[60:63], v[100:115]
    ds_read_b128 v[40:43], v134 offset:4096
    ds_read_b64_tr_b16 v[56:57], v29 offset:8192
    ds_read_b64_tr_b16 v[58:59], v29 offset:9216
    s_waitcnt lgkmcnt(6)
    v_mfma_f32_32x32x16_bf16 v[84:99], v[44:47], v[64:67], v[84:99]
    v_mfma_f32_32x32x16_bf16 v[116:131], v[48:51], v[64:67], v[116:131]
    s_waitcnt lgkmcnt(3)
    v_mfma_f32_32x32x16_bf16 v[68:83], v[36:39], v[52:55], v[68:83]
    ds_read_b128 v[44:47], v135 offset:0
    ds_read_b64_tr_b16 v[60:61], v28 offset:12288
    ds_read_b64_tr_b16 v[62:63], v28 offset:13312
    s_waitcnt lgkmcnt(5)
    v_mfma_f32_32x32x16_bf16 v[100:115], v[40:43], v[52:55], v[100:115]
    ds_read_b128 v[48:51], v135 offset:4096
    ds_read_b64_tr_b16 v[64:65], v29 offset:12288
    ds_read_b64_tr_b16 v[66:67], v29 offset:13312
    s_waitcnt lgkmcnt(6)
    v_mfma_f32_32x32x16_bf16 v[84:99], v[36:39], v[56:59], v[84:99]
    v_mfma_f32_32x32x16_bf16 v[116:131], v[40:43], v[56:59], v[116:131]
    s_waitcnt lgkmcnt(0)
    s_barrier
    v_mfma_f32_32x32x16_bf16 v[68:83], v[44:47], v[60:63], v[68:83]
    v_xor_b32 v132, 32768, v132
    v_xor_b32 v133, 32768, v133
    v_xor_b32 v134, 32768, v134
    v_xor_b32 v135, 32768, v135
    v_xor_b32 v28, 32768, v28
    v_xor_b32 v29, 32768, v29
    ds_read_b128 v[36:39], v132 offset:0
    ds_read_b64_tr_b16 v[52:53], v28 offset:0
    ds_read_b64_tr_b16 v[54:55], v28 offset:1024
    v_mfma_f32_32x32x16_bf16 v[100:115], v[48:51], v[60:63], v[100:115]
    ds_read_b128 v[40:43], v132 offset:4096
    ds_read_b64_tr_b16 v[56:57], v29 offset:0
    ds_read_b64_tr_b16 v[58:59], v29 offset:1024
    v_mfma_f32_32x32x16_bf16 v[84:99], v[44:47], v[64:67], v[84:99]
    v_mfma_f32_32x32x16_bf16 v[116:131], v[48:51], v[64:67], v[116:131]
    s_waitcnt lgkmcnt(3)
    v_mfma_f32_32x32x16_bf16 v[68:83], v[36:39], v[52:55], v[68:83]
    ds_read_b128 v[44:47], v133 offset:0
    ds_read_b64_tr_b16 v[60:61], v28 offset:4096
    ds_read_b64_tr_b16 v[62:63], v28 offset:5120
    s_waitcnt lgkmcnt(5)
    v_mfma_f32_32x32x16_bf16 v[100:115], v[40:43], v[52:55], v[100:115]
    ds_read_b128 v[48:51], v133 offset:4096
    ds_read_b64_tr_b16 v[64:65], v29 offset:4096
    ds_read_b64_tr_b16 v[66:67], v29 offset:5120
    s_waitcnt lgkmcnt(6)
    v_mfma_f32_32x32x16_bf16 v[84:99], v[36:39], v[56:59], v[84:99]
    v_mfma_f32_32x32x16_bf16 v[116:131], v[40:43], v[56:59], v[116:131]
    s_waitcnt lgkmcnt(3)
    v_mfma_f32_32x32x16_bf16 v[68:83], v[44:47], v[60:63], v[68:83]
    ds_read_b128 v[36:39], v134 offset:0
    ds_read_b64_tr_b16 v[52:53], v28 offset:8192
    ds_read_b64_tr_b16 v[54:55], v28 offset:9216
    s_waitcnt lgkmcnt(5)
    v_mfma_f32_32x32x16_bf16 v[100:115], v[48:51], v[60:63], v[100:115]
    ds_read_b128 v[40:43], v134 offset:4096
    ds_read_b64_tr_b16 v[56:57], v29 offset:8192
    ds_read_b64_tr_b16 v[58:59], v29 offset:9216
    s_waitcnt lgkmcnt(6)
    v_mfma_f32_32x32x16_bf16 v[84:99], v[44:47], v[64:67], v[84:99]
    v_mfma_f32_32x32x16_bf16 v[116:131], v[48:51], v[64:67], v[116:131]
    s_waitcnt lgkmcnt(3)
    v_mfma_f32_32x32x16_bf16 v[68:83], v[36:39], v[52:55], v[68:83]
    ds_read_b128 v[44:47], v135 offset:0
    ds_read_b64_tr_b16 v[60:61], v28 offset:12288
    ds_read_b64_tr_b16 v[62:63], v28 offset:13312
    s_waitcnt lgkmcnt(5)
    v_mfma_f32_32x32x16_bf16 v[100:115], v[40:43], v[52:55], v[100:115]
    ds_read_b128 v[48:51], v135 offset:4096
    ds_read_b64_tr_b16 v[64:65], v29 offset:12288
    ds_read_b64_tr_b16 v[66:67], v29 offset:13312
    s_waitcnt lgkmcnt(6)
    v_mfma_f32_32x32x16_bf16 v[84:99], v[36:39], v[56:59], v[84:99]
    v_mfma_f32_32x32x16_bf16 v[116:131], v[40:43], v[56:59], v[116:131]
    s_waitcnt lgkmcnt(0)
    s_barrier
    v_mfma_f32_32x32x16_bf16 v[68:83], v[44:47], v[60:63], v[68:83]
    v_xor_b32 v132, 16384, v132
    v_xor_b32 v133, 16384, v133
    v_xor_b32 v134, 16384, v134
    v_xor_b32 v135, 16384, v135
    v_xor_b32 v28, 16384, v28
    v_xor_b32 v29, 16384, v29
    ds_read_b128 v[36:39], v132 offset:0
    ds_read_b64_tr_b16 v[52:53], v28 offset:0
    ds_read_b64_tr_b16 v[54:55], v28 offset:1024
    v_mfma_f32_32x32x16_bf16 v[100:115], v[48:51], v[60:63], v[100:115]
    ds_read_b128 v[40:43], v132 offset:4096
    ds_read_b64_tr_b16 v[56:57], v29 offset:0
    ds_read_b64_tr_b16 v[58:59], v29 offset:1024
    v_mfma_f32_32x32x16_bf16 v[84:99], v[44:47], v[64:67], v[84:99]
    v_mfma_f32_32x32x16_bf16 v[116:131], v[48:51], v[64:67], v[116:131]
    s_add_u32 s55, s55, 1
    s_cmp_lt_u32 s55, 3
    s_cbranch_scc1 k1_kernel_v_loop
    s_waitcnt lgkmcnt(3)
    v_mfma_f32_32x32x16_bf16 v[68:83], v[36:39], v[52:55], v[68:83]
    ds_read_b128 v[44:47], v133 offset:0
    ds_read_b64_tr_b16 v[60:61], v28 offset:4096
    ds_read_b64_tr_b16 v[62:63], v28 offset:5120
    s_waitcnt lgkmcnt(5)
    v_mfma_f32_32x32x16_bf16 v[100:115], v[40:43], v[52:55], v[100:115]
    ds_read_b128 v[48:51], v133 offset:4096
    ds_read_b64_tr_b16 v[64:65], v29 offset:4096
    ds_read_b64_tr_b16 v[66:67], v29 offset:5120
    s_waitcnt lgkmcnt(6)
    v_mfma_f32_32x32x16_bf16 v[84:99], v[36:39], v[56:59], v[84:99]
    v_mfma_f32_32x32x16_bf16 v[116:131], v[40:43], v[56:59], v[116:131]
    s_waitcnt lgkmcnt(3)
    v_mfma_f32_32x32x16_bf16 v[68:83], v[44:47], v[60:63], v[68:83]
    ds_read_b128 v[36:39], v134 offset:0
    ds_read_b64_tr_b16 v[52:53], v28 offset:8192
    ds_read_b64_tr_b16 v[54:55], v28 offset:9216
    s_waitcnt lgkmcnt(5)
    v_mfma_f32_32x32x16_bf16 v[100:115], v[48:51], v[60:63], v[100:115]
    ds_read_b128 v[40:43], v134 offset:4096
    ds_read_b64_tr_b16 v[56:57], v29 offset:8192
    ds_read_b64_tr_b16 v[58:59], v29 offset:9216
    s_waitcnt lgkmcnt(6)
    v_mfma_f32_32x32x16_bf16 v[84:99], v[44:47], v[64:67], v[84:99]
    v_mfma_f32_32x32x16_bf16 v[116:131], v[48:51], v[64:67], v[116:131]
    s_waitcnt lgkmcnt(3)
    v_mfma_f32_32x32x16_bf16 v[68:83], v[36:39], v[52:55], v[68:83]
    ds_read_b128 v[44:47], v135 offset:0
    ds_read_b64_tr_b16 v[60:61], v28 offset:12288
    ds_read_b64_tr_b16 v[62:63], v28 offset:13312
    s_waitcnt lgkmcnt(5)
    v_mfma_f32_32x32x16_bf16 v[100:115], v[40:43], v[52:55], v[100:115]
    ds_read_b128 v[48:51], v135 offset:4096
    ds_read_b64_tr_b16 v[64:65], v29 offset:12288
    ds_read_b64_tr_b16 v[66:67], v29 offset:13312
    s_waitcnt lgkmcnt(6)
    v_mfma_f32_32x32x16_bf16 v[84:99], v[36:39], v[56:59], v[84:99]
    v_mfma_f32_32x32x16_bf16 v[116:131], v[40:43], v[56:59], v[116:131]
    s_waitcnt lgkmcnt(0)
    s_barrier
    v_mfma_f32_32x32x16_bf16 v[68:83], v[44:47], v[60:63], v[68:83]
    v_xor_b32 v132, 32768, v132
    v_xor_b32 v133, 32768, v133
    v_xor_b32 v134, 32768, v134
    v_xor_b32 v135, 32768, v135
    v_xor_b32 v28, 32768, v28
    v_xor_b32 v29, 32768, v29
    ds_read_b128 v[36:39], v132 offset:0
    ds_read_b64_tr_b16 v[52:53], v28 offset:0
    ds_read_b64_tr_b16 v[54:55], v28 offset:1024
    v_mfma_f32_32x32x16_bf16 v[100:115], v[48:51], v[60:63], v[100:115]
    ds_read_b128 v[40:43], v132 offset:4096
    ds_read_b64_tr_b16 v[56:57], v29 offset:0
    ds_read_b64_tr_b16 v[58:59], v29 offset:1024
    v_mfma_f32_32x32x16_bf16 v[84:99], v[44:47], v[64:67], v[84:99]
    v_mfma_f32_32x32x16_bf16 v[116:131], v[48:51], v[64:67], v[116:131]
    s_waitcnt lgkmcnt(0)
    ds_read_b32 v36, v149
    ds_read_b32 v38, v149 offset:128
    ds_read_b128 v[160:163], v150 offset:0
    ds_read_b128 v[192:195], v150 offset:512
    ds_read_b128 v[164:167], v150 offset:32
    ds_read_b128 v[196:199], v150 offset:544
    ds_read_b128 v[168:171], v150 offset:64
    ds_read_b128 v[200:203], v150 offset:576
    ds_read_b128 v[172:175], v150 offset:96
    ds_read_b128 v[204:207], v150 offset:608
    ds_read_b128 v[176:179], v150 offset:128
    ds_read_b128 v[208:211], v150 offset:640
    ds_read_b128 v[180:183], v150 offset:160
    ds_read_b128 v[212:215], v150 offset:672
    ds_read_b128 v[184:187], v150 offset:192
    ds_read_b128 v[216:219], v150 offset:704
    ds_read_b128 v[188:191], v150 offset:224
    ds_read_b128 v[220:223], v150 offset:736
    s_waitcnt lgkmcnt(0)
    v_pk_mul_f32 v[68:69], v[68:69], v[160:161]
    v_pk_fma_f32 v[68:69], v[192:193], v[36:37], v[68:69] op_sel_hi:[1,0,1] neg_lo:[1,0,0] neg_hi:[1,0,0]
    v_pk_mul_f32 v[70:71], v[70:71], v[162:163]
    v_pk_fma_f32 v[70:71], v[194:195], v[36:37], v[70:71] op_sel_hi:[1,0,1] neg_lo:[1,0,0] neg_hi:[1,0,0]
    v_pk_mul_f32 v[72:73], v[72:73], v[164:165]
    v_pk_fma_f32 v[72:73], v[196:197], v[36:37], v[72:73] op_sel_hi:[1,0,1] neg_lo:[1,0,0] neg_hi:[1,0,0]
    v_pk_mul_f32 v[74:75], v[74:75], v[166:167]
    v_pk_fma_f32 v[74:75], v[198:199], v[36:37], v[74:75] op_sel_hi:[1,0,1] neg_lo:[1,0,0] neg_hi:[1,0,0]
    v_cvt_pk_bf16_f32 v68, v68, v69
    v_cvt_pk_bf16_f32 v69, v70, v71
    v_cvt_pk_bf16_f32 v70, v72, v73
    v_cvt_pk_bf16_f32 v71, v74, v75
    buffer_store_dwordx4 v[68:71], v140, s[20:23], s53 offen offset:0
    v_pk_mul_f32 v[76:77], v[76:77], v[168:169]
    v_pk_fma_f32 v[76:77], v[200:201], v[36:37], v[76:77] op_sel_hi:[1,0,1] neg_lo:[1,0,0] neg_hi:[1,0,0]
    v_pk_mul_f32 v[78:79], v[78:79], v[170:171]
    v_pk_fma_f32 v[78:79], v[202:203], v[36:37], v[78:79] op_sel_hi:[1,0,1] neg_lo:[1,0,0] neg_hi:[1,0,0]
    v_pk_mul_f32 v[80:81], v[80:81], v[172:173]
    v_pk_fma_f32 v[80:81], v[204:205], v[36:37], v[80:81] op_sel_hi:[1,0,1] neg_lo:[1,0,0] neg_hi:[1,0,0]
    v_pk_mul_f32 v[82:83], v[82:83], v[174:175]
    v_pk_fma_f32 v[82:83], v[206:207], v[36:37], v[82:83] op_sel_hi:[1,0,1] neg_lo:[1,0,0] neg_hi:[1,0,0]
    v_cvt_pk_bf16_f32 v76, v76, v77
    v_cvt_pk_bf16_f32 v77, v78, v79
    v_cvt_pk_bf16_f32 v78, v80, v81
    v_cvt_pk_bf16_f32 v79, v82, v83
    buffer_store_dwordx4 v[76:79], v140, s[20:23], s53 offen offset:640
    v_pk_mul_f32 v[84:85], v[84:85], v[160:161]
    v_pk_fma_f32 v[84:85], v[192:193], v[38:39], v[84:85] op_sel_hi:[1,0,1] neg_lo:[1,0,0] neg_hi:[1,0,0]
    v_pk_mul_f32 v[86:87], v[86:87], v[162:163]
    v_pk_fma_f32 v[86:87], v[194:195], v[38:39], v[86:87] op_sel_hi:[1,0,1] neg_lo:[1,0,0] neg_hi:[1,0,0]
    v_pk_mul_f32 v[88:89], v[88:89], v[164:165]
    v_pk_fma_f32 v[88:89], v[196:197], v[38:39], v[88:89] op_sel_hi:[1,0,1] neg_lo:[1,0,0] neg_hi:[1,0,0]
    v_pk_mul_f32 v[90:91], v[90:91], v[166:167]
    v_pk_fma_f32 v[90:91], v[198:199], v[38:39], v[90:91] op_sel_hi:[1,0,1] neg_lo:[1,0,0] neg_hi:[1,0,0]
    v_cvt_pk_bf16_f32 v84, v84, v85
    v_cvt_pk_bf16_f32 v85, v86, v87
    v_cvt_pk_bf16_f32 v86, v88, v89
    v_cvt_pk_bf16_f32 v87, v90, v91
    buffer_store_dwordx4 v[84:87], v141, s[20:23], s53 offen offset:0
    v_pk_mul_f32 v[92:93], v[92:93], v[168:169]
    v_pk_fma_f32 v[92:93], v[200:201], v[38:39], v[92:93] op_sel_hi:[1,0,1] neg_lo:[1,0,0] neg_hi:[1,0,0]
    v_pk_mul_f32 v[94:95], v[94:95], v[170:171]
    v_pk_fma_f32 v[94:95], v[202:203], v[38:39], v[94:95] op_sel_hi:[1,0,1] neg_lo:[1,0,0] neg_hi:[1,0,0]
    v_pk_mul_f32 v[96:97], v[96:97], v[172:173]
    v_pk_fma_f32 v[96:97], v[204:205], v[38:39], v[96:97] op_sel_hi:[1,0,1] neg_lo:[1,0,0] neg_hi:[1,0,0]
    v_pk_mul_f32 v[98:99], v[98:99], v[174:175]
    v_pk_fma_f32 v[98:99], v[206:207], v[38:39], v[98:99] op_sel_hi:[1,0,1] neg_lo:[1,0,0] neg_hi:[1,0,0]
    v_cvt_pk_bf16_f32 v92, v92, v93
    v_cvt_pk_bf16_f32 v93, v94, v95
    v_cvt_pk_bf16_f32 v94, v96, v97
    v_cvt_pk_bf16_f32 v95, v98, v99
    buffer_store_dwordx4 v[92:95], v141, s[20:23], s53 offen offset:640
    v_pk_mul_f32 v[100:101], v[100:101], v[176:177]
    v_pk_fma_f32 v[100:101], v[208:209], v[36:37], v[100:101] op_sel_hi:[1,0,1] neg_lo:[1,0,0] neg_hi:[1,0,0]
    v_pk_mul_f32 v[102:103], v[102:103], v[178:179]
    v_pk_fma_f32 v[102:103], v[210:211], v[36:37], v[102:103] op_sel_hi:[1,0,1] neg_lo:[1,0,0] neg_hi:[1,0,0]
    v_pk_mul_f32 v[104:105], v[104:105], v[180:181]
    v_pk_fma_f32 v[104:105], v[212:213], v[36:37], v[104:105] op_sel_hi:[1,0,1] neg_lo:[1,0,0] neg_hi:[1,0,0]
    v_pk_mul_f32 v[106:107], v[106:107], v[182:183]
    v_pk_fma_f32 v[106:107], v[214:215], v[36:37], v[106:107] op_sel_hi:[1,0,1] neg_lo:[1,0,0] neg_hi:[1,0,0]
    v_cvt_pk_bf16_f32 v100, v100, v101
    v_cvt_pk_bf16_f32 v101, v102, v103
    v_cvt_pk_bf16_f32 v102, v104, v105
    v_cvt_pk_bf16_f32 v103, v106, v107
    buffer_store_dwordx4 v[100:103], v140, s[20:23], s54 offen offset:0
    v_pk_mul_f32 v[108:109], v[108:109], v[184:185]
    v_pk_fma_f32 v[108:109], v[216:217], v[36:37], v[108:109] op_sel_hi:[1,0,1] neg_lo:[1,0,0] neg_hi:[1,0,0]
    v_pk_mul_f32 v[110:111], v[110:111], v[186:187]
    v_pk_fma_f32 v[110:111], v[218:219], v[36:37], v[110:111] op_sel_hi:[1,0,1] neg_lo:[1,0,0] neg_hi:[1,0,0]
    v_pk_mul_f32 v[112:113], v[112:113], v[188:189]
    v_pk_fma_f32 v[112:113], v[220:221], v[36:37], v[112:113] op_sel_hi:[1,0,1] neg_lo:[1,0,0] neg_hi:[1,0,0]
    v_pk_mul_f32 v[114:115], v[114:115], v[190:191]
    v_pk_fma_f32 v[114:115], v[222:223], v[36:37], v[114:115] op_sel_hi:[1,0,1] neg_lo:[1,0,0] neg_hi:[1,0,0]
    v_cvt_pk_bf16_f32 v108, v108, v109
    v_cvt_pk_bf16_f32 v109, v110, v111
    v_cvt_pk_bf16_f32 v110, v112, v113
    v_cvt_pk_bf16_f32 v111, v114, v115
    buffer_store_dwordx4 v[108:111], v140, s[20:23], s54 offen offset:640
    v_pk_mul_f32 v[116:117], v[116:117], v[176:177]
    v_pk_fma_f32 v[116:117], v[208:209], v[38:39], v[116:117] op_sel_hi:[1,0,1] neg_lo:[1,0,0] neg_hi:[1,0,0]
    v_pk_mul_f32 v[118:119], v[118:119], v[178:179]
    v_pk_fma_f32 v[118:119], v[210:211], v[38:39], v[118:119] op_sel_hi:[1,0,1] neg_lo:[1,0,0] neg_hi:[1,0,0]
    v_pk_mul_f32 v[120:121], v[120:121], v[180:181]
    v_pk_fma_f32 v[120:121], v[212:213], v[38:39], v[120:121] op_sel_hi:[1,0,1] neg_lo:[1,0,0] neg_hi:[1,0,0]
    v_pk_mul_f32 v[122:123], v[122:123], v[182:183]
    v_pk_fma_f32 v[122:123], v[214:215], v[38:39], v[122:123] op_sel_hi:[1,0,1] neg_lo:[1,0,0] neg_hi:[1,0,0]
    v_cvt_pk_bf16_f32 v116, v116, v117
    v_cvt_pk_bf16_f32 v117, v118, v119
    v_cvt_pk_bf16_f32 v118, v120, v121
    v_cvt_pk_bf16_f32 v119, v122, v123
    buffer_store_dwordx4 v[116:119], v141, s[20:23], s54 offen offset:0
    v_pk_mul_f32 v[124:125], v[124:125], v[184:185]
    v_pk_fma_f32 v[124:125], v[216:217], v[38:39], v[124:125] op_sel_hi:[1,0,1] neg_lo:[1,0,0] neg_hi:[1,0,0]
    v_pk_mul_f32 v[126:127], v[126:127], v[186:187]
    v_pk_fma_f32 v[126:127], v[218:219], v[38:39], v[126:127] op_sel_hi:[1,0,1] neg_lo:[1,0,0] neg_hi:[1,0,0]
    v_pk_mul_f32 v[128:129], v[128:129], v[188:189]
    v_pk_fma_f32 v[128:129], v[220:221], v[38:39], v[128:129] op_sel_hi:[1,0,1] neg_lo:[1,0,0] neg_hi:[1,0,0]
    v_pk_mul_f32 v[130:131], v[130:131], v[190:191]
    v_pk_fma_f32 v[130:131], v[222:223], v[38:39], v[130:131] op_sel_hi:[1,0,1] neg_lo:[1,0,0] neg_hi:[1,0,0]
    v_cvt_pk_bf16_f32 v124, v124, v125
    v_cvt_pk_bf16_f32 v125, v126, v127
    v_cvt_pk_bf16_f32 v126, v128, v129
    v_cvt_pk_bf16_f32 v127, v130, v131
    buffer_store_dwordx4 v[124:127], v141, s[20:23], s54 offen offset:640
k1_kernel_fin:
k1_kernel_end:
    s_endpgm

.section .rodata,"a"
.p2align 6
.amdhsa_kernel k1_kernel
  .amdhsa_next_free_vgpr 224
  .amdhsa_next_free_sgpr 100
  .amdhsa_accum_offset 224
  .amdhsa_group_segment_fixed_size 0
  .amdhsa_kernarg_size 80
  .amdhsa_user_sgpr_count 2
  .amdhsa_user_sgpr_kernarg_segment_ptr 1
  .amdhsa_system_sgpr_workgroup_id_x 1
.end_amdhsa_kernel

.text
.globl m2_kernel
.p2align 8
.type m2_kernel,@function
m2_kernel:
    s_cmp_ge_u32 s2, 256
    s_cbranch_scc1 m2_kernel_end
    s_load_dwordx16 s[4:19], s[0:1], 0
    s_load_dwordx2 s[20:21], s[0:1], 72
    v_and_b32 v1, 63, v0
    v_lshrrev_b32 v2, 6, v0
    s_nop 0
    v_readfirstlane_b32 s22, v2
    s_and_b32 s24, s2, 7
    s_bfe_u32 s25, s2, 0x20003
    s_lshr_b32 s26, s2, 5
    s_lshr_b32 s27, s24, 2
    s_lshl_b32 s27, s27, 2
    s_add_u32 s27, s27, s25
    s_waitcnt lgkmcnt(0)
    s_add_u32 s34, s20, 19812352
    s_addc_u32 s35, s21, 0
    s_load_dword s23, s[34:35], 0
    s_add_u32 s28, s20, 26779648
    s_addc_u32 s29, s21, 0
    s_mov_b32 s30, 131072
    s_mov_b32 s31, 0x00020000
    s_mov_b32 s40, s20
    s_mov_b32 s41, s21
    s_mov_b32 s42, 7864320
    s_mov_b32 s43, 0x00020000
    s_lshl_b32 s34, s24, 2
    s_add_u32 s61, s34, s25
    s_mul_i32 s36, s61, 81920
    v_lshlrev_b32 v156, 4, v1
    s_add_u32 s34, s22, 0
    s_lshl_b32 s35, s34, 10
    s_add_u32 s37, s35, 71680
    s_add_u32 s38, s35, 2621440
    s_add_u32 s39, s35, 5232640
    s_cmp_lt_u32 s34, 10
    s_cselect_b32 s54, s35, s37
    s_cselect_b32 s57, s38, s39
    s_add_u32 s57, s57, s36
    s_cmp_lt_u32 s34, 20
    s_cselect_b32 s54, s54, 0x28000
    s_cselect_b32 s57, s57, 0x70000000
    s_add_u32 s34, s22, 8
    s_lshl_b32 s35, s34, 10
    s_add_u32 s37, s35, 71680
    s_add_u32 s38, s35, 2621440
    s_add_u32 s39, s35, 5232640
    s_cmp_lt_u32 s34, 10
    s_cselect_b32 s55, s35, s37
    s_cselect_b32 s58, s38, s39
    s_add_u32 s58, s58, s36
    s_cmp_lt_u32 s34, 20
    s_cselect_b32 s55, s55, 0x28000
    s_cselect_b32 s58, s58, 0x70000000
    s_add_u32 s34, s22, 16
    s_lshl_b32 s35, s34, 10
    s_add_u32 s37, s35, 71680
    s_add_u32 s38, s35, 2621440
    s_add_u32 s39, s35, 5232640
    s_cmp_lt_u32 s34, 10
    s_cselect_b32 s56, s35, s37
    s_cselect_b32 s59, s38, s39
    s_add_u32 s59, s59, s36
    s_cmp_lt_u32 s34, 20
    s_cselect_b32 s56, s56, 0x28000
    s_cselect_b32 s59, s59, 0x70000000
    s_lshl_b32 s34, s26, 3
    s_add_u32 s34, s34, s22
    s_mul_i32 s35, s34, 1280
    s_add_u32 s35, s35, s36
    v_and_b32 v112, 31, v1
    v_lshrrev_b32 v113, 5, v1
    v_mov_b32 v2, v156
    v_lshlrev_b32 v3, 3, v112
    v_add_u32 v3, 1024, v3
    buffer_load_dwordx4 v[8:11], v2, s[40:43], s35 offen
    buffer_load_dwordx2 v[12:13], v3, s[40:43], s35 offen
    s_mov_b32 s60, 0
    s_add_u32 m0, s54, s60
    s_add_u32 s39, s57, s60
    buffer_load_dwordx4 v156, s[40:43], s39 offen lds
    s_add_u32 m0, s55, s60
    s_add_u32 s39, s58, s60
    buffer_load_dwordx4 v156, s[40:43], s39 offen lds
    s_add_u32 m0, s56, s60
    s_add_u32 s39, s59, s60
    buffer_load_dwordx4 v156, s[40:43], s39 offen lds
    s_add_u32 s60, s60, 10240
    s_cmp_ge_u32 s60, 81920
    s_cselect_b32 s60, 0x40000000, s60
    s_add_u32 m0, s54, s60
    s_add_u32 s39, s57, s60
    buffer_load_dwordx4 v156, s[40:43], s39 offen lds
    s_add_u32 m0, s55, s60
    s_add_u32 s39, s58, s60
    buffer_load_dwordx4 v156, s[40:43], s39 offen lds
    s_add_u32 m0, s56, s60
    s_add_u32 s39, s59, s60
    buffer_load_dwordx4 v156, s[40:43], s39 offen lds
    s_add_u32 s60, s60, 10240
    s_cmp_ge_u32 s60, 81920
    s_cselect_b32 s60, 0x40000000, s60
    s_add_u32 m0, s54, s60
    s_add_u32 s39, s57, s60
    buffer_load_dwordx4 v156, s[40:43], s39 offen lds
    s_add_u32 m0, s55, s60
    s_add_u32 s39, s58, s60
    buffer_load_dwordx4 v156, s[40:43], s39 offen lds
    s_add_u32 m0, s56, s60
    s_add_u32 s39, s59, s60
    buffer_load_dwordx4 v156, s[40:43], s39 offen lds
    s_add_u32 s60, s60, 10240
    s_cmp_ge_u32 s60, 81920
    s_cselect_b32 s60, 0x40000000, s60
    s_add_u32 s44, s20, 7864320
    s_addc_u32 s45, s21, 0
    s_mov_b32 s46, 2621440
    s_mov_b32 s47, 0x00020000
    v_mul_u32_u24 v4, 320, v113
    v_lshl_add_u32 v4, v112, 4, v4
    v_add_u32 v4, 81920, v4
    v_cmp_gt_u32 s[50:51], 20, v112
    v_cmp_eq_u32 vcc, 20, v112
    v_mov_b32 v114, 0
    v_mov_b32 v115, 0x3f803f80
    v_cndmask_b32 v116, v114, v115, vcc
    v_cmp_eq_u32 vcc, 24, v112
    s_nop 1
    v_cndmask_b32 v116, v116, v115, vcc
    v_mov_b32 v32, v116
    v_mov_b32 v36, v116
    v_mov_b32 v33, v116
    v_mov_b32 v37, v116
    v_mov_b32 v34, v116
    v_mov_b32 v38, v116
    v_mov_b32 v35, v116
    v_mov_b32 v39, v116
    v_mov_b32 v40, v116
    v_mov_b32 v44, v116
    v_mov_b32 v41, v116
    v_mov_b32 v45, v116
    v_mov_b32 v42, v116
    v_mov_b32 v46, v116
    v_mov_b32 v43, v116
    v_mov_b32 v47, v116
    v_cmp_eq_u32 vcc, 0, v113
    v_mov_b32 v115, 0x00003f80
    s_nop 0
    v_cndmask_b32 v117, v114, v115, vcc
    v_mov_b32 v22, v117
    v_mov_b32 v23, 0
    v_mov_b32 v30, v117
    v_mov_b32 v31, 0
    v_mov_b32 v14, 0
    v_mov_b32 v15, 0
    v_mov_b32 v96, 0
    v_mov_b32 v97, 0
    v_mov_b32 v98, 0
    v_mov_b32 v99, 0
    v_mov_b32 v100, 0
    v_mov_b32 v101, 0
    v_mov_b32 v102, 0
    v_mov_b32 v103, 0
    v_mov_b32 v104, 0
    v_mov_b32 v105, 0
    v_mov_b32 v106, 0
    v_mov_b32 v107, 0
    v_mov_b32 v108, 0
    v_mov_b32 v109, 0
    v_mov_b32 v110, 0
    v_mov_b32 v111, 0
    v_mov_b32 v88, 0
    v_mov_b32 v89, 0
    v_mov_b32 v90, 0
    v_mov_b32 v91, 0
    v_mov_b32 v92, 0
    v_mov_b32 v93, 0
    v_mov_b32 v94, 0
    v_mov_b32 v95, 0
    s_mul_i32 s37, s61, 5
    v_and_b32 v118, 15, v112
    v_lshrrev_b32 v119, 4, v112
    v_mul_u32_u24 v119, 20480, v119
    v_lshl_add_u32 v119, v118, 3, v119
    s_mul_i32 s52, s34, 40960
    v_add_u32 v120, s37, v113
    v_add_u32 v120, 0, v120
    v_lshl_add_u32 v5, v120, 7, v119
    v_add_u32 v120, s37, v113
    v_add_u32 v120, 2, v120
    v_lshl_add_u32 v6, v120, 7, v119
    v_add_u32 v120, s37, v113
    v_add_u32 v120, 4, v120
    v_lshl_add_u32 v7, v120, 7, v119
    s_lshl_b32 s70, s2, 3
    s_add_u32 s70, s70, s22
    s_add_u32 s71, s70, 2048
    s_mul_i32 s35, s70, 4370
    s_lshr_b32 s35, s35, 20
    s_mul_i32 s36, s35, 240
    s_sub_u32 s34, s70, s36
    s_mul_i32 s36, s34, 2731
    s_lshr_b32 s36, s36, 16
    s_mul_i32 s37, s36, 24
    s_sub_u32 s34, s34, s37
    s_mul_i32 s37, s34, 10923
    s_lshr_b32 s37, s37, 16
    s_mul_i32 s38, s37, 6
    s_sub_u32 s34, s34, s38
    s_lshl_b32 s34, s34, 6
    v_add_u32 v120, s34, v1
    v_mul_u32_u24 v121, 10923, v120
    v_lshrrev_b32 v121, 16, v121
    v_mul_u32_u24 v122, 6, v121
    v_sub_u32 v122, v120, v122
    v_mul_u32_u24 v121, 3072, v121
    v_lshl_add_u32 v121, v122, 4, v121
    s_mul_i32 s36, s36, 196608
    s_mul_i32 s35, s35, 192
    s_add_u32 s36, s36, s35
    s_and_b32 s35, s37, 1
    s_mul_i32 s35, s35, 96
    s_add_u32 s36, s36, s35
    v_add_u32 v144, s36, v121
    s_cmp_lt_u32 s37, 2
    s_cselect_b32 s62, s12, s14
    s_cselect_b32 s63, s13, s15
    s_add_u32 s32, s70, 800
    s_lshl_b32 s32, s32, 10
    s_cmp_lt_u32 s70, 3840
    s_cselect_b32 s32, s32, 0x70000000
    s_mul_i32 s35, s71, 4370
    s_lshr_b32 s35, s35, 20
    s_mul_i32 s36, s35, 240
    s_sub_u32 s34, s71, s36
    s_mul_i32 s36, s34, 2731
    s_lshr_b32 s36, s36, 16
    s_mul_i32 s37, s36, 24
    s_sub_u32 s34, s34, s37
    s_mul_i32 s37, s34, 10923
    s_lshr_b32 s37, s37, 16
    s_mul_i32 s38, s37, 6
    s_sub_u32 s34, s34, s38
    s_lshl_b32 s34, s34, 6
    v_add_u32 v120, s34, v1
    v_mul_u32_u24 v121, 10923, v120
    v_lshrrev_b32 v121, 16, v121
    v_mul_u32_u24 v122, 6, v121
    v_sub_u32 v122, v120, v122
    v_mul_u32_u24 v121, 3072, v121
    v_lshl_add_u32 v121, v122, 4, v121
    s_mul_i32 s36, s36, 196608
    s_mul_i32 s35, s35, 192
    s_add_u32 s36, s36, s35
    s_and_b32 s35, s37, 1
    s_mul_i32 s35, s35, 96
    s_add_u32 s36, s36, s35
    v_add_u32 v145, s36, v121
    s_cmp_lt_u32 s37, 2
    s_cselect_b32 s64, s12, s14
    s_cselect_b32 s65, s13, s15
    s_add_u32 s33, s71, 800
    s_lshl_b32 s33, s33, 10
    s_cmp_lt_u32 s71, 3840
    s_cselect_b32 s33, s33, 0x70000000
    s_mul_i32 s35, s70, 4370
    s_lshr_b32 s35, s35, 20
    s_mul_i32 s36, s35, 240
    s_sub_u32 s34, s70, s36
    s_mul_i32 s36, s34, 3277
    s_lshr_b32 s36, s36, 16
    s_mul_i32 s37, s36, 20
    s_sub_u32 s34, s34, s37
    s_cmp_ge_u32 s34, 10
    s_cselect_b32 s37, 1, 0
    s_mul_i32 s38, s37, 10
    s_sub_u32 s34, s34, s38
    s_lshl_b32 s34, s34, 6
    v_add_u32 v120, s34, v1
    v_mul_u32_u24 v121, 6554, v120
    v_lshrrev_b32 v121, 16, v121
    v_mul_u32_u24 v122, 10, v121
    v_sub_u32 v122, v120, v122
    v_mul_u32_u24 v121, 1280, v121
    v_lshl_add_u32 v121, v122, 4, v121
    s_mul_i32 s37, s37, 768
    s_lshl_b32 s36, s36, 6
    s_add_u32 s36, s36, s37
    s_mul_i32 s36, s36, 1280
    s_mul_i32 s35, s35, 160
    s_add_u32 s36, s36, s35
    v_add_u32 v146, s36, v121
    s_add_u32 s49, s70, 4640
    s_lshl_b32 s49, s49, 10
    s_cmp_lt_u32 s70, 1920
    s_cselect_b32 s49, s49, 0x70000000
    s_mul_i32 s35, s70, 10486
    s_lshr_b32 s35, s35, 20
    s_mul_i32 s36, s35, 100
    s_sub_u32 s34, s70, s36
    s_mul_i32 s36, s34, 3277
    s_lshr_b32 s36, s36, 16
    s_mul_i32 s37, s36, 20
    s_sub_u32 s34, s34, s37
    s_cmp_ge_u32 s34, 10
    s_cselect_b32 s37, 1, 0
    s_mul_i32 s38, s37, 10
    s_sub_u32 s34, s34, s38
    s_lshl_b32 s34, s34, 6
    v_add_u32 v120, s34, v1
    v_mul_u32_u24 v121, 6554, v120
    v_lshrrev_b32 v121, 16, v121
    v_mul_u32_u24 v122, 10, v121
    v_sub_u32 v122, v120, v122
    v_mul_u32_u24 v121, 1280, v121
    v_lshl_add_u32 v121, v122, 4, v121
    s_mul_i32 s37, s37, 320
    s_lshl_b32 s36, s36, 6
    s_add_u32 s36, s36, s37
    s_mul_i32 s36, s36, 1280
    s_mul_i32 s35, s35, 160
    s_add_u32 s36, s36, s35
    v_add_u32 v147, s36, v121
    s_add_u32 s53, s70, 0
    s_lshl_b32 s53, s53, 10
    s_cmp_lt_u32 s70, 800
    s_cselect_b32 s53, s53, 0x70000000
    s_lshl_b32 s34, s26, 3
    s_add_u32 s34, s34, s22
    s_lshr_b32 s35, s24, 1
    s_lshl_b32 s35, s35, 2
    s_add_u32 s35, s35, s25
    s_mul_i32 s35, s35, 245760
    s_add_u32 s35, s35, 819200
    s_mul_i32 s36, s34, 3840
    s_add_u32 s35, s35, s36
    s_mul_i32 s37, s27, 245760
    s_add_u32 s37, s37, 4747264
    s_add_u32 s37, s37, s36
    v_lshlrev_b32 v120, 7, v1
    v_add_u32 v121, s35, v120
    v_add_u32 v122, s37, v120
    v_cmp_gt_u32 vcc, 32, v1
    s_nop 1
    v_cndmask_b32 v158, v122, v121, vcc
    v_and_b32 v121, 31, v1
    v_cmp_gt_u32 vcc, 30, v121
    v_mov_b32 v122, 0x7f000000
    s_nop 0
    v_cndmask_b32 v158, v122, v158, vcc
    s_mul_i32 s37, s27, 102400
    s_mul_i32 s36, s34, 1664
    s_add_u32 s37, s37, s36
    v_add_u32 v121, s37, v120
    v_cmp_gt_u32 vcc, 13, v1
    s_nop 1
    v_cndmask_b32 v159, v122, v121, vcc
    v_lshlrev_b32 v148, 7, v1
    v_add_u32 v149, 8192, v148
    v_add_u32 v150, 16384, v148
    v_add_u32 v151, 24576, v148
    v_cmp_eq_u32 vcc, 1, v113
    v_mov_b32 v120, 0x7f000000
    s_nop 0
    v_cndmask_b32 v7, v7, v120, vcc
    s_waitcnt vmcnt(9)
    v_cndmask_b32 v12, v12, v114, vcc
    v_cndmask_b32 v13, v13, v114, vcc
    s_waitcnt vmcnt(6)
    s_barrier
    ds_read_b128 v[16:19], v2 offset:0
    ds_read_b64 v[20:21], v3 offset:0
    ds_read_b128 v[24:27], v2 offset:1280
    ds_read_b64 v[28:29], v3 offset:1280
    s_waitcnt lgkmcnt(2)
    v_mfma_f32_32x32x16_bf16 v[48:63], v[16:19], v[8:11], 0
    v_mfma_f32_32x32x16_bf16 v[48:63], v[20:23], v[12:15], v[48:63]
    s_nop 11
    v_max3_f32 v112, v48, v49, v50
    v_max3_f32 v112, v112, v51, v52
    v_max3_f32 v112, v112, v53, v54
    v_max3_f32 v112, v112, v55, v56
    v_max3_f32 v112, v112, v57, v58
    v_max3_f32 v112, v112, v59, v60
    v_max3_f32 v112, v112, v61, v62
    v_max_f32 v112, v112, v63
    v_mov_b32 v114, v112
    s_nop 1
    v_permlane32_swap_b32 v114, v112
    v_max_f32 v112, v112, v114
    v_sub_f32 v112, 0, v112
    v_cvt_pk_bf16_f32 v112, v112, 0
    v_and_b32 v112, 0xffff, v112
    v_cmp_gt_u32 vcc, 32, v1
    s_nop 1
    v_cndmask_b32 v14, 0, v112, vcc
    v_mfma_f32_32x32x16_bf16 v[48:63], v[16:19], v[8:11], 0
    s_nop 0
    v_mfma_f32_32x32x16_bf16 v[48:63], v[20:23], v[12:15], v[48:63]
    s_waitcnt lgkmcnt(0)
    s_nop 10
    v_exp_f32 v48, v48
    v_mfma_f32_32x32x16_bf16 v[64:79], v[24:27], v[8:11], 0
    v_exp_f32 v49, v49
    v_exp_f32 v50, v50
    ds_read_b128 v[16:19], v2 offset:2560
    ds_read_b64 v[20:21], v3 offset:2560
    s_mov_b64 exec, s[50:51]
    ds_read_b128 v[32:35], v4 offset:0
    ds_read_b128 v[36:39], v4 offset:640
    s_mov_b64 exec, -1
    v_exp_f32 v51, v51
    v_cvt_pk_bf16_f32 v80, v48, v49
    v_exp_f32 v52, v52
    v_exp_f32 v53, v53
    v_mfma_f32_32x32x16_bf16 v[64:79], v[28:31], v[12:15], v[64:79]
    v_cvt_pk_bf16_f32 v81, v50, v51
    v_exp_f32 v54, v54
    v_exp_f32 v55, v55
    s_add_u32 m0, s54, s60
    s_add_u32 s39, s57, s60
    buffer_load_dwordx4 v156, s[40:43], s39 offen lds
    s_add_u32 m0, s55, s60
    s_add_u32 s39, s58, s60
    buffer_load_dwordx4 v156, s[40:43], s39 offen lds
    v_cvt_pk_bf16_f32 v82, v52, v53
    v_exp_f32 v56, v56
    v_exp_f32 v57, v57
    v_mfma_f32_32x32x16_bf16 v[96:111], v[40:43], v[88:91], v[96:111]
    v_cvt_pk_bf16_f32 v83, v54, v55
    v_exp_f32 v58, v58
    v_exp_f32 v59, v59
    v_cvt_pk_bf16_f32 v84, v56, v57
    v_exp_f32 v60, v60
    v_exp_f32 v61, v61
    v_mfma_f32_32x32x16_bf16 v[96:111], v[44:47], v[92:95], v[96:111]
    v_cvt_pk_bf16_f32 v85, v58, v59
    v_exp_f32 v62, v62
    v_exp_f32 v63, v63
    v_cvt_pk_bf16_f32 v86, v60, v61
    v_cvt_pk_bf16_f32 v87, v62, v63
    s_waitcnt lgkmcnt(0)
    v_exp_f32 v64, v64
    v_mfma_f32_32x32x16_bf16 v[48:63], v[16:19], v[8:11], 0
    v_exp_f32 v65, v65
    v_exp_f32 v66, v66
    ds_read_b128 v[24:27], v2 offset:3840
    ds_read_b64 v[28:29], v3 offset:3840
    s_mov_b64 exec, s[50:51]
    ds_read_b128 v[40:43], v4 offset:1280
    ds_read_b128 v[44:47], v4 offset:1920
    s_mov_b64 exec, -1
    v_exp_f32 v67, v67
    v_cvt_pk_bf16_f32 v88, v64, v65
    v_exp_f32 v68, v68
    v_exp_f32 v69, v69
    v_mfma_f32_32x32x16_bf16 v[48:63], v[20:23], v[12:15], v[48:63]
    v_cvt_pk_bf16_f32 v89, v66, v67
    v_exp_f32 v70, v70
    v_exp_f32 v71, v71
    s_add_u32 m0, s56, s60
    s_add_u32 s39, s59, s60
    buffer_load_dwordx4 v156, s[40:43], s39 offen lds
    s_add_u32 s60, s60, 10240
    s_cmp_ge_u32 s60, 81920
    s_cselect_b32 s60, 0x40000000, s60
    v_cvt_pk_bf16_f32 v90, v68, v69
    v_exp_f32 v72, v72
    v_exp_f32 v73, v73
    v_mfma_f32_32x32x16_bf16 v[96:111], v[32:35], v[80:83], v[96:111]
    v_cvt_pk_bf16_f32 v91, v70, v71
    v_exp_f32 v74, v74
    v_exp_f32 v75, v75
    v_cvt_pk_bf16_f32 v92, v72, v73
    v_exp_f32 v76, v76
    v_exp_f32 v77, v77
    v_mfma_f32_32x32x16_bf16 v[96:111], v[36:39], v[84:87], v[96:111]
    v_cvt_pk_bf16_f32 v93, v74, v75
    v_exp_f32 v78, v78
    v_exp_f32 v79, v79
    v_cvt_pk_bf16_f32 v94, v76, v77
    v_cvt_pk_bf16_f32 v95, v78, v79
    s_waitcnt lgkmcnt(0)
    v_exp_f32 v48, v48
    v_mfma_f32_32x32x16_bf16 v[64:79], v[24:27], v[8:11], 0
    v_exp_f32 v49, v49
    v_exp_f32 v50, v50
    ds_read_b128 v[16:19], v2 offset:5120
    ds_read_b64 v[20:21], v3 offset:5120
    s_mov_b64 exec, s[50:51]
    ds_read_b128 v[32:35], v4 offset:2560
    ds_read_b128 v[36:39], v4 offset:3200
    s_mov_b64 exec, -1
    v_exp_f32 v51, v51
    v_cvt_pk_bf16_f32 v80, v48, v49
    v_exp_f32 v52, v52
    v_exp_f32 v53, v53
    v_mfma_f32_32x32x16_bf16 v[64:79], v[28:31], v[12:15], v[64:79]
    v_cvt_pk_bf16_f32 v81, v50, v51
    v_exp_f32 v54, v54
    v_exp_f32 v55, v55
    v_cvt_pk_bf16_f32 v82, v52, v53
    v_exp_f32 v56, v56
    v_exp_f32 v57, v57
    v_mfma_f32_32x32x16_bf16 v[96:111], v[40:43], v[88:91], v[96:111]
    v_cvt_pk_bf16_f32 v83, v54, v55
    v_exp_f32 v58, v58
    v_exp_f32 v59, v59
    v_cvt_pk_bf16_f32 v84, v56, v57
    v_exp_f32 v60, v60
    v_exp_f32 v61, v61
    v_mfma_f32_32x32x16_bf16 v[96:111], v[44:47], v[92:95], v[96:111]
    v_cvt_pk_bf16_f32 v85, v58, v59
    v_exp_f32 v62, v62
    v_exp_f32 v63, v63
    v_cvt_pk_bf16_f32 v86, v60, v61
    v_cvt_pk_bf16_f32 v87, v62, v63
    s_waitcnt lgkmcnt(0)
    v_exp_f32 v64, v64
    v_mfma_f32_32x32x16_bf16 v[48:63], v[16:19], v[8:11], 0
    v_exp_f32 v65, v65
    v_exp_f32 v66, v66
    ds_read_b128 v[24:27], v2 offset:6400
    ds_read_b64 v[28:29], v3 offset:6400
    s_mov_b64 exec, s[50:51]
    ds_read_b128 v[40:43], v4 offset:3840
    ds_read_b128 v[44:47], v4 offset:4480
    s_mov_b64 exec, -1
    v_exp_f32 v67, v67
    v_cvt_pk_bf16_f32 v88, v64, v65
    v_exp_f32 v68, v68
    v_exp_f32 v69, v69
    v_mfma_f32_32x32x16_bf16 v[48:63], v[20:23], v[12:15], v[48:63]
    v_cvt_pk_bf16_f32 v89, v66, v67
    v_exp_f32 v70, v70
    v_exp_f32 v71, v71
    v_cvt_pk_bf16_f32 v90, v68, v69
    v_exp_f32 v72, v72
    v_exp_f32 v73, v73
    v_mfma_f32_32x32x16_bf16 v[96:111], v[32:35], v[80:83], v[96:111]
    v_cvt_pk_bf16_f32 v91, v70, v71
    v_exp_f32 v74, v74
    v_exp_f32 v75, v75
    v_cvt_pk_bf16_f32 v92, v72, v73
    v_exp_f32 v76, v76
    v_exp_f32 v77, v77
    v_mfma_f32_32x32x16_bf16 v[96:111], v[36:39], v[84:87], v[96:111]
    v_cvt_pk_bf16_f32 v93, v74, v75
    v_exp_f32 v78, v78
    v_exp_f32 v79, v79
    v_cvt_pk_bf16_f32 v94, v76, v77
    v_cvt_pk_bf16_f32 v95, v78, v79
    s_waitcnt lgkmcnt(0)
    v_exp_f32 v48, v48
    v_mfma_f32_32x32x16_bf16 v[64:79], v[24:27], v[8:11], 0
    v_exp_f32 v49, v49
    v_exp_f32 v50, v50
    ds_read_b128 v[16:19], v2 offset:7680
    ds_read_b64 v[20:21], v3 offset:7680
    s_mov_b64 exec, s[50:51]
    ds_read_b128 v[32:35], v4 offset:5120
    ds_read_b128 v[36:39], v4 offset:5760
    s_mov_b64 exec, -1
    v_exp_f32 v51, v51
    v_cvt_pk_bf16_f32 v80, v48, v49
    v_exp_f32 v52, v52
    v_exp_f32 v53, v53
    v_mfma_f32_32x32x16_bf16 v[64:79], v[28:31], v[12:15], v[64:79]
    v_cvt_pk_bf16_f32 v81, v50, v51
    v_exp_f32 v54, v54
    v_exp_f32 v55, v55
    s_add_u32 m0, s54, s60
    s_add_u32 s39, s57, s60
    buffer_load_dwordx4 v156, s[40:43], s39 offen lds
    s_add_u32 m0, s55, s60
    s_add_u32 s39, s58, s60
    buffer_load_dwordx4 v156, s[40:43], s39 offen lds
    v_cvt_pk_bf16_f32 v82, v52, v53
    v_exp_f32 v56, v56
    v_exp_f32 v57, v57
    v_mfma_f32_32x32x16_bf16 v[96:111], v[40:43], v[88:91], v[96:111]
    v_cvt_pk_bf16_f32 v83, v54, v55
    v_exp_f32 v58, v58
    v_exp_f32 v59, v59
    v_cvt_pk_bf16_f32 v84, v56, v57
    v_exp_f32 v60, v60
    v_exp_f32 v61, v61
    v_mfma_f32_32x32x16_bf16 v[96:111], v[44:47], v[92:95], v[96:111]
    v_cvt_pk_bf16_f32 v85, v58, v59
    v_exp_f32 v62, v62
    v_exp_f32 v63, v63
    v_cvt_pk_bf16_f32 v86, v60, v61
    v_cvt_pk_bf16_f32 v87, v62, v63
    s_waitcnt lgkmcnt(0)
    v_exp_f32 v64, v64
    v_mfma_f32_32x32x16_bf16 v[48:63], v[16:19], v[8:11], 0
    v_exp_f32 v65, v65
    v_exp_f32 v66, v66
    ds_read_b128 v[24:27], v2 offset:8960
    ds_read_b64 v[28:29], v3 offset:8960
    s_mov_b64 exec, s[50:51]
    ds_read_b128 v[40:43], v4 offset:6400
    ds_read_b128 v[44:47], v4 offset:7040
    s_mov_b64 exec, -1
    v_exp_f32 v67, v67
    v_cvt_pk_bf16_f32 v88, v64, v65
    v_exp_f32 v68, v68
    v_exp_f32 v69, v69
    v_mfma_f32_32x32x16_bf16 v[48:63], v[20:23], v[12:15], v[48:63]
    v_cvt_pk_bf16_f32 v89, v66, v67
    v_exp_f32 v70, v70
    v_exp_f32 v71, v71
    s_add_u32 m0, s56, s60
    s_add_u32 s39, s59, s60
    buffer_load_dwordx4 v156, s[40:43], s39 offen lds
    s_add_u32 s60, s60, 10240
    s_cmp_ge_u32 s60, 81920
    s_cselect_b32 s60, 0x40000000, s60
    v_cvt_pk_bf16_f32 v90, v68, v69
    v_exp_f32 v72, v72
    v_exp_f32 v73, v73
    v_mfma_f32_32x32x16_bf16 v[96:111], v[32:35], v[80:83], v[96:111]
    v_cvt_pk_bf16_f32 v91, v70, v71
    v_exp_f32 v74, v74
    v_exp_f32 v75, v75
    v_cvt_pk_bf16_f32 v92, v72, v73
    v_exp_f32 v76, v76
    v_exp_f32 v77, v77
    v_mfma_f32_32x32x16_bf16 v[96:111], v[36:39], v[84:87], v[96:111]
    v_cvt_pk_bf16_f32 v93, v74, v75
    v_exp_f32 v78, v78
    v_exp_f32 v79, v79
    v_cvt_pk_bf16_f32 v94, v76, v77
    v_cvt_pk_bf16_f32 v95, v78, v79
    s_waitcnt vmcnt(9)
    s_barrier
    s_waitcnt lgkmcnt(0)
    v_exp_f32 v48, v48
    v_mfma_f32_32x32x16_bf16 v[64:79], v[24:27], v[8:11], 0
    v_exp_f32 v49, v49
    v_exp_f32 v50, v50
    ds_read_b128 v[16:19], v2 offset:10240
    ds_read_b64 v[20:21], v3 offset:10240
    s_mov_b64 exec, s[50:51]
    ds_read_b128 v[32:35], v4 offset:7680
    ds_read_b128 v[36:39], v4 offset:8320
    s_mov_b64 exec, -1
    v_exp_f32 v51, v51
    v_cvt_pk_bf16_f32 v80, v48, v49
    v_exp_f32 v52, v52
    v_exp_f32 v53, v53
    v_mfma_f32_32x32x16_bf16 v[64:79], v[28:31], v[12:15], v[64:79]
    v_cvt_pk_bf16_f32 v81, v50, v51
    v_exp_f32 v54, v54
    v_exp_f32 v55, v55
    v_cvt_pk_bf16_f32 v82, v52, v53
    v_exp_f32 v56, v56
    v_exp_f32 v57, v57
    v_mfma_f32_32x32x16_bf16 v[96:111], v[40:43], v[88:91], v[96:111]
    v_cvt_pk_bf16_f32 v83, v54, v55
    v_exp_f32 v58, v58
    v_exp_f32 v59, v59
    v_cvt_pk_bf16_f32 v84, v56, v57
    v_exp_f32 v60, v60
    v_exp_f32 v61, v61
    v_mfma_f32_32x32x16_bf16 v[96:111], v[44:47], v[92:95], v[96:111]
    v_cvt_pk_bf16_f32 v85, v58, v59
    v_exp_f32 v62, v62
    v_exp_f32 v63, v63
    v_cvt_pk_bf16_f32 v86, v60, v61
    v_cvt_pk_bf16_f32 v87, v62, v63
    s_waitcnt lgkmcnt(0)
    v_exp_f32 v64, v64
    v_mfma_f32_32x32x16_bf16 v[48:63], v[16:19], v[8:11], 0
    v_exp_f32 v65, v65
    v_exp_f32 v66, v66
    ds_read_b128 v[24:27], v2 offset:11520
    ds_read_b64 v[28:29], v3 offset:11520
    s_mov_b64 exec, s[50:51]
    ds_read_b128 v[40:43], v4 offset:8960
    ds_read_b128 v[44:47], v4 offset:9600
    s_mov_b64 exec, -1
    v_exp_f32 v67, v67
    v_cvt_pk_bf16_f32 v88, v64, v65
    v_exp_f32 v68, v68
    v_exp_f32 v69, v69
    v_mfma_f32_32x32x16_bf16 v[48:63], v[20:23], v[12:15], v[48:63]
    v_cvt_pk_bf16_f32 v89, v66, v67
    v_exp_f32 v70, v70
    v_exp_f32 v71, v71
    v_cvt_pk_bf16_f32 v90, v68, v69
    v_exp_f32 v72, v72
    v_exp_f32 v73, v73
    v_mfma_f32_32x32x16_bf16 v[96:111], v[32:35], v[80:83], v[96:111]
    v_cvt_pk_bf16_f32 v91, v70, v71
    v_exp_f32 v74, v74
    v_exp_f32 v75, v75
    v_cvt_pk_bf16_f32 v92, v72, v73
    v_exp_f32 v76, v76
    v_exp_f32 v77, v77
    v_mfma_f32_32x32x16_bf16 v[96:111], v[36:39], v[84:87], v[96:111]
    v_cvt_pk_bf16_f32 v93, v74, v75
    v_exp_f32 v78, v78
    v_exp_f32 v79, v79
    v_cvt_pk_bf16_f32 v94, v76, v77
    v_cvt_pk_bf16_f32 v95, v78, v79
    v_add_u32 v2, 10240, v2
    v_add_u32 v3, 10240, v3
    v_add_u32 v4, 10240, v4
    s_waitcnt lgkmcnt(0)
    v_exp_f32 v48, v48
    v_mfma_f32_32x32x16_bf16 v[64:79], v[24:27], v[8:11], 0
    v_exp_f32 v49, v49
    v_exp_f32 v50, v50
    ds_read_b128 v[16:19], v2 offset:2560
    ds_read_b64 v[20:21], v3 offset:2560
    s_mov_b64 exec, s[50:51]
    ds_read_b128 v[32:35], v4 offset:0
    ds_read_b128 v[36:39], v4 offset:640
    s_mov_b64 exec, -1
    v_exp_f32 v51, v51
    v_cvt_pk_bf16_f32 v80, v48, v49
    v_exp_f32 v52, v52
    v_exp_f32 v53, v53
    v_mfma_f32_32x32x16_bf16 v[64:79], v[28:31], v[12:15], v[64:79]
    v_cvt_pk_bf16_f32 v81, v50, v51
    v_exp_f32 v54, v54
    v_exp_f32 v55, v55
    s_add_u32 m0, s54, s60
    s_add_u32 s39, s57, s60
    buffer_load_dwordx4 v156, s[40:43], s39 offen lds
    s_add_u32 m0, s55, s60
    s_add_u32 s39, s58, s60
    buffer_load_dwordx4 v156, s[40:43], s39 offen lds
    v_cvt_pk_bf16_f32 v82, v52, v53
    v_exp_f32 v56, v56
    v_exp_f32 v57, v57
    v_mfma_f32_32x32x16_bf16 v[96:111], v[40:43], v[88:91], v[96:111]
    v_cvt_pk_bf16_f32 v83, v54, v55
    v_exp_f32 v58, v58
    v_exp_f32 v59, v59
    v_cvt_pk_bf16_f32 v84, v56, v57
    v_exp_f32 v60, v60
    v_exp_f32 v61, v61
    v_mfma_f32_32x32x16_bf16 v[96:111], v[44:47], v[92:95], v[96:111]
    v_cvt_pk_bf16_f32 v85, v58, v59
    v_exp_f32 v62, v62
    v_exp_f32 v63, v63
    v_cvt_pk_bf16_f32 v86, v60, v61
    v_cvt_pk_bf16_f32 v87, v62, v63
    s_waitcnt lgkmcnt(0)
    v_exp_f32 v64, v64
    v_mfma_f32_32x32x16_bf16 v[48:63], v[16:19], v[8:11], 0
    v_exp_f32 v65, v65
    v_exp_f32 v66, v66
    ds_read_b128 v[24:27], v2 offset:3840
    ds_read_b64 v[28:29], v3 offset:3840
    s_mov_b64 exec, s[50:51]
    ds_read_b128 v[40:43], v4 offset:1280
    ds_read_b128 v[44:47], v4 offset:1920
    s_mov_b64 exec, -1
    v_exp_f32 v67, v67
    v_cvt_pk_bf16_f32 v88, v64, v65
    v_exp_f32 v68, v68
    v_exp_f32 v69, v69
    v_mfma_f32_32x32x16_bf16 v[48:63], v[20:23], v[12:15], v[48:63]
    v_cvt_pk_bf16_f32 v89, v66, v67
    v_exp_f32 v70, v70
    v_exp_f32 v71, v71
    s_add_u32 m0, s56, s60
    s_add_u32 s39, s59, s60
    buffer_load_dwordx4 v156, s[40:43], s39 offen lds
    s_add_u32 s60, s60, 10240
    s_cmp_ge_u32 s60, 81920
    s_cselect_b32 s60, 0x40000000, s60
    v_cvt_pk_bf16_f32 v90, v68, v69
    v_exp_f32 v72, v72
    v_exp_f32 v73, v73
    v_mfma_f32_32x32x16_bf16 v[96:111], v[32:35], v[80:83], v[96:111]
    v_cvt_pk_bf16_f32 v91, v70, v71
    v_exp_f32 v74, v74
    v_exp_f32 v75, v75
    v_cvt_pk_bf16_f32 v92, v72, v73
    v_exp_f32 v76, v76
    v_exp_f32 v77, v77
    v_mfma_f32_32x32x16_bf16 v[96:111], v[36:39], v[84:87], v[96:111]
    v_cvt_pk_bf16_f32 v93, v74, v75
    v_exp_f32 v78, v78
    v_exp_f32 v79, v79
    v_cvt_pk_bf16_f32 v94, v76, v77
    v_cvt_pk_bf16_f32 v95, v78, v79
    s_waitcnt lgkmcnt(0)
    v_exp_f32 v48, v48
    v_mfma_f32_32x32x16_bf16 v[64:79], v[24:27], v[8:11], 0
    v_exp_f32 v49, v49
    v_exp_f32 v50, v50
    ds_read_b128 v[16:19], v2 offset:5120
    ds_read_b64 v[20:21], v3 offset:5120
    s_mov_b64 exec, s[50:51]
    ds_read_b128 v[32:35], v4 offset:2560
    ds_read_b128 v[36:39], v4 offset:3200
    s_mov_b64 exec, -1
    v_exp_f32 v51, v51
    v_cvt_pk_bf16_f32 v80, v48, v49
    v_exp_f32 v52, v52
    v_exp_f32 v53, v53
    v_mfma_f32_32x32x16_bf16 v[64:79], v[28:31], v[12:15], v[64:79]
    v_cvt_pk_bf16_f32 v81, v50, v51
    v_exp_f32 v54, v54
    v_exp_f32 v55, v55
    s_add_u32 m0, s54, s60
    s_add_u32 s39, s57, s60
    buffer_load_dwordx4 v156, s[40:43], s39 offen lds
    s_add_u32 m0, s55, s60
    s_add_u32 s39, s58, s60
    buffer_load_dwordx4 v156, s[40:43], s39 offen lds
    v_cvt_pk_bf16_f32 v82, v52, v53
    v_exp_f32 v56, v56
    v_exp_f32 v57, v57
    v_mfma_f32_32x32x16_bf16 v[96:111], v[40:43], v[88:91], v[96:111]
    v_cvt_pk_bf16_f32 v83, v54, v55
    v_exp_f32 v58, v58
    v_exp_f32 v59, v59
    v_cvt_pk_bf16_f32 v84, v56, v57
    v_exp_f32 v60, v60
    v_exp_f32 v61, v61
    v_mfma_f32_32x32x16_bf16 v[96:111], v[44:47], v[92:95], v[96:111]
    v_cvt_pk_bf16_f32 v85, v58, v59
    v_exp_f32 v62, v62
    v_exp_f32 v63, v63
    v_cvt_pk_bf16_f32 v86, v60, v61
    v_cvt_pk_bf16_f32 v87, v62, v63
    s_waitcnt lgkmcnt(0)
    v_exp_f32 v64, v64
    v_mfma_f32_32x32x16_bf16 v[48:63], v[16:19], v[8:11], 0
    v_exp_f32 v65, v65
    v_exp_f32 v66, v66
    ds_read_b128 v[24:27], v2 offset:6400
    ds_read_b64 v[28:29], v3 offset:6400
    s_mov_b64 exec, s[50:51]
    ds_read_b128 v[40:43], v4 offset:3840
    ds_read_b128 v[44:47], v4 offset:4480
    s_mov_b64 exec, -1
    v_exp_f32 v67, v67
    v_cvt_pk_bf16_f32 v88, v64, v65
    v_exp_f32 v68, v68
    v_exp_f32 v69, v69
    v_mfma_f32_32x32x16_bf16 v[48:63], v[20:23], v[12:15], v[48:63]
    v_cvt_pk_bf16_f32 v89, v66, v67
    v_exp_f32 v70, v70
    v_exp_f32 v71, v71
    s_add_u32 m0, s56, s60
    s_add_u32 s39, s59, s60
    buffer_load_dwordx4 v156, s[40:43], s39 offen lds
    s_add_u32 s60, s60, 10240
    s_cmp_ge_u32 s60, 81920
    s_cselect_b32 s60, 0x40000000, s60
    v_cvt_pk_bf16_f32 v90, v68, v69
    v_exp_f32 v72, v72
    v_exp_f32 v73, v73
    v_mfma_f32_32x32x16_bf16 v[96:111], v[32:35], v[80:83], v[96:111]
    v_cvt_pk_bf16_f32 v91, v70, v71
    v_exp_f32 v74, v74
    v_exp_f32 v75, v75
    v_cvt_pk_bf16_f32 v92, v72, v73
    v_exp_f32 v76, v76
    v_exp_f32 v77, v77
    v_mfma_f32_32x32x16_bf16 v[96:111], v[36:39], v[84:87], v[96:111]
    v_cvt_pk_bf16_f32 v93, v74, v75
    v_exp_f32 v78, v78
    v_exp_f32 v79, v79
    v_cvt_pk_bf16_f32 v94, v76, v77
    v_cvt_pk_bf16_f32 v95, v78, v79
    s_waitcnt lgkmcnt(0)
    v_exp_f32 v48, v48
    v_mfma_f32_32x32x16_bf16 v[64:79], v[24:27], v[8:11], 0
    v_exp_f32 v49, v49
    v_exp_f32 v50, v50
    ds_read_b128 v[16:19], v2 offset:7680
    ds_read_b64 v[20:21], v3 offset:7680
    s_mov_b64 exec, s[50:51]
    ds_read_b128 v[32:35], v4 offset:5120
    ds_read_b128 v[36:39], v4 offset:5760
    s_mov_b64 exec, -1
    v_exp_f32 v51, v51
    v_cvt_pk_bf16_f32 v80, v48, v49
    v_exp_f32 v52, v52
    v_exp_f32 v53, v53
    v_mfma_f32_32x32x16_bf16 v[64:79], v[28:31], v[12:15], v[64:79]
    v_cvt_pk_bf16_f32 v81, v50, v51
    v_exp_f32 v54, v54
    v_exp_f32 v55, v55
    s_add_u32 m0, s54, s60
    s_add_u32 s39, s57, s60
    buffer_load_dwordx4 v156, s[40:43], s39 offen lds
    s_add_u32 m0, s55, s60
    s_add_u32 s39, s58, s60
    buffer_load_dwordx4 v156, s[40:43], s39 offen lds
    v_cvt_pk_bf16_f32 v82, v52, v53
    v_exp_f32 v56, v56
    v_exp_f32 v57, v57
    v_mfma_f32_32x32x16_bf16 v[96:111], v[40:43], v[88:91], v[96:111]
    v_cvt_pk_bf16_f32 v83, v54, v55
    v_exp_f32 v58, v58
    v_exp_f32 v59, v59
    v_cvt_pk_bf16_f32 v84, v56, v57
    v_exp_f32 v60, v60
    v_exp_f32 v61, v61
    v_mfma_f32_32x32x16_bf16 v[96:111], v[44:47], v[92:95], v[96:111]
    v_cvt_pk_bf16_f32 v85, v58, v59
    v_exp_f32 v62, v62
    v_exp_f32 v63, v63
    v_cvt_pk_bf16_f32 v86, v60, v61
    v_cvt_pk_bf16_f32 v87, v62, v63
    s_waitcnt lgkmcnt(0)
    v_exp_f32 v64, v64
    v_mfma_f32_32x32x16_bf16 v[48:63], v[16:19], v[8:11], 0
    v_exp_f32 v65, v65
    v_exp_f32 v66, v66
    ds_read_b128 v[24:27], v2 offset:8960
    ds_read_b64 v[28:29], v3 offset:8960
    s_mov_b64 exec, s[50:51]
    ds_read_b128 v[40:43], v4 offset:6400
    ds_read_b128 v[44:47], v4 offset:7040
    s_mov_b64 exec, -1
    v_exp_f32 v67, v67
    v_cvt_pk_bf16_f32 v88, v64, v65
    v_exp_f32 v68, v68
    v_exp_f32 v69, v69
    v_mfma_f32_32x32x16_bf16 v[48:63], v[20:23], v[12:15], v[48:63]
    v_cvt_pk_bf16_f32 v89, v66, v67
    v_exp_f32 v70, v70
    v_exp_f32 v71, v71
    s_add_u32 m0, s56, s60
    s_add_u32 s39, s59, s60
    buffer_load_dwordx4 v156, s[40:43], s39 offen lds
    s_add_u32 s60, s60, 10240
    s_cmp_ge_u32 s60, 81920
    s_cselect_b32 s60, 0x40000000, s60
    v_cvt_pk_bf16_f32 v90, v68, v69
    v_exp_f32 v72, v72
    v_exp_f32 v73, v73
    v_mfma_f32_32x32x16_bf16 v[96:111], v[32:35], v[80:83], v[96:111]
    v_cvt_pk_bf16_f32 v91, v70, v71
    v_exp_f32 v74, v74
    v_exp_f32 v75, v75
    v_cvt_pk_bf16_f32 v92, v72, v73
    v_exp_f32 v76, v76
    v_exp_f32 v77, v77
    v_mfma_f32_32x32x16_bf16 v[96:111], v[36:39], v[84:87], v[96:111]
    v_cvt_pk_bf16_f32 v93, v74, v75
    v_exp_f32 v78, v78
    v_exp_f32 v79, v79
    v_cvt_pk_bf16_f32 v94, v76, v77
    v_cvt_pk_bf16_f32 v95, v78, v79
    s_waitcnt vmcnt(15)
    s_barrier
    s_waitcnt lgkmcnt(0)
    v_exp_f32 v48, v48
    v_mfma_f32_32x32x16_bf16 v[64:79], v[24:27], v[8:11], 0
    v_exp_f32 v49, v49
    v_exp_f32 v50, v50
    ds_read_b128 v[16:19], v2 offset:10240
    ds_read_b64 v[20:21], v3 offset:10240
    s_mov_b64 exec, s[50:51]
    ds_read_b128 v[32:35], v4 offset:7680
    ds_read_b128 v[36:39], v4 offset:8320
    s_mov_b64 exec, -1
    v_exp_f32 v51, v51
    v_cvt_pk_bf16_f32 v80, v48, v49
    v_exp_f32 v52, v52
    v_exp_f32 v53, v53
    v_mfma_f32_32x32x16_bf16 v[64:79], v[28:31], v[12:15], v[64:79]
    v_cvt_pk_bf16_f32 v81, v50, v51
    v_exp_f32 v54, v54
    v_exp_f32 v55, v55
    v_cvt_pk_bf16_f32 v82, v52, v53
    v_exp_f32 v56, v56
    v_exp_f32 v57, v57
    v_mfma_f32_32x32x16_bf16 v[96:111], v[40:43], v[88:91], v[96:111]
    v_cvt_pk_bf16_f32 v83, v54, v55
    v_exp_f32 v58, v58
    v_exp_f32 v59, v59
    v_cvt_pk_bf16_f32 v84, v56, v57
    v_exp_f32 v60, v60
    v_exp_f32 v61, v61
    v_mfma_f32_32x32x16_bf16 v[96:111], v[44:47], v[92:95], v[96:111]
    v_cvt_pk_bf16_f32 v85, v58, v59
    v_exp_f32 v62, v62
    v_exp_f32 v63, v63
    v_cvt_pk_bf16_f32 v86, v60, v61
    v_cvt_pk_bf16_f32 v87, v62, v63
    s_waitcnt lgkmcnt(0)
    v_exp_f32 v64, v64
    v_mfma_f32_32x32x16_bf16 v[48:63], v[16:19], v[8:11], 0
    v_exp_f32 v65, v65
    v_exp_f32 v66, v66
    ds_read_b128 v[24:27], v2 offset:11520
    ds_read_b64 v[28:29], v3 offset:11520
    s_mov_b64 exec, s[50:51]
    ds_read_b128 v[40:43], v4 offset:8960
    ds_read_b128 v[44:47], v4 offset:9600
    s_mov_b64 exec, -1
    v_exp_f32 v67, v67
    v_cvt_pk_bf16_f32 v88, v64, v65
    v_exp_f32 v68, v68
    v_exp_f32 v69, v69
    v_mfma_f32_32x32x16_bf16 v[48:63], v[20:23], v[12:15], v[48:63]
    v_cvt_pk_bf16_f32 v89, v66, v67
    v_exp_f32 v70, v70
    v_exp_f32 v71, v71
    v_cvt_pk_bf16_f32 v90, v68, v69
    v_exp_f32 v72, v72
    v_exp_f32 v73, v73
    v_mfma_f32_32x32x16_bf16 v[96:111], v[32:35], v[80:83], v[96:111]
    v_cvt_pk_bf16_f32 v91, v70, v71
    v_exp_f32 v74, v74
    v_exp_f32 v75, v75
    v_cvt_pk_bf16_f32 v92, v72, v73
    v_exp_f32 v76, v76
    v_exp_f32 v77, v77
    v_mfma_f32_32x32x16_bf16 v[96:111], v[36:39], v[84:87], v[96:111]
    v_cvt_pk_bf16_f32 v93, v74, v75
    v_exp_f32 v78, v78
    v_exp_f32 v79, v79
    v_cvt_pk_bf16_f32 v94, v76, v77
    v_cvt_pk_bf16_f32 v95, v78, v79
    v_add_u32 v2, 10240, v2
    v_add_u32 v3, 10240, v3
    v_add_u32 v4, 10240, v4
    s_waitcnt lgkmcnt(0)
    v_exp_f32 v48, v48
    v_mfma_f32_32x32x16_bf16 v[64:79], v[24:27], v[8:11], 0
    v_exp_f32 v49, v49
    v_exp_f32 v50, v50
    ds_read_b128 v[16:19], v2 offset:2560
    ds_read_b64 v[20:21], v3 offset:2560
    s_mov_b64 exec, s[50:51]
    ds_read_b128 v[32:35], v4 offset:0
    ds_read_b128 v[36:39], v4 offset:640
    s_mov_b64 exec, -1
    v_exp_f32 v51, v51
    v_cvt_pk_bf16_f32 v80, v48, v49
    v_exp_f32 v52, v52
    v_exp_f32 v53, v53
    v_mfma_f32_32x32x16_bf16 v[64:79], v[28:31], v[12:15], v[64:79]
    v_cvt_pk_bf16_f32 v81, v50, v51
    v_exp_f32 v54, v54
    v_exp_f32 v55, v55
    v_cvt_pk_bf16_f32 v82, v52, v53
    v_exp_f32 v56, v56
    v_exp_f32 v57, v57
    v_mfma_f32_32x32x16_bf16 v[96:111], v[40:43], v[88:91], v[96:111]
    v_cvt_pk_bf16_f32 v83, v54, v55
    v_exp_f32 v58, v58
    v_exp_f32 v59, v59
    v_cvt_pk_bf16_f32 v84, v56, v57
    v_exp_f32 v60, v60
    v_exp_f32 v61, v61
    v_mfma_f32_32x32x16_bf16 v[96:111], v[44:47], v[92:95], v[96:111]
    v_cvt_pk_bf16_f32 v85, v58, v59
    v_exp_f32 v62, v62
    v_exp_f32 v63, v63
    v_cvt_pk_bf16_f32 v86, v60, v61
    v_cvt_pk_bf16_f32 v87, v62, v63
    s_waitcnt lgkmcnt(0)
    v_exp_f32 v64, v64
    v_mfma_f32_32x32x16_bf16 v[48:63], v[16:19], v[8:11], 0
    v_exp_f32 v65, v65
    v_exp_f32 v66, v66
    ds_read_b128 v[24:27], v2 offset:3840
    ds_read_b64 v[28:29], v3 offset:3840
    s_mov_b64 exec, s[50:51]
    ds_read_b128 v[40:43], v4 offset:1280
    ds_read_b128 v[44:47], v4 offset:1920
    s_mov_b64 exec, -1
    v_exp_f32 v67, v67
    v_cvt_pk_bf16_f32 v88, v64, v65
    v_exp_f32 v68, v68
    v_exp_f32 v69, v69
    v_mfma_f32_32x32x16_bf16 v[48:63], v[20:23], v[12:15], v[48:63]
    v_cvt_pk_bf16_f32 v89, v66, v67
    v_exp_f32 v70, v70
    v_exp_f32 v71, v71
    v_cvt_pk_bf16_f32 v90, v68, v69
    v_exp_f32 v72, v72
    v_exp_f32 v73, v73
    v_mfma_f32_32x32x16_bf16 v[96:111], v[32:35], v[80:83], v[96:111]
    v_cvt_pk_bf16_f32 v91, v70, v71
    v_exp_f32 v74, v74
    v_exp_f32 v75, v75
    v_cvt_pk_bf16_f32 v92, v72, v73
    v_exp_f32 v76, v76
    v_exp_f32 v77, v77
    v_mfma_f32_32x32x16_bf16 v[96:111], v[36:39], v[84:87], v[96:111]
    v_cvt_pk_bf16_f32 v93, v74, v75
    v_exp_f32 v78, v78
    v_exp_f32 v79, v79
    v_cvt_pk_bf16_f32 v94, v76, v77
    v_cvt_pk_bf16_f32 v95, v78, v79
    s_mov_b32 s68, s62
    s_mov_b32 s69, s63
    s_mov_b32 s70, 1966080
    s_mov_b32 s71, 0x00020000
    buffer_load_dwordx4 v[128:131], v144, s[68:71], 0 offen
    s_mov_b32 s68, s64
    s_mov_b32 s69, s65
    s_mov_b32 s70, 1966080
    s_mov_b32 s71, 0x00020000
    buffer_load_dwordx4 v[132:135], v145, s[68:71], 0 offen
    s_mov_b32 s68, s16
    s_mov_b32 s69, s17
    s_mov_b32 s70, 1966080
    s_mov_b32 s71, 0x00020000
    buffer_load_dwordx4 v[136:139], v146, s[68:71], 0 offen
    s_mov_b32 s68, s8
    s_mov_b32 s69, s9
    s_mov_b32 s70, 819200
    s_mov_b32 s71, 0x00020000
    buffer_load_dwordx4 v[140:143], v147, s[68:71], 0 offen
    s_waitcnt lgkmcnt(0)
    v_exp_f32 v48, v48
    v_mfma_f32_32x32x16_bf16 v[64:79], v[24:27], v[8:11], 0
    v_exp_f32 v49, v49
    v_exp_f32 v50, v50
    ds_read_b128 v[16:19], v2 offset:5120
    ds_read_b64 v[20:21], v3 offset:5120
    s_mov_b64 exec, s[50:51]
    ds_read_b128 v[32:35], v4 offset:2560
    ds_read_b128 v[36:39], v4 offset:3200
    s_mov_b64 exec, -1
    v_exp_f32 v51, v51
    v_cvt_pk_bf16_f32 v80, v48, v49
    v_exp_f32 v52, v52
    v_exp_f32 v53, v53
    v_mfma_f32_32x32x16_bf16 v[64:79], v[28:31], v[12:15], v[64:79]
    v_cvt_pk_bf16_f32 v81, v50, v51
    v_exp_f32 v54, v54
    v_exp_f32 v55, v55
    v_cvt_pk_bf16_f32 v82, v52, v53
    v_exp_f32 v56, v56
    v_exp_f32 v57, v57
    v_mfma_f32_32x32x16_bf16 v[96:111], v[40:43], v[88:91], v[96:111]
    v_cvt_pk_bf16_f32 v83, v54, v55
    v_exp_f32 v58, v58
    v_exp_f32 v59, v59
    v_cvt_pk_bf16_f32 v84, v56, v57
    v_exp_f32 v60, v60
    v_exp_f32 v61, v61
    v_mfma_f32_32x32x16_bf16 v[96:111], v[44:47], v[92:95], v[96:111]
    v_cvt_pk_bf16_f32 v85, v58, v59
    v_exp_f32 v62, v62
    v_exp_f32 v63, v63
    v_cvt_pk_bf16_f32 v86, v60, v61
    v_cvt_pk_bf16_f32 v87, v62, v63
    s_waitcnt lgkmcnt(0)
    v_exp_f32 v64, v64
    v_mfma_f32_32x32x16_bf16 v[48:63], v[16:19], v[8:11], 0
    v_exp_f32 v65, v65
    v_exp_f32 v66, v66
    ds_read_b128 v[24:27], v2 offset:6400
    ds_read_b64 v[28:29], v3 offset:6400
    s_mov_b64 exec, s[50:51]
    ds_read_b128 v[40:43], v4 offset:3840
    ds_read_b128 v[44:47], v4 offset:4480
    s_mov_b64 exec, -1
    v_exp_f32 v67, v67
    v_cvt_pk_bf16_f32 v88, v64, v65
    v_exp_f32 v68, v68
    v_exp_f32 v69, v69
    v_mfma_f32_32x32x16_bf16 v[48:63], v[20:23], v[12:15], v[48:63]
    v_cvt_pk_bf16_f32 v89, v66, v67
    v_exp_f32 v70, v70
    v_exp_f32 v71, v71
    v_cvt_pk_bf16_f32 v90, v68, v69
    v_exp_f32 v72, v72
    v_exp_f32 v73, v73
    v_mfma_f32_32x32x16_bf16 v[96:111], v[32:35], v[80:83], v[96:111]
    v_cvt_pk_bf16_f32 v91, v70, v71
    v_exp_f32 v74, v74
    v_exp_f32 v75, v75
    v_cvt_pk_bf16_f32 v92, v72, v73
    v_exp_f32 v76, v76
    v_exp_f32 v77, v77
    v_mfma_f32_32x32x16_bf16 v[96:111], v[36:39], v[84:87], v[96:111]
    v_cvt_pk_bf16_f32 v93, v74, v75
    v_exp_f32 v78, v78
    v_exp_f32 v79, v79
    v_cvt_pk_bf16_f32 v94, v76, v77
    v_cvt_pk_bf16_f32 v95, v78, v79
    s_waitcnt lgkmcnt(0)
    v_exp_f32 v48, v48
    v_mfma_f32_32x32x16_bf16 v[64:79], v[24:27], v[8:11], 0
    v_exp_f32 v49, v49
    v_exp_f32 v50, v50
    ds_read_b128 v[16:19], v2 offset:7680
    ds_read_b64 v[20:21], v3 offset:7680
    s_mov_b64 exec, s[50:51]
    ds_read_b128 v[32:35], v4 offset:5120
    ds_read_b128 v[36:39], v4 offset:5760
    s_mov_b64 exec, -1
    v_exp_f32 v51, v51
    v_cvt_pk_bf16_f32 v80, v48, v49
    v_exp_f32 v52, v52
    v_exp_f32 v53, v53
    v_mfma_f32_32x32x16_bf16 v[64:79], v[28:31], v[12:15], v[64:79]
    v_cvt_pk_bf16_f32 v81, v50, v51
    v_exp_f32 v54, v54
    v_exp_f32 v55, v55
    v_cvt_pk_bf16_f32 v82, v52, v53
    v_exp_f32 v56, v56
    v_exp_f32 v57, v57
    v_mfma_f32_32x32x16_bf16 v[96:111], v[40:43], v[88:91], v[96:111]
    v_cvt_pk_bf16_f32 v83, v54, v55
    v_exp_f32 v58, v58
    v_exp_f32 v59, v59
    v_cvt_pk_bf16_f32 v84, v56, v57
    v_exp_f32 v60, v60
    v_exp_f32 v61, v61
    v_mfma_f32_32x32x16_bf16 v[96:111], v[44:47], v[92:95], v[96:111]
    v_cvt_pk_bf16_f32 v85, v58, v59
    v_exp_f32 v62, v62
    v_exp_f32 v63, v63
    v_cvt_pk_bf16_f32 v86, v60, v61
    v_cvt_pk_bf16_f32 v87, v62, v63
    s_waitcnt lgkmcnt(0)
    v_exp_f32 v64, v64
    v_mfma_f32_32x32x16_bf16 v[48:63], v[16:19], v[8:11], 0
    v_exp_f32 v65, v65
    v_exp_f32 v66, v66
    ds_read_b128 v[24:27], v2 offset:8960
    ds_read_b64 v[28:29], v3 offset:8960
    s_mov_b64 exec, s[50:51]
    ds_read_b128 v[40:43], v4 offset:6400
    ds_read_b128 v[44:47], v4 offset:7040
    s_mov_b64 exec, -1
    v_exp_f32 v67, v67
    v_cvt_pk_bf16_f32 v88, v64, v65
    v_exp_f32 v68, v68
    v_exp_f32 v69, v69
    v_mfma_f32_32x32x16_bf16 v[48:63], v[20:23], v[12:15], v[48:63]
    v_cvt_pk_bf16_f32 v89, v66, v67
    v_exp_f32 v70, v70
    v_exp_f32 v71, v71
    v_cvt_pk_bf16_f32 v90, v68, v69
    v_exp_f32 v72, v72
    v_exp_f32 v73, v73
    v_mfma_f32_32x32x16_bf16 v[96:111], v[32:35], v[80:83], v[96:111]
    v_cvt_pk_bf16_f32 v91, v70, v71
    v_exp_f32 v74, v74
    v_exp_f32 v75, v75
    v_cvt_pk_bf16_f32 v92, v72, v73
    v_exp_f32 v76, v76
    v_exp_f32 v77, v77
    v_mfma_f32_32x32x16_bf16 v[96:111], v[36:39], v[84:87], v[96:111]
    v_cvt_pk_bf16_f32 v93, v74, v75
    v_exp_f32 v78, v78
    v_exp_f32 v79, v79
    v_cvt_pk_bf16_f32 v94, v76, v77
    v_cvt_pk_bf16_f32 v95, v78, v79
    s_waitcnt vmcnt(13)
    s_barrier
    s_waitcnt lgkmcnt(0)
    v_exp_f32 v48, v48
    v_mfma_f32_32x32x16_bf16 v[64:79], v[24:27], v[8:11], 0
    v_exp_f32 v49, v49
    v_exp_f32 v50, v50
    ds_read_b128 v[16:19], v2 offset:10240
    ds_read_b64 v[20:21], v3 offset:10240
    s_mov_b64 exec, s[50:51]
    ds_read_b128 v[32:35], v4 offset:7680
    ds_read_b128 v[36:39], v4 offset:8320
    s_mov_b64 exec, -1
    v_exp_f32 v51, v51
    v_cvt_pk_bf16_f32 v80, v48, v49
    v_exp_f32 v52, v52
    v_exp_f32 v53, v53
    v_mfma_f32_32x32x16_bf16 v[64:79], v[28:31], v[12:15], v[64:79]
    v_cvt_pk_bf16_f32 v81, v50, v51
    v_exp_f32 v54, v54
    v_exp_f32 v55, v55
    v_cvt_pk_bf16_f32 v82, v52, v53
    v_exp_f32 v56, v56
    v_exp_f32 v57, v57
    v_mfma_f32_32x32x16_bf16 v[96:111], v[40:43], v[88:91], v[96:111]
    v_cvt_pk_bf16_f32 v83, v54, v55
    v_exp_f32 v58, v58
    v_exp_f32 v59, v59
    v_cvt_pk_bf16_f32 v84, v56, v57
    v_exp_f32 v60, v60
    v_exp_f32 v61, v61
    v_mfma_f32_32x32x16_bf16 v[96:111], v[44:47], v[92:95], v[96:111]
    v_cvt_pk_bf16_f32 v85, v58, v59
    v_exp_f32 v62, v62
    v_exp_f32 v63, v63
    v_cvt_pk_bf16_f32 v86, v60, v61
    v_cvt_pk_bf16_f32 v87, v62, v63
    s_waitcnt lgkmcnt(0)
    v_exp_f32 v64, v64
    v_mfma_f32_32x32x16_bf16 v[48:63], v[16:19], v[8:11], 0
    v_exp_f32 v65, v65
    v_exp_f32 v66, v66
    ds_read_b128 v[24:27], v2 offset:11520
    ds_read_b64 v[28:29], v3 offset:11520
    s_mov_b64 exec, s[50:51]
    ds_read_b128 v[40:43], v4 offset:8960
    ds_read_b128 v[44:47], v4 offset:9600
    s_mov_b64 exec, -1
    v_exp_f32 v67, v67
    v_cvt_pk_bf16_f32 v88, v64, v65
    v_exp_f32 v68, v68
    v_exp_f32 v69, v69
    v_mfma_f32_32x32x16_bf16 v[48:63], v[20:23], v[12:15], v[48:63]
    v_cvt_pk_bf16_f32 v89, v66, v67
    v_exp_f32 v70, v70
    v_exp_f32 v71, v71
    v_cvt_pk_bf16_f32 v90, v68, v69
    v_exp_f32 v72, v72
    v_exp_f32 v73, v73
    v_mfma_f32_32x32x16_bf16 v[96:111], v[32:35], v[80:83], v[96:111]
    v_cvt_pk_bf16_f32 v91, v70, v71
    v_exp_f32 v74, v74
    v_exp_f32 v75, v75
    v_cvt_pk_bf16_f32 v92, v72, v73
    v_exp_f32 v76, v76
    v_exp_f32 v77, v77
    v_mfma_f32_32x32x16_bf16 v[96:111], v[36:39], v[84:87], v[96:111]
    v_cvt_pk_bf16_f32 v93, v74, v75
    v_exp_f32 v78, v78
    v_exp_f32 v79, v79
    v_cvt_pk_bf16_f32 v94, v76, v77
    v_cvt_pk_bf16_f32 v95, v78, v79
    v_add_u32 v2, 10240, v2
    v_add_u32 v3, 10240, v3
    v_add_u32 v4, 10240, v4
    s_waitcnt lgkmcnt(0)
    v_exp_f32 v48, v48
    v_mfma_f32_32x32x16_bf16 v[64:79], v[24:27], v[8:11], 0
    v_exp_f32 v49, v49
    v_exp_f32 v50, v50
    ds_read_b128 v[16:19], v2 offset:2560
    ds_read_b64 v[20:21], v3 offset:2560
    s_mov_b64 exec, s[50:51]
    ds_read_b128 v[32:35], v4 offset:0
    ds_read_b128 v[36:39], v4 offset:640
    s_mov_b64 exec, -1
    v_exp_f32 v51, v51
    v_cvt_pk_bf16_f32 v80, v48, v49
    v_exp_f32 v52, v52
    v_exp_f32 v53, v53
    v_mfma_f32_32x32x16_bf16 v[64:79], v[28:31], v[12:15], v[64:79]
    v_cvt_pk_bf16_f32 v81, v50, v51
    v_exp_f32 v54, v54
    v_exp_f32 v55, v55
    v_cvt_pk_bf16_f32 v82, v52, v53
    v_exp_f32 v56, v56
    v_exp_f32 v57, v57
    v_mfma_f32_32x32x16_bf16 v[96:111], v[40:43], v[88:91], v[96:111]
    v_cvt_pk_bf16_f32 v83, v54, v55
    v_exp_f32 v58, v58
    v_exp_f32 v59, v59
    v_cvt_pk_bf16_f32 v84, v56, v57
    v_exp_f32 v60, v60
    v_exp_f32 v61, v61
    v_mfma_f32_32x32x16_bf16 v[96:111], v[44:47], v[92:95], v[96:111]
    v_cvt_pk_bf16_f32 v85, v58, v59
    v_exp_f32 v62, v62
    v_exp_f32 v63, v63
    v_cvt_pk_bf16_f32 v86, v60, v61
    v_cvt_pk_bf16_f32 v87, v62, v63
    s_waitcnt lgkmcnt(0)
    v_exp_f32 v64, v64
    v_mfma_f32_32x32x16_bf16 v[48:63], v[16:19], v[8:11], 0
    v_exp_f32 v65, v65
    v_exp_f32 v66, v66
    ds_read_b128 v[24:27], v2 offset:3840
    ds_read_b64 v[28:29], v3 offset:3840
    s_mov_b64 exec, s[50:51]
    ds_read_b128 v[40:43], v4 offset:1280
    ds_read_b128 v[44:47], v4 offset:1920
    s_mov_b64 exec, -1
    v_exp_f32 v67, v67
    v_cvt_pk_bf16_f32 v88, v64, v65
    v_exp_f32 v68, v68
    v_exp_f32 v69, v69
    v_mfma_f32_32x32x16_bf16 v[48:63], v[20:23], v[12:15], v[48:63]
    v_cvt_pk_bf16_f32 v89, v66, v67
    v_exp_f32 v70, v70
    v_exp_f32 v71, v71
    v_cvt_pk_bf16_f32 v90, v68, v69
    v_exp_f32 v72, v72
    v_exp_f32 v73, v73
    v_mfma_f32_32x32x16_bf16 v[96:111], v[32:35], v[80:83], v[96:111]
    v_cvt_pk_bf16_f32 v91, v70, v71
    v_exp_f32 v74, v74
    v_exp_f32 v75, v75
    v_cvt_pk_bf16_f32 v92, v72, v73
    v_exp_f32 v76, v76
    v_exp_f32 v77, v77
    v_mfma_f32_32x32x16_bf16 v[96:111], v[36:39], v[84:87], v[96:111]
    v_cvt_pk_bf16_f32 v93, v74, v75
    v_exp_f32 v78, v78
    v_exp_f32 v79, v79
    v_cvt_pk_bf16_f32 v94, v76, v77
    v_cvt_pk_bf16_f32 v95, v78, v79
    s_waitcnt lgkmcnt(0)
    v_exp_f32 v48, v48
    v_mfma_f32_32x32x16_bf16 v[64:79], v[24:27], v[8:11], 0
    v_exp_f32 v49, v49
    v_exp_f32 v50, v50
    ds_read_b128 v[16:19], v2 offset:5120
    ds_read_b64 v[20:21], v3 offset:5120
    s_mov_b64 exec, s[50:51]
    ds_read_b128 v[32:35], v4 offset:2560
    ds_read_b128 v[36:39], v4 offset:3200
    s_mov_b64 exec, -1
    v_exp_f32 v51, v51
    v_cvt_pk_bf16_f32 v80, v48, v49
    v_exp_f32 v52, v52
    v_exp_f32 v53, v53
    v_mfma_f32_32x32x16_bf16 v[64:79], v[28:31], v[12:15], v[64:79]
    v_cvt_pk_bf16_f32 v81, v50, v51
    v_exp_f32 v54, v54
    v_exp_f32 v55, v55
    v_cvt_pk_bf16_f32 v82, v52, v53
    v_exp_f32 v56, v56
    v_exp_f32 v57, v57
    v_mfma_f32_32x32x16_bf16 v[96:111], v[40:43], v[88:91], v[96:111]
    v_cvt_pk_bf16_f32 v83, v54, v55
    v_exp_f32 v58, v58
    v_exp_f32 v59, v59
    v_cvt_pk_bf16_f32 v84, v56, v57
    v_exp_f32 v60, v60
    v_exp_f32 v61, v61
    v_mfma_f32_32x32x16_bf16 v[96:111], v[44:47], v[92:95], v[96:111]
    v_cvt_pk_bf16_f32 v85, v58, v59
    v_exp_f32 v62, v62
    v_exp_f32 v63, v63
    v_cvt_pk_bf16_f32 v86, v60, v61
    v_cvt_pk_bf16_f32 v87, v62, v63
    s_waitcnt lgkmcnt(0)
    v_exp_f32 v64, v64
    v_mfma_f32_32x32x16_bf16 v[48:63], v[16:19], v[8:11], 0
    v_exp_f32 v65, v65
    v_exp_f32 v66, v66
    ds_read_b128 v[24:27], v2 offset:6400
    ds_read_b64 v[28:29], v3 offset:6400
    s_mov_b64 exec, s[50:51]
    ds_read_b128 v[40:43], v4 offset:3840
    ds_read_b128 v[44:47], v4 offset:4480
    s_mov_b64 exec, -1
    v_exp_f32 v67, v67
    v_cvt_pk_bf16_f32 v88, v64, v65
    v_exp_f32 v68, v68
    v_exp_f32 v69, v69
    v_mfma_f32_32x32x16_bf16 v[48:63], v[20:23], v[12:15], v[48:63]
    v_cvt_pk_bf16_f32 v89, v66, v67
    v_exp_f32 v70, v70
    v_exp_f32 v71, v71
    v_cvt_pk_bf16_f32 v90, v68, v69
    v_exp_f32 v72, v72
    v_exp_f32 v73, v73
    v_mfma_f32_32x32x16_bf16 v[96:111], v[32:35], v[80:83], v[96:111]
    v_cvt_pk_bf16_f32 v91, v70, v71
    v_exp_f32 v74, v74
    v_exp_f32 v75, v75
    v_cvt_pk_bf16_f32 v92, v72, v73
    v_exp_f32 v76, v76
    v_exp_f32 v77, v77
    v_mfma_f32_32x32x16_bf16 v[96:111], v[36:39], v[84:87], v[96:111]
    v_cvt_pk_bf16_f32 v93, v74, v75
    v_exp_f32 v78, v78
    v_exp_f32 v79, v79
    v_cvt_pk_bf16_f32 v94, v76, v77
    v_cvt_pk_bf16_f32 v95, v78, v79
    s_waitcnt vmcnt(0)
    s_add_u32 s68, s20, 19816448
    s_addc_u32 s69, s21, 0
    s_mov_b32 s70, 6717440
    s_mov_b32 s71, 0x00020000
    buffer_store_dwordx4 v[128:131], v156, s[68:71], s32 offen sc1
    buffer_store_dwordx4 v[132:135], v156, s[68:71], s33 offen sc1
    buffer_store_dwordx4 v[136:139], v156, s[68:71], s49 offen sc1
    buffer_store_dwordx4 v[140:143], v156, s[68:71], s53 offen sc1
    s_waitcnt lgkmcnt(0)
    v_exp_f32 v48, v48
    v_mfma_f32_32x32x16_bf16 v[64:79], v[24:27], v[8:11], 0
    v_exp_f32 v49, v49
    v_exp_f32 v50, v50
    ds_read_b128 v[16:19], v2 offset:7680
    ds_read_b64 v[20:21], v3 offset:7680
    s_mov_b64 exec, s[50:51]
    ds_read_b128 v[32:35], v4 offset:5120
    ds_read_b128 v[36:39], v4 offset:5760
    s_mov_b64 exec, -1
    v_exp_f32 v51, v51
    v_cvt_pk_bf16_f32 v80, v48, v49
    v_exp_f32 v52, v52
    v_exp_f32 v53, v53
    v_mfma_f32_32x32x16_bf16 v[64:79], v[28:31], v[12:15], v[64:79]
    v_cvt_pk_bf16_f32 v81, v50, v51
    v_exp_f32 v54, v54
    v_exp_f32 v55, v55
    v_cvt_pk_bf16_f32 v82, v52, v53
    v_exp_f32 v56, v56
    v_exp_f32 v57, v57
    v_mfma_f32_32x32x16_bf16 v[96:111], v[40:43], v[88:91], v[96:111]
    v_cvt_pk_bf16_f32 v83, v54, v55
    v_exp_f32 v58, v58
    v_exp_f32 v59, v59
    v_cvt_pk_bf16_f32 v84, v56, v57
    v_exp_f32 v60, v60
    v_exp_f32 v61, v61
    v_mfma_f32_32x32x16_bf16 v[96:111], v[44:47], v[92:95], v[96:111]
    v_cvt_pk_bf16_f32 v85, v58, v59
    v_exp_f32 v62, v62
    v_exp_f32 v63, v63
    v_cvt_pk_bf16_f32 v86, v60, v61
    v_cvt_pk_bf16_f32 v87, v62, v63
    s_waitcnt lgkmcnt(0)
    v_exp_f32 v64, v64
    v_mfma_f32_32x32x16_bf16 v[48:63], v[16:19], v[8:11], 0
    v_exp_f32 v65, v65
    v_exp_f32 v66, v66
    ds_read_b128 v[24:27], v2 offset:8960
    ds_read_b64 v[28:29], v3 offset:8960
    s_mov_b64 exec, s[50:51]
    ds_read_b128 v[40:43], v4 offset:6400
    ds_read_b128 v[44:47], v4 offset:7040
    s_mov_b64 exec, -1
    v_exp_f32 v67, v67
    v_cvt_pk_bf16_f32 v88, v64, v65
    v_exp_f32 v68, v68
    v_exp_f32 v69, v69
    v_mfma_f32_32x32x16_bf16 v[48:63], v[20:23], v[12:15], v[48:63]
    v_cvt_pk_bf16_f32 v89, v66, v67
    v_exp_f32 v70, v70
    v_exp_f32 v71, v71
    v_cvt_pk_bf16_f32 v90, v68, v69
    v_exp_f32 v72, v72
    v_exp_f32 v73, v73
    v_mfma_f32_32x32x16_bf16 v[96:111], v[32:35], v[80:83], v[96:111]
    v_cvt_pk_bf16_f32 v91, v70, v71
    v_exp_f32 v74, v74
    v_exp_f32 v75, v75
    v_cvt_pk_bf16_f32 v92, v72, v73
    v_exp_f32 v76, v76
    v_exp_f32 v77, v77
    v_mfma_f32_32x32x16_bf16 v[96:111], v[36:39], v[84:87], v[96:111]
    v_cvt_pk_bf16_f32 v93, v74, v75
    v_exp_f32 v78, v78
    v_exp_f32 v79, v79
    v_cvt_pk_bf16_f32 v94, v76, v77
    v_cvt_pk_bf16_f32 v95, v78, v79
    s_waitcnt lgkmcnt(0)
    v_exp_f32 v48, v48
    v_mfma_f32_32x32x16_bf16 v[64:79], v[24:27], v[8:11], 0
    v_exp_f32 v49, v49
    v_exp_f32 v50, v50
    ds_read_b128 v[16:19], v2 offset:10240
    ds_read_b64 v[20:21], v3 offset:10240
    s_mov_b64 exec, s[50:51]
    ds_read_b128 v[32:35], v4 offset:7680
    ds_read_b128 v[36:39], v4 offset:8320
    s_mov_b64 exec, -1
    v_exp_f32 v51, v51
    v_cvt_pk_bf16_f32 v80, v48, v49
    v_exp_f32 v52, v52
    v_exp_f32 v53, v53
    v_mfma_f32_32x32x16_bf16 v[64:79], v[28:31], v[12:15], v[64:79]
    v_cvt_pk_bf16_f32 v81, v50, v51
    v_exp_f32 v54, v54
    v_exp_f32 v55, v55
    v_cvt_pk_bf16_f32 v82, v52, v53
    v_exp_f32 v56, v56
    v_exp_f32 v57, v57
    v_mfma_f32_32x32x16_bf16 v[96:111], v[40:43], v[88:91], v[96:111]
    v_cvt_pk_bf16_f32 v83, v54, v55
    v_exp_f32 v58, v58
    v_exp_f32 v59, v59
    v_cvt_pk_bf16_f32 v84, v56, v57
    v_exp_f32 v60, v60
    v_exp_f32 v61, v61
    v_mfma_f32_32x32x16_bf16 v[96:111], v[44:47], v[92:95], v[96:111]
    v_cvt_pk_bf16_f32 v85, v58, v59
    v_exp_f32 v62, v62
    v_exp_f32 v63, v63
    v_cvt_pk_bf16_f32 v86, v60, v61
    v_cvt_pk_bf16_f32 v87, v62, v63
    s_waitcnt lgkmcnt(0)
    v_exp_f32 v64, v64
    v_mfma_f32_32x32x16_bf16 v[48:63], v[16:19], v[8:11], 0
    v_exp_f32 v65, v65
    v_exp_f32 v66, v66
    ds_read_b128 v[24:27], v2 offset:11520
    ds_read_b64 v[28:29], v3 offset:11520
    s_mov_b64 exec, s[50:51]
    ds_read_b128 v[40:43], v4 offset:8960
    ds_read_b128 v[44:47], v4 offset:9600
    s_mov_b64 exec, -1
    v_exp_f32 v67, v67
    v_cvt_pk_bf16_f32 v88, v64, v65
    v_exp_f32 v68, v68
    v_exp_f32 v69, v69
    v_mfma_f32_32x32x16_bf16 v[48:63], v[20:23], v[12:15], v[48:63]
    v_cvt_pk_bf16_f32 v89, v66, v67
    v_exp_f32 v70, v70
    v_exp_f32 v71, v71
    v_cvt_pk_bf16_f32 v90, v68, v69
    v_exp_f32 v72, v72
    v_exp_f32 v73, v73
    v_mfma_f32_32x32x16_bf16 v[96:111], v[32:35], v[80:83], v[96:111]
    v_cvt_pk_bf16_f32 v91, v70, v71
    v_exp_f32 v74, v74
    v_exp_f32 v75, v75
    v_cvt_pk_bf16_f32 v92, v72, v73
    v_exp_f32 v76, v76
    v_exp_f32 v77, v77
    v_mfma_f32_32x32x16_bf16 v[96:111], v[36:39], v[84:87], v[96:111]
    v_cvt_pk_bf16_f32 v93, v74, v75
    v_exp_f32 v78, v78
    v_exp_f32 v79, v79
    v_cvt_pk_bf16_f32 v94, v76, v77
    v_cvt_pk_bf16_f32 v95, v78, v79
    v_add_u32 v2, 10240, v2
    v_add_u32 v3, 10240, v3
    v_add_u32 v4, 10240, v4
    s_waitcnt lgkmcnt(0)
    v_exp_f32 v48, v48
    v_mfma_f32_32x32x16_bf16 v[64:79], v[24:27], v[8:11], 0
    v_exp_f32 v49, v49
    v_exp_f32 v50, v50
    ds_read_b128 v[16:19], v2 offset:2560
    ds_read_b64 v[20:21], v3 offset:2560
    s_mov_b64 exec, s[50:51]
    ds_read_b128 v[32:35], v4 offset:0
    ds_read_b128 v[36:39], v4 offset:640
    s_mov_b64 exec, -1
    v_exp_f32 v51, v51
    v_cvt_pk_bf16_f32 v80, v48, v49
    v_exp_f32 v52, v52
    v_exp_f32 v53, v53
    v_mfma_f32_32x32x16_bf16 v[64:79], v[28:31], v[12:15], v[64:79]
    v_cvt_pk_bf16_f32 v81, v50, v51
    v_exp_f32 v54, v54
    v_exp_f32 v55, v55
    v_cvt_pk_bf16_f32 v82, v52, v53
    v_exp_f32 v56, v56
    v_exp_f32 v57, v57
    v_mfma_f32_32x32x16_bf16 v[96:111], v[40:43], v[88:91], v[96:111]
    v_cvt_pk_bf16_f32 v83, v54, v55
    v_exp_f32 v58, v58
    v_exp_f32 v59, v59
    v_cvt_pk_bf16_f32 v84, v56, v57
    v_exp_f32 v60, v60
    v_exp_f32 v61, v61
    v_mfma_f32_32x32x16_bf16 v[96:111], v[44:47], v[92:95], v[96:111]
    v_cvt_pk_bf16_f32 v85, v58, v59
    v_exp_f32 v62, v62
    v_exp_f32 v63, v63
    v_cvt_pk_bf16_f32 v86, v60, v61
    v_cvt_pk_bf16_f32 v87, v62, v63
    s_waitcnt lgkmcnt(0)
    v_exp_f32 v64, v64
    v_mfma_f32_32x32x16_bf16 v[48:63], v[16:19], v[8:11], 0
    v_exp_f32 v65, v65
    v_exp_f32 v66, v66
    ds_read_b128 v[24:27], v2 offset:3840
    ds_read_b64 v[28:29], v3 offset:3840
    s_mov_b64 exec, s[50:51]
    ds_read_b128 v[40:43], v4 offset:1280
    ds_read_b128 v[44:47], v4 offset:1920
    s_mov_b64 exec, -1
    v_exp_f32 v67, v67
    v_cvt_pk_bf16_f32 v88, v64, v65
    v_exp_f32 v68, v68
    v_exp_f32 v69, v69
    v_mfma_f32_32x32x16_bf16 v[48:63], v[20:23], v[12:15], v[48:63]
    v_cvt_pk_bf16_f32 v89, v66, v67
    v_exp_f32 v70, v70
    v_exp_f32 v71, v71
    v_cvt_pk_bf16_f32 v90, v68, v69
    v_exp_f32 v72, v72
    v_exp_f32 v73, v73
    v_mfma_f32_32x32x16_bf16 v[96:111], v[32:35], v[80:83], v[96:111]
    v_cvt_pk_bf16_f32 v91, v70, v71
    v_exp_f32 v74, v74
    v_exp_f32 v75, v75
    v_cvt_pk_bf16_f32 v92, v72, v73
    v_exp_f32 v76, v76
    v_exp_f32 v77, v77
    v_mfma_f32_32x32x16_bf16 v[96:111], v[36:39], v[84:87], v[96:111]
    v_cvt_pk_bf16_f32 v93, v74, v75
    v_exp_f32 v78, v78
    v_exp_f32 v79, v79
    v_cvt_pk_bf16_f32 v94, v76, v77
    v_cvt_pk_bf16_f32 v95, v78, v79
    s_waitcnt lgkmcnt(0)
    v_exp_f32 v48, v48
    v_mfma_f32_32x32x16_bf16 v[64:79], v[24:27], v[8:11], 0
    v_exp_f32 v49, v49
    v_exp_f32 v50, v50
    ds_read_b128 v[16:19], v2 offset:5120
    ds_read_b64 v[20:21], v3 offset:5120
    s_mov_b64 exec, s[50:51]
    ds_read_b128 v[32:35], v4 offset:2560
    ds_read_b128 v[36:39], v4 offset:3200
    s_mov_b64 exec, -1
    v_exp_f32 v51, v51
    v_cvt_pk_bf16_f32 v80, v48, v49
    v_exp_f32 v52, v52
    v_exp_f32 v53, v53
    v_mfma_f32_32x32x16_bf16 v[64:79], v[28:31], v[12:15], v[64:79]
    v_cvt_pk_bf16_f32 v81, v50, v51
    v_exp_f32 v54, v54
    v_exp_f32 v55, v55
    v_cvt_pk_bf16_f32 v82, v52, v53
    v_exp_f32 v56, v56
    v_exp_f32 v57, v57
    v_mfma_f32_32x32x16_bf16 v[96:111], v[40:43], v[88:91], v[96:111]
    v_cvt_pk_bf16_f32 v83, v54, v55
    v_exp_f32 v58, v58
    v_exp_f32 v59, v59
    v_cvt_pk_bf16_f32 v84, v56, v57
    v_exp_f32 v60, v60
    v_exp_f32 v61, v61
    v_mfma_f32_32x32x16_bf16 v[96:111], v[44:47], v[92:95], v[96:111]
    v_cvt_pk_bf16_f32 v85, v58, v59
    v_exp_f32 v62, v62
    v_exp_f32 v63, v63
    v_cvt_pk_bf16_f32 v86, v60, v61
    v_cvt_pk_bf16_f32 v87, v62, v63
    s_waitcnt lgkmcnt(0)
    v_exp_f32 v64, v64
    v_mfma_f32_32x32x16_bf16 v[48:63], v[16:19], v[8:11], 0
    v_exp_f32 v65, v65
    v_exp_f32 v66, v66
    ds_read_b128 v[24:27], v2 offset:6400
    ds_read_b64 v[28:29], v3 offset:6400
    s_mov_b64 exec, s[50:51]
    ds_read_b128 v[40:43], v4 offset:3840
    ds_read_b128 v[44:47], v4 offset:4480
    s_mov_b64 exec, -1
    v_exp_f32 v67, v67
    v_cvt_pk_bf16_f32 v88, v64, v65
    v_exp_f32 v68, v68
    v_exp_f32 v69, v69
    v_mfma_f32_32x32x16_bf16 v[48:63], v[20:23], v[12:15], v[48:63]
    v_cvt_pk_bf16_f32 v89, v66, v67
    v_exp_f32 v70, v70
    v_exp_f32 v71, v71
    v_cvt_pk_bf16_f32 v90, v68, v69
    v_exp_f32 v72, v72
    v_exp_f32 v73, v73
    v_mfma_f32_32x32x16_bf16 v[96:111], v[32:35], v[80:83], v[96:111]
    v_cvt_pk_bf16_f32 v91, v70, v71
    v_exp_f32 v74, v74
    v_exp_f32 v75, v75
    v_cvt_pk_bf16_f32 v92, v72, v73
    v_exp_f32 v76, v76
    v_exp_f32 v77, v77
    v_mfma_f32_32x32x16_bf16 v[96:111], v[36:39], v[84:87], v[96:111]
    v_cvt_pk_bf16_f32 v93, v74, v75
    v_exp_f32 v78, v78
    v_exp_f32 v79, v79
    v_cvt_pk_bf16_f32 v94, v76, v77
    v_cvt_pk_bf16_f32 v95, v78, v79
    s_waitcnt lgkmcnt(0)
    v_exp_f32 v48, v48
    v_mfma_f32_32x32x16_bf16 v[64:79], v[24:27], v[8:11], 0
    v_exp_f32 v49, v49
    v_exp_f32 v50, v50
    ds_read_b128 v[16:19], v2 offset:7680
    ds_read_b64 v[20:21], v3 offset:7680
    s_mov_b64 exec, s[50:51]
    ds_read_b128 v[32:35], v4 offset:5120
    ds_read_b128 v[36:39], v4 offset:5760
    s_mov_b64 exec, -1
    v_exp_f32 v51, v51
    v_cvt_pk_bf16_f32 v80, v48, v49
    v_exp_f32 v52, v52
    v_exp_f32 v53, v53
    v_mfma_f32_32x32x16_bf16 v[64:79], v[28:31], v[12:15], v[64:79]
    v_cvt_pk_bf16_f32 v81, v50, v51
    v_exp_f32 v54, v54
    v_exp_f32 v55, v55
    v_cvt_pk_bf16_f32 v82, v52, v53
    v_exp_f32 v56, v56
    v_exp_f32 v57, v57
    v_mfma_f32_32x32x16_bf16 v[96:111], v[40:43], v[88:91], v[96:111]
    v_cvt_pk_bf16_f32 v83, v54, v55
    v_exp_f32 v58, v58
    v_exp_f32 v59, v59
    v_cvt_pk_bf16_f32 v84, v56, v57
    v_exp_f32 v60, v60
    v_exp_f32 v61, v61
    v_mfma_f32_32x32x16_bf16 v[96:111], v[44:47], v[92:95], v[96:111]
    v_cvt_pk_bf16_f32 v85, v58, v59
    v_exp_f32 v62, v62
    v_exp_f32 v63, v63
    v_cvt_pk_bf16_f32 v86, v60, v61
    v_cvt_pk_bf16_f32 v87, v62, v63
    s_waitcnt lgkmcnt(0)
    v_exp_f32 v64, v64
    v_mfma_f32_32x32x16_bf16 v[48:63], v[16:19], v[8:11], 0
    v_exp_f32 v65, v65
    v_exp_f32 v66, v66
    ds_read_b128 v[24:27], v2 offset:8960
    ds_read_b64 v[28:29], v3 offset:8960
    s_mov_b64 exec, s[50:51]
    ds_read_b128 v[40:43], v4 offset:6400
    ds_read_b128 v[44:47], v4 offset:7040
    s_mov_b64 exec, -1
    v_exp_f32 v67, v67
    v_cvt_pk_bf16_f32 v88, v64, v65
    v_exp_f32 v68, v68
    v_exp_f32 v69, v69
    v_mfma_f32_32x32x16_bf16 v[48:63], v[20:23], v[12:15], v[48:63]
    v_cvt_pk_bf16_f32 v89, v66, v67
    v_exp_f32 v70, v70
    v_exp_f32 v71, v71
    v_cvt_pk_bf16_f32 v90, v68, v69
    v_exp_f32 v72, v72
    v_exp_f32 v73, v73
    v_mfma_f32_32x32x16_bf16 v[96:111], v[32:35], v[80:83], v[96:111]
    v_cvt_pk_bf16_f32 v91, v70, v71
    v_exp_f32 v74, v74
    v_exp_f32 v75, v75
    v_cvt_pk_bf16_f32 v92, v72, v73
    v_exp_f32 v76, v76
    v_exp_f32 v77, v77
    v_mfma_f32_32x32x16_bf16 v[96:111], v[36:39], v[84:87], v[96:111]
    v_cvt_pk_bf16_f32 v93, v74, v75
    v_exp_f32 v78, v78
    v_exp_f32 v79, v79
    v_cvt_pk_bf16_f32 v94, v76, v77
    v_cvt_pk_bf16_f32 v95, v78, v79
    s_waitcnt vmcnt(0)
    s_barrier
    s_cmp_lg_u32 s22, 0
    s_cbranch_scc1 m2_kernel_nofw
    s_waitcnt lgkmcnt(0)
    s_add_u32 s34, s23, 2654435761
    v_mov_b32 v120, s34
    s_lshl_b32 s35, s2, 7
    s_add_u32 s35, s35, 0
    v_mov_b32 v121, s35
    v_cmp_eq_u32 vcc, 0, v1
    s_nop 3
    s_and_saveexec_b64 s[36:37], vcc
    buffer_store_dword v120, v121, s[28:31], 0 offen sc1
    s_mov_b64 exec, s[36:37]
m2_kernel_nofw:
    s_waitcnt lgkmcnt(0)
    v_exp_f32 v48, v48
    v_mfma_f32_32x32x16_bf16 v[64:79], v[24:27], v[8:11], 0
    v_exp_f32 v49, v49
    v_exp_f32 v50, v50
    ds_read_b128 v[16:19], v2 offset:10240
    ds_read_b64 v[20:21], v3 offset:10240
    s_mov_b64 exec, s[50:51]
    ds_read_b128 v[32:35], v4 offset:7680
    ds_read_b128 v[36:39], v4 offset:8320
    s_mov_b64 exec, -1
    v_exp_f32 v51, v51
    v_cvt_pk_bf16_f32 v80, v48, v49
    v_exp_f32 v52, v52
    v_exp_f32 v53, v53
    v_mfma_f32_32x32x16_bf16 v[64:79], v[28:31], v[12:15], v[64:79]
    v_cvt_pk_bf16_f32 v81, v50, v51
    v_exp_f32 v54, v54
    v_exp_f32 v55, v55
    v_cvt_pk_bf16_f32 v82, v52, v53
    v_exp_f32 v56, v56
    v_exp_f32 v57, v57
    v_mfma_f32_32x32x16_bf16 v[96:111], v[40:43], v[88:91], v[96:111]
    v_cvt_pk_bf16_f32 v83, v54, v55
    v_exp_f32 v58, v58
    v_exp_f32 v59, v59
    v_cvt_pk_bf16_f32 v84, v56, v57
    v_exp_f32 v60, v60
    v_exp_f32 v61, v61
    v_mfma_f32_32x32x16_bf16 v[96:111], v[44:47], v[92:95], v[96:111]
    v_cvt_pk_bf16_f32 v85, v58, v59
    v_exp_f32 v62, v62
    v_exp_f32 v63, v63
    v_cvt_pk_bf16_f32 v86, v60, v61
    v_cvt_pk_bf16_f32 v87, v62, v63
    s_waitcnt lgkmcnt(0)
    v_exp_f32 v64, v64
    v_mfma_f32_32x32x16_bf16 v[48:63], v[16:19], v[8:11], 0
    v_exp_f32 v65, v65
    v_exp_f32 v66, v66
    ds_read_b128 v[24:27], v2 offset:11520
    ds_read_b64 v[28:29], v3 offset:11520
    s_mov_b64 exec, s[50:51]
    ds_read_b128 v[40:43], v4 offset:8960
    ds_read_b128 v[44:47], v4 offset:9600
    s_mov_b64 exec, -1
    v_exp_f32 v67, v67
    v_cvt_pk_bf16_f32 v88, v64, v65
    v_exp_f32 v68, v68
    v_exp_f32 v69, v69
    v_mfma_f32_32x32x16_bf16 v[48:63], v[20:23], v[12:15], v[48:63]
    v_cvt_pk_bf16_f32 v89, v66, v67
    v_exp_f32 v70, v70
    v_exp_f32 v71, v71
    v_cvt_pk_bf16_f32 v90, v68, v69
    v_exp_f32 v72, v72
    v_exp_f32 v73, v73
    v_mfma_f32_32x32x16_bf16 v[96:111], v[32:35], v[80:83], v[96:111]
    v_cvt_pk_bf16_f32 v91, v70, v71
    v_exp_f32 v74, v74
    v_exp_f32 v75, v75
    v_cvt_pk_bf16_f32 v92, v72, v73
    v_exp_f32 v76, v76
    v_exp_f32 v77, v77
    v_mfma_f32_32x32x16_bf16 v[96:111], v[36:39], v[84:87], v[96:111]
    v_cvt_pk_bf16_f32 v93, v74, v75
    v_exp_f32 v78, v78
    v_exp_f32 v79, v79
    v_cvt_pk_bf16_f32 v94, v76, v77
    v_cvt_pk_bf16_f32 v95, v78, v79
    v_add_u32 v2, 10240, v2
    v_add_u32 v3, 10240, v3
    v_add_u32 v4, 10240, v4
    s_waitcnt lgkmcnt(0)
    v_exp_f32 v48, v48
    v_mfma_f32_32x32x16_bf16 v[64:79], v[24:27], v[8:11], 0
    v_exp_f32 v49, v49
    v_exp_f32 v50, v50
    ds_read_b128 v[16:19], v2 offset:2560
    ds_read_b64 v[20:21], v3 offset:2560
    s_mov_b64 exec, s[50:51]
    ds_read_b128 v[32:35], v4 offset:0
    ds_read_b128 v[36:39], v4 offset:640
    s_mov_b64 exec, -1
    v_exp_f32 v51, v51
    v_cvt_pk_bf16_f32 v80, v48, v49
    v_exp_f32 v52, v52
    v_exp_f32 v53, v53
    v_mfma_f32_32x32x16_bf16 v[64:79], v[28:31], v[12:15], v[64:79]
    v_cvt_pk_bf16_f32 v81, v50, v51
    v_exp_f32 v54, v54
    v_exp_f32 v55, v55
    v_cvt_pk_bf16_f32 v82, v52, v53
    v_exp_f32 v56, v56
    v_exp_f32 v57, v57
    v_mfma_f32_32x32x16_bf16 v[96:111], v[40:43], v[88:91], v[96:111]
    v_cvt_pk_bf16_f32 v83, v54, v55
    v_exp_f32 v58, v58
    v_exp_f32 v59, v59
    v_cvt_pk_bf16_f32 v84, v56, v57
    v_exp_f32 v60, v60
    v_exp_f32 v61, v61
    v_mfma_f32_32x32x16_bf16 v[96:111], v[44:47], v[92:95], v[96:111]
    v_cvt_pk_bf16_f32 v85, v58, v59
    v_exp_f32 v62, v62
    v_exp_f32 v63, v63
    v_cvt_pk_bf16_f32 v86, v60, v61
    v_cvt_pk_bf16_f32 v87, v62, v63
    s_waitcnt lgkmcnt(0)
    v_exp_f32 v64, v64
    v_mfma_f32_32x32x16_bf16 v[48:63], v[16:19], v[8:11], 0
    v_exp_f32 v65, v65
    v_exp_f32 v66, v66
    ds_read_b128 v[24:27], v2 offset:3840
    ds_read_b64 v[28:29], v3 offset:3840
    s_mov_b64 exec, s[50:51]
    ds_read_b128 v[40:43], v4 offset:1280
    ds_read_b128 v[44:47], v4 offset:1920
    s_mov_b64 exec, -1
    v_exp_f32 v67, v67
    v_cvt_pk_bf16_f32 v88, v64, v65
    v_exp_f32 v68, v68
    v_exp_f32 v69, v69
    v_mfma_f32_32x32x16_bf16 v[48:63], v[20:23], v[12:15], v[48:63]
    v_cvt_pk_bf16_f32 v89, v66, v67
    v_exp_f32 v70, v70
    v_exp_f32 v71, v71
    v_cvt_pk_bf16_f32 v90, v68, v69
    v_exp_f32 v72, v72
    v_exp_f32 v73, v73
    v_mfma_f32_32x32x16_bf16 v[96:111], v[32:35], v[80:83], v[96:111]
    v_cvt_pk_bf16_f32 v91, v70, v71
    v_exp_f32 v74, v74
    v_exp_f32 v75, v75
    v_cvt_pk_bf16_f32 v92, v72, v73
    v_exp_f32 v76, v76
    v_exp_f32 v77, v77
    v_mfma_f32_32x32x16_bf16 v[96:111], v[36:39], v[84:87], v[96:111]
    v_cvt_pk_bf16_f32 v93, v74, v75
    v_exp_f32 v78, v78
    v_exp_f32 v79, v79
    v_cvt_pk_bf16_f32 v94, v76, v77
    v_cvt_pk_bf16_f32 v95, v78, v79
    s_waitcnt lgkmcnt(0)
    v_exp_f32 v48, v48
    v_mfma_f32_32x32x16_bf16 v[64:79], v[24:27], v[8:11], 0
    v_exp_f32 v49, v49
    v_exp_f32 v50, v50
    ds_read_b128 v[16:19], v2 offset:5120
    ds_read_b64 v[20:21], v3 offset:5120
    s_mov_b64 exec, s[50:51]
    ds_read_b128 v[32:35], v4 offset:2560
    ds_read_b128 v[36:39], v4 offset:3200
    s_mov_b64 exec, -1
    v_exp_f32 v51, v51
    v_cvt_pk_bf16_f32 v80, v48, v49
    v_exp_f32 v52, v52
    v_exp_f32 v53, v53
    v_mfma_f32_32x32x16_bf16 v[64:79], v[28:31], v[12:15], v[64:79]
    v_cvt_pk_bf16_f32 v81, v50, v51
    v_exp_f32 v54, v54
    v_exp_f32 v55, v55
    v_cvt_pk_bf16_f32 v82, v52, v53
    v_exp_f32 v56, v56
    v_exp_f32 v57, v57
    v_mfma_f32_32x32x16_bf16 v[96:111], v[40:43], v[88:91], v[96:111]
    v_cvt_pk_bf16_f32 v83, v54, v55
    v_exp_f32 v58, v58
    v_exp_f32 v59, v59
    v_cvt_pk_bf16_f32 v84, v56, v57
    v_exp_f32 v60, v60
    v_exp_f32 v61, v61
    v_mfma_f32_32x32x16_bf16 v[96:111], v[44:47], v[92:95], v[96:111]
    v_cvt_pk_bf16_f32 v85, v58, v59
    v_exp_f32 v62, v62
    v_exp_f32 v63, v63
    v_cvt_pk_bf16_f32 v86, v60, v61
    v_cvt_pk_bf16_f32 v87, v62, v63
    s_waitcnt lgkmcnt(0)
    v_exp_f32 v64, v64
    v_mfma_f32_32x32x16_bf16 v[48:63], v[16:19], v[8:11], 0
    v_exp_f32 v65, v65
    v_exp_f32 v66, v66
    ds_read_b128 v[24:27], v2 offset:6400
    ds_read_b64 v[28:29], v3 offset:6400
    s_mov_b64 exec, s[50:51]
    ds_read_b128 v[40:43], v4 offset:3840
    ds_read_b128 v[44:47], v4 offset:4480
    s_mov_b64 exec, -1
    v_exp_f32 v67, v67
    v_cvt_pk_bf16_f32 v88, v64, v65
    v_exp_f32 v68, v68
    v_exp_f32 v69, v69
    v_mfma_f32_32x32x16_bf16 v[48:63], v[20:23], v[12:15], v[48:63]
    v_cvt_pk_bf16_f32 v89, v66, v67
    v_exp_f32 v70, v70
    v_exp_f32 v71, v71
    v_cvt_pk_bf16_f32 v90, v68, v69
    v_exp_f32 v72, v72
    v_exp_f32 v73, v73
    v_mfma_f32_32x32x16_bf16 v[96:111], v[32:35], v[80:83], v[96:111]
    v_cvt_pk_bf16_f32 v91, v70, v71
    v_exp_f32 v74, v74
    v_exp_f32 v75, v75
    v_cvt_pk_bf16_f32 v92, v72, v73
    v_exp_f32 v76, v76
    v_exp_f32 v77, v77
    v_mfma_f32_32x32x16_bf16 v[96:111], v[36:39], v[84:87], v[96:111]
    v_cvt_pk_bf16_f32 v93, v74, v75
    v_exp_f32 v78, v78
    v_exp_f32 v79, v79
    v_cvt_pk_bf16_f32 v94, v76, v77
    v_cvt_pk_bf16_f32 v95, v78, v79
    s_waitcnt lgkmcnt(0)
    v_exp_f32 v48, v48
    v_mfma_f32_32x32x16_bf16 v[64:79], v[24:27], v[8:11], 0
    v_exp_f32 v49, v49
    v_exp_f32 v50, v50
    ds_read_b128 v[16:19], v2 offset:7680
    ds_read_b64 v[20:21], v3 offset:7680
    s_mov_b64 exec, s[50:51]
    ds_read_b128 v[32:35], v4 offset:5120
    ds_read_b128 v[36:39], v4 offset:5760
    s_mov_b64 exec, -1
    v_exp_f32 v51, v51
    v_cvt_pk_bf16_f32 v80, v48, v49
    v_exp_f32 v52, v52
    v_exp_f32 v53, v53
    v_mfma_f32_32x32x16_bf16 v[64:79], v[28:31], v[12:15], v[64:79]
    v_cvt_pk_bf16_f32 v81, v50, v51
    v_exp_f32 v54, v54
    v_exp_f32 v55, v55
    v_cvt_pk_bf16_f32 v82, v52, v53
    v_exp_f32 v56, v56
    v_exp_f32 v57, v57
    v_mfma_f32_32x32x16_bf16 v[96:111], v[40:43], v[88:91], v[96:111]
    v_cvt_pk_bf16_f32 v83, v54, v55
    v_exp_f32 v58, v58
    v_exp_f32 v59, v59
    v_cvt_pk_bf16_f32 v84, v56, v57
    v_exp_f32 v60, v60
    v_exp_f32 v61, v61
    v_mfma_f32_32x32x16_bf16 v[96:111], v[44:47], v[92:95], v[96:111]
    v_cvt_pk_bf16_f32 v85, v58, v59
    v_exp_f32 v62, v62
    v_exp_f32 v63, v63
    v_cvt_pk_bf16_f32 v86, v60, v61
    v_cvt_pk_bf16_f32 v87, v62, v63
    s_waitcnt lgkmcnt(0)
    v_exp_f32 v64, v64
    v_mfma_f32_32x32x16_bf16 v[48:63], v[16:19], v[8:11], 0
    v_exp_f32 v65, v65
    v_exp_f32 v66, v66
    ds_read_b128 v[24:27], v2 offset:8960
    ds_read_b64 v[28:29], v3 offset:8960
    s_mov_b64 exec, s[50:51]
    ds_read_b128 v[40:43], v4 offset:6400
    ds_read_b128 v[44:47], v4 offset:7040
    s_mov_b64 exec, -1
    v_exp_f32 v67, v67
    v_cvt_pk_bf16_f32 v88, v64, v65
    v_exp_f32 v68, v68
    v_exp_f32 v69, v69
    v_mfma_f32_32x32x16_bf16 v[48:63], v[20:23], v[12:15], v[48:63]
    v_cvt_pk_bf16_f32 v89, v66, v67
    v_exp_f32 v70, v70
    v_exp_f32 v71, v71
    v_cvt_pk_bf16_f32 v90, v68, v69
    v_exp_f32 v72, v72
    v_exp_f32 v73, v73
    v_mfma_f32_32x32x16_bf16 v[96:111], v[32:35], v[80:83], v[96:111]
    v_cvt_pk_bf16_f32 v91, v70, v71
    v_exp_f32 v74, v74
    v_exp_f32 v75, v75
    v_cvt_pk_bf16_f32 v92, v72, v73
    v_exp_f32 v76, v76
    v_exp_f32 v77, v77
    v_mfma_f32_32x32x16_bf16 v[96:111], v[36:39], v[84:87], v[96:111]
    v_cvt_pk_bf16_f32 v93, v74, v75
    v_exp_f32 v78, v78
    v_exp_f32 v79, v79
    v_cvt_pk_bf16_f32 v94, v76, v77
    v_cvt_pk_bf16_f32 v95, v78, v79
    s_waitcnt lgkmcnt(0)
    v_exp_f32 v48, v48
    v_mfma_f32_32x32x16_bf16 v[64:79], v[24:27], v[8:11], 0
    v_exp_f32 v49, v49
    v_exp_f32 v50, v50
    ds_read_b128 v[16:19], v2 offset:10240
    ds_read_b64 v[20:21], v3 offset:10240
    s_mov_b64 exec, s[50:51]
    ds_read_b128 v[32:35], v4 offset:7680
    ds_read_b128 v[36:39], v4 offset:8320
    s_mov_b64 exec, -1
    v_exp_f32 v51, v51
    v_cvt_pk_bf16_f32 v80, v48, v49
    v_exp_f32 v52, v52
    v_exp_f32 v53, v53
    v_mfma_f32_32x32x16_bf16 v[64:79], v[28:31], v[12:15], v[64:79]
    v_cvt_pk_bf16_f32 v81, v50, v51
    v_exp_f32 v54, v54
    v_exp_f32 v55, v55
    v_cvt_pk_bf16_f32 v82, v52, v53
    v_exp_f32 v56, v56
    v_exp_f32 v57, v57
    v_mfma_f32_32x32x16_bf16 v[96:111], v[40:43], v[88:91], v[96:111]
    v_cvt_pk_bf16_f32 v83, v54, v55
    v_exp_f32 v58, v58
    v_exp_f32 v59, v59
    v_cvt_pk_bf16_f32 v84, v56, v57
    v_exp_f32 v60, v60
    v_exp_f32 v61, v61
    v_mfma_f32_32x32x16_bf16 v[96:111], v[44:47], v[92:95], v[96:111]
    v_cvt_pk_bf16_f32 v85, v58, v59
    v_exp_f32 v62, v62
    v_exp_f32 v63, v63
    v_cvt_pk_bf16_f32 v86, v60, v61
    v_cvt_pk_bf16_f32 v87, v62, v63
    s_waitcnt lgkmcnt(0)
    v_exp_f32 v64, v64
    v_mfma_f32_32x32x16_bf16 v[48:63], v[16:19], v[8:11], 0
    v_exp_f32 v65, v65
    v_exp_f32 v66, v66
    ds_read_b128 v[24:27], v2 offset:11520
    ds_read_b64 v[28:29], v3 offset:11520
    s_mov_b64 exec, s[50:51]
    ds_read_b128 v[40:43], v4 offset:8960
    ds_read_b128 v[44:47], v4 offset:9600
    s_mov_b64 exec, -1
    v_exp_f32 v67, v67
    v_cvt_pk_bf16_f32 v88, v64, v65
    v_exp_f32 v68, v68
    v_exp_f32 v69, v69
    v_mfma_f32_32x32x16_bf16 v[48:63], v[20:23], v[12:15], v[48:63]
    v_cvt_pk_bf16_f32 v89, v66, v67
    v_exp_f32 v70, v70
    v_exp_f32 v71, v71
    v_cvt_pk_bf16_f32 v90, v68, v69
    v_exp_f32 v72, v72
    v_exp_f32 v73, v73
    v_mfma_f32_32x32x16_bf16 v[96:111], v[32:35], v[80:83], v[96:111]
    v_cvt_pk_bf16_f32 v91, v70, v71
    v_exp_f32 v74, v74
    v_exp_f32 v75, v75
    v_cvt_pk_bf16_f32 v92, v72, v73
    v_exp_f32 v76, v76
    v_exp_f32 v77, v77
    v_mfma_f32_32x32x16_bf16 v[96:111], v[36:39], v[84:87], v[96:111]
    v_cvt_pk_bf16_f32 v93, v74, v75
    v_exp_f32 v78, v78
    v_exp_f32 v79, v79
    v_cvt_pk_bf16_f32 v94, v76, v77
    v_cvt_pk_bf16_f32 v95, v78, v79
    buffer_load_dword v152, v148, s[28:31], 0 offen sc1
    buffer_load_dword v153, v149, s[28:31], 0 offen sc1
    buffer_load_dword v154, v150, s[28:31], 0 offen sc1
    buffer_load_dword v155, v151, s[28:31], 0 offen sc1
    v_add_u32 v2, 10240, v2
    v_add_u32 v3, 10240, v3
    v_add_u32 v4, 10240, v4
    s_waitcnt lgkmcnt(0)
    v_exp_f32 v48, v48
    v_mfma_f32_32x32x16_bf16 v[64:79], v[24:27], v[8:11], 0
    v_exp_f32 v49, v49
    v_exp_f32 v50, v50
    ds_read_b128 v[16:19], v2 offset:2560
    ds_read_b64 v[20:21], v3 offset:2560
    s_mov_b64 exec, s[50:51]
    ds_read_b128 v[32:35], v4 offset:0
    ds_read_b128 v[36:39], v4 offset:640
    s_mov_b64 exec, -1
    v_exp_f32 v51, v51
    v_cvt_pk_bf16_f32 v80, v48, v49
    v_exp_f32 v52, v52
    v_exp_f32 v53, v53
    v_mfma_f32_32x32x16_bf16 v[64:79], v[28:31], v[12:15], v[64:79]
    v_cvt_pk_bf16_f32 v81, v50, v51
    v_exp_f32 v54, v54
    v_exp_f32 v55, v55
    v_cvt_pk_bf16_f32 v82, v52, v53
    v_exp_f32 v56, v56
    v_exp_f32 v57, v57
    v_mfma_f32_32x32x16_bf16 v[96:111], v[40:43], v[88:91], v[96:111]
    v_cvt_pk_bf16_f32 v83, v54, v55
    v_exp_f32 v58, v58
    v_exp_f32 v59, v59
    v_cvt_pk_bf16_f32 v84, v56, v57
    v_exp_f32 v60, v60
    v_exp_f32 v61, v61
    v_mfma_f32_32x32x16_bf16 v[96:111], v[44:47], v[92:95], v[96:111]
    v_cvt_pk_bf16_f32 v85, v58, v59
    v_exp_f32 v62, v62
    v_exp_f32 v63, v63
    v_cvt_pk_bf16_f32 v86, v60, v61
    v_cvt_pk_bf16_f32 v87, v62, v63
    s_waitcnt lgkmcnt(0)
    v_exp_f32 v64, v64
    v_mfma_f32_32x32x16_bf16 v[48:63], v[16:19], v[8:11], 0
    v_exp_f32 v65, v65
    v_exp_f32 v66, v66
    ds_read_b128 v[24:27], v2 offset:3840
    ds_read_b64 v[28:29], v3 offset:3840
    s_mov_b64 exec, s[50:51]
    ds_read_b128 v[40:43], v4 offset:1280
    ds_read_b128 v[44:47], v4 offset:1920
    s_mov_b64 exec, -1
    v_exp_f32 v67, v67
    v_cvt_pk_bf16_f32 v88, v64, v65
    v_exp_f32 v68, v68
    v_exp_f32 v69, v69
    v_mfma_f32_32x32x16_bf16 v[48:63], v[20:23], v[12:15], v[48:63]
    v_cvt_pk_bf16_f32 v89, v66, v67
    v_exp_f32 v70, v70
    v_exp_f32 v71, v71
    v_cvt_pk_bf16_f32 v90, v68, v69
    v_exp_f32 v72, v72
    v_exp_f32 v73, v73
    v_mfma_f32_32x32x16_bf16 v[96:111], v[32:35], v[80:83], v[96:111]
    v_cvt_pk_bf16_f32 v91, v70, v71
    v_exp_f32 v74, v74
    v_exp_f32 v75, v75
    v_cvt_pk_bf16_f32 v92, v72, v73
    v_exp_f32 v76, v76
    v_exp_f32 v77, v77
    v_mfma_f32_32x32x16_bf16 v[96:111], v[36:39], v[84:87], v[96:111]
    v_cvt_pk_bf16_f32 v93, v74, v75
    v_exp_f32 v78, v78
    v_exp_f32 v79, v79
    v_cvt_pk_bf16_f32 v94, v76, v77
    v_cvt_pk_bf16_f32 v95, v78, v79
    s_waitcnt lgkmcnt(0)
    v_exp_f32 v48, v48
    v_mfma_f32_32x32x16_bf16 v[64:79], v[24:27], v[8:11], 0
    v_exp_f32 v49, v49
    v_exp_f32 v50, v50
    ds_read_b128 v[16:19], v2 offset:5120
    ds_read_b64 v[20:21], v3 offset:5120
    s_mov_b64 exec, s[50:51]
    ds_read_b128 v[32:35], v4 offset:2560
    ds_read_b128 v[36:39], v4 offset:3200
    s_mov_b64 exec, -1
    v_exp_f32 v51, v51
    v_cvt_pk_bf16_f32 v80, v48, v49
    v_exp_f32 v52, v52
    v_exp_f32 v53, v53
    v_mfma_f32_32x32x16_bf16 v[64:79], v[28:31], v[12:15], v[64:79]
    v_cvt_pk_bf16_f32 v81, v50, v51
    v_exp_f32 v54, v54
    v_exp_f32 v55, v55
    v_cvt_pk_bf16_f32 v82, v52, v53
    v_exp_f32 v56, v56
    v_exp_f32 v57, v57
    v_mfma_f32_32x32x16_bf16 v[96:111], v[40:43], v[88:91], v[96:111]
    v_cvt_pk_bf16_f32 v83, v54, v55
    v_exp_f32 v58, v58
    v_exp_f32 v59, v59
    v_cvt_pk_bf16_f32 v84, v56, v57
    v_exp_f32 v60, v60
    v_exp_f32 v61, v61
    v_mfma_f32_32x32x16_bf16 v[96:111], v[44:47], v[92:95], v[96:111]
    v_cvt_pk_bf16_f32 v85, v58, v59
    v_exp_f32 v62, v62
    v_exp_f32 v63, v63
    v_cvt_pk_bf16_f32 v86, v60, v61
    v_cvt_pk_bf16_f32 v87, v62, v63
    s_waitcnt lgkmcnt(0)
    v_exp_f32 v64, v64
    v_mfma_f32_32x32x16_bf16 v[48:63], v[16:19], v[8:11], 0
    v_exp_f32 v65, v65
    v_exp_f32 v66, v66
    ds_read_b128 v[24:27], v2 offset:6400
    ds_read_b64 v[28:29], v3 offset:6400
    s_mov_b64 exec, s[50:51]
    ds_read_b128 v[40:43], v4 offset:3840
    ds_read_b128 v[44:47], v4 offset:4480
    s_mov_b64 exec, -1
    v_exp_f32 v67, v67
    v_cvt_pk_bf16_f32 v88, v64, v65
    v_exp_f32 v68, v68
    v_exp_f32 v69, v69
    v_mfma_f32_32x32x16_bf16 v[48:63], v[20:23], v[12:15], v[48:63]
    v_cvt_pk_bf16_f32 v89, v66, v67
    v_exp_f32 v70, v70
    v_exp_f32 v71, v71
    v_cvt_pk_bf16_f32 v90, v68, v69
    v_exp_f32 v72, v72
    v_exp_f32 v73, v73
    v_mfma_f32_32x32x16_bf16 v[96:111], v[32:35], v[80:83], v[96:111]
    v_cvt_pk_bf16_f32 v91, v70, v71
    v_exp_f32 v74, v74
    v_exp_f32 v75, v75
    v_cvt_pk_bf16_f32 v92, v72, v73
    v_exp_f32 v76, v76
    v_exp_f32 v77, v77
    v_mfma_f32_32x32x16_bf16 v[96:111], v[36:39], v[84:87], v[96:111]
    v_cvt_pk_bf16_f32 v93, v74, v75
    v_exp_f32 v78, v78
    v_exp_f32 v79, v79
    v_cvt_pk_bf16_f32 v94, v76, v77
    v_cvt_pk_bf16_f32 v95, v78, v79
    s_waitcnt lgkmcnt(0)
    v_exp_f32 v48, v48
    v_mfma_f32_32x32x16_bf16 v[64:79], v[24:27], v[8:11], 0
    v_exp_f32 v49, v49
    v_exp_f32 v50, v50
    ds_read_b128 v[16:19], v2 offset:7680
    ds_read_b64 v[20:21], v3 offset:7680
    s_mov_b64 exec, s[50:51]
    ds_read_b128 v[32:35], v4 offset:5120
    ds_read_b128 v[36:39], v4 offset:5760
    s_mov_b64 exec, -1
    v_exp_f32 v51, v51
    v_cvt_pk_bf16_f32 v80, v48, v49
    v_exp_f32 v52, v52
    v_exp_f32 v53, v53
    v_mfma_f32_32x32x16_bf16 v[64:79], v[28:31], v[12:15], v[64:79]
    v_cvt_pk_bf16_f32 v81, v50, v51
    v_exp_f32 v54, v54
    v_exp_f32 v55, v55
    v_cvt_pk_bf16_f32 v82, v52, v53
    v_exp_f32 v56, v56
    v_exp_f32 v57, v57
    v_mfma_f32_32x32x16_bf16 v[96:111], v[40:43], v[88:91], v[96:111]
    v_cvt_pk_bf16_f32 v83, v54, v55
    v_exp_f32 v58, v58
    v_exp_f32 v59, v59
    v_cvt_pk_bf16_f32 v84, v56, v57
    v_exp_f32 v60, v60
    v_exp_f32 v61, v61
    v_mfma_f32_32x32x16_bf16 v[96:111], v[44:47], v[92:95], v[96:111]
    v_cvt_pk_bf16_f32 v85, v58, v59
    v_exp_f32 v62, v62
    v_exp_f32 v63, v63
    v_cvt_pk_bf16_f32 v86, v60, v61
    v_cvt_pk_bf16_f32 v87, v62, v63
    s_waitcnt lgkmcnt(0)
    v_exp_f32 v64, v64
    v_mfma_f32_32x32x16_bf16 v[48:63], v[16:19], v[8:11], 0
    v_exp_f32 v65, v65
    v_exp_f32 v66, v66
    ds_read_b128 v[24:27], v2 offset:8960
    ds_read_b64 v[28:29], v3 offset:8960
    s_mov_b64 exec, s[50:51]
    ds_read_b128 v[40:43], v4 offset:6400
    ds_read_b128 v[44:47], v4 offset:7040
    s_mov_b64 exec, -1
    v_exp_f32 v67, v67
    v_cvt_pk_bf16_f32 v88, v64, v65
    v_exp_f32 v68, v68
    v_exp_f32 v69, v69
    v_mfma_f32_32x32x16_bf16 v[48:63], v[20:23], v[12:15], v[48:63]
    v_cvt_pk_bf16_f32 v89, v66, v67
    v_exp_f32 v70, v70
    v_exp_f32 v71, v71
    v_cvt_pk_bf16_f32 v90, v68, v69
    v_exp_f32 v72, v72
    v_exp_f32 v73, v73
    v_mfma_f32_32x32x16_bf16 v[96:111], v[32:35], v[80:83], v[96:111]
    v_cvt_pk_bf16_f32 v91, v70, v71
    v_exp_f32 v74, v74
    v_exp_f32 v75, v75
    v_cvt_pk_bf16_f32 v92, v72, v73
    v_exp_f32 v76, v76
    v_exp_f32 v77, v77
    v_mfma_f32_32x32x16_bf16 v[96:111], v[36:39], v[84:87], v[96:111]
    v_cvt_pk_bf16_f32 v93, v74, v75
    v_exp_f32 v78, v78
    v_exp_f32 v79, v79
    v_cvt_pk_bf16_f32 v94, v76, v77
    v_cvt_pk_bf16_f32 v95, v78, v79
    s_waitcnt lgkmcnt(0)
    v_exp_f32 v48, v48
    v_mfma_f32_32x32x16_bf16 v[64:79], v[24:27], v[8:11], 0
    v_exp_f32 v49, v49
    v_exp_f32 v50, v50
    ds_read_b128 v[16:19], v2 offset:10240
    ds_read_b64 v[20:21], v3 offset:10240
    s_mov_b64 exec, s[50:51]
    ds_read_b128 v[32:35], v4 offset:7680
    ds_read_b128 v[36:39], v4 offset:8320
    s_mov_b64 exec, -1
    v_exp_f32 v51, v51
    v_cvt_pk_bf16_f32 v80, v48, v49
    v_exp_f32 v52, v52
    v_exp_f32 v53, v53
    v_mfma_f32_32x32x16_bf16 v[64:79], v[28:31], v[12:15], v[64:79]
    v_cvt_pk_bf16_f32 v81, v50, v51
    v_exp_f32 v54, v54
    v_exp_f32 v55, v55
    v_cvt_pk_bf16_f32 v82, v52, v53
    v_exp_f32 v56, v56
    v_exp_f32 v57, v57
    v_mfma_f32_32x32x16_bf16 v[96:111], v[40:43], v[88:91], v[96:111]
    v_cvt_pk_bf16_f32 v83, v54, v55
    v_exp_f32 v58, v58
    v_exp_f32 v59, v59
    v_cvt_pk_bf16_f32 v84, v56, v57
    v_exp_f32 v60, v60
    v_exp_f32 v61, v61
    v_mfma_f32_32x32x16_bf16 v[96:111], v[44:47], v[92:95], v[96:111]
    v_cvt_pk_bf16_f32 v85, v58, v59
    v_exp_f32 v62, v62
    v_exp_f32 v63, v63
    v_cvt_pk_bf16_f32 v86, v60, v61
    v_cvt_pk_bf16_f32 v87, v62, v63
    s_waitcnt lgkmcnt(0)
    v_exp_f32 v64, v64
    v_mfma_f32_32x32x16_bf16 v[48:63], v[16:19], v[8:11], 0
    v_exp_f32 v65, v65
    v_exp_f32 v66, v66
    ds_read_b128 v[24:27], v2 offset:11520
    ds_read_b64 v[28:29], v3 offset:11520
    s_mov_b64 exec, s[50:51]
    ds_read_b128 v[40:43], v4 offset:8960
    ds_read_b128 v[44:47], v4 offset:9600
    s_mov_b64 exec, -1
    v_exp_f32 v67, v67
    v_cvt_pk_bf16_f32 v88, v64, v65
    v_exp_f32 v68, v68
    v_exp_f32 v69, v69
    v_mfma_f32_32x32x16_bf16 v[48:63], v[20:23], v[12:15], v[48:63]
    v_cvt_pk_bf16_f32 v89, v66, v67
    v_exp_f32 v70, v70
    v_exp_f32 v71, v71
    v_cvt_pk_bf16_f32 v90, v68, v69
    v_exp_f32 v72, v72
    v_exp_f32 v73, v73
    v_mfma_f32_32x32x16_bf16 v[96:111], v[32:35], v[80:83], v[96:111]
    v_cvt_pk_bf16_f32 v91, v70, v71
    v_exp_f32 v74, v74
    v_exp_f32 v75, v75
    v_cvt_pk_bf16_f32 v92, v72, v73
    v_exp_f32 v76, v76
    v_exp_f32 v77, v77
    v_mfma_f32_32x32x16_bf16 v[96:111], v[36:39], v[84:87], v[96:111]
    v_cvt_pk_bf16_f32 v93, v74, v75
    v_exp_f32 v78, v78
    v_exp_f32 v79, v79
    v_cvt_pk_bf16_f32 v94, v76, v77
    v_cvt_pk_bf16_f32 v95, v78, v79
    v_add_u32 v2, 10240, v2
    v_add_u32 v3, 10240, v3
    v_add_u32 v4, 10240, v4
    s_waitcnt lgkmcnt(0)
    v_exp_f32 v48, v48
    v_mfma_f32_32x32x16_bf16 v[64:79], v[24:27], v[8:11], 0
    v_exp_f32 v49, v49
    v_exp_f32 v50, v50
    ds_read_b128 v[16:19], v2 offset:2560
    ds_read_b64 v[20:21], v3 offset:2560
    s_mov_b64 exec, s[50:51]
    ds_read_b128 v[32:35], v4 offset:0
    ds_read_b128 v[36:39], v4 offset:640
    s_mov_b64 exec, -1
    v_exp_f32 v51, v51
    v_cvt_pk_bf16_f32 v80, v48, v49
    v_exp_f32 v52, v52
    v_exp_f32 v53, v53
    v_mfma_f32_32x32x16_bf16 v[64:79], v[28:31], v[12:15], v[64:79]
    v_cvt_pk_bf16_f32 v81, v50, v51
    v_exp_f32 v54, v54
    v_exp_f32 v55, v55
    v_cvt_pk_bf16_f32 v82, v52, v53
    v_exp_f32 v56, v56
    v_exp_f32 v57, v57
    v_mfma_f32_32x32x16_bf16 v[96:111], v[40:43], v[88:91], v[96:111]
    v_cvt_pk_bf16_f32 v83, v54, v55
    v_exp_f32 v58, v58
    v_exp_f32 v59, v59
    v_cvt_pk_bf16_f32 v84, v56, v57
    v_exp_f32 v60, v60
    v_exp_f32 v61, v61
    v_mfma_f32_32x32x16_bf16 v[96:111], v[44:47], v[92:95], v[96:111]
    v_cvt_pk_bf16_f32 v85, v58, v59
    v_exp_f32 v62, v62
    v_exp_f32 v63, v63
    v_cvt_pk_bf16_f32 v86, v60, v61
    v_cvt_pk_bf16_f32 v87, v62, v63
    s_waitcnt lgkmcnt(0)
    v_exp_f32 v64, v64
    v_mfma_f32_32x32x16_bf16 v[48:63], v[16:19], v[8:11], 0
    v_exp_f32 v65, v65
    v_exp_f32 v66, v66
    ds_read_b128 v[24:27], v2 offset:3840
    ds_read_b64 v[28:29], v3 offset:3840
    s_mov_b64 exec, s[50:51]
    ds_read_b128 v[40:43], v4 offset:1280
    ds_read_b128 v[44:47], v4 offset:1920
    s_mov_b64 exec, -1
    v_exp_f32 v67, v67
    v_cvt_pk_bf16_f32 v88, v64, v65
    v_exp_f32 v68, v68
    v_exp_f32 v69, v69
    v_mfma_f32_32x32x16_bf16 v[48:63], v[20:23], v[12:15], v[48:63]
    v_cvt_pk_bf16_f32 v89, v66, v67
    v_exp_f32 v70, v70
    v_exp_f32 v71, v71
    v_cvt_pk_bf16_f32 v90, v68, v69
    v_exp_f32 v72, v72
    v_exp_f32 v73, v73
    v_mfma_f32_32x32x16_bf16 v[96:111], v[32:35], v[80:83], v[96:111]
    v_cvt_pk_bf16_f32 v91, v70, v71
    v_exp_f32 v74, v74
    v_exp_f32 v75, v75
    v_cvt_pk_bf16_f32 v92, v72, v73
    v_exp_f32 v76, v76
    v_exp_f32 v77, v77
    v_mfma_f32_32x32x16_bf16 v[96:111], v[36:39], v[84:87], v[96:111]
    v_cvt_pk_bf16_f32 v93, v74, v75
    v_exp_f32 v78, v78
    v_exp_f32 v79, v79
    v_cvt_pk_bf16_f32 v94, v76, v77
    v_cvt_pk_bf16_f32 v95, v78, v79
    s_waitcnt vmcnt(0)
    s_add_u32 s34, s23, 2654435761
    v_cmp_ne_u32 vcc, s34, v152
    v_cmp_ne_u32 s[36:37], s34, v153
    s_nop 3
    s_or_b64 vcc, vcc, s[36:37]
    v_cmp_ne_u32 s[36:37], s34, v154
    s_nop 3
    s_or_b64 vcc, vcc, s[36:37]
    v_cmp_ne_u32 s[36:37], s34, v155
    s_nop 3
    s_or_b64 vcc, vcc, s[36:37]
    s_cbranch_vccnz m2_kernel_nowpf
    s_add_u32 s68, s20, 19816448
    s_addc_u32 s69, s21, 0
    s_mov_b32 s70, 6717440
    s_mov_b32 s71, 0x00020000
    buffer_load_dword v128, v158, s[68:71], 0 offen
    buffer_load_dword v129, v159, s[68:71], 0 offen
m2_kernel_nowpf:
    s_waitcnt lgkmcnt(0)
    v_exp_f32 v48, v48
    v_mfma_f32_32x32x16_bf16 v[64:79], v[24:27], v[8:11], 0
    v_exp_f32 v49, v49
    v_exp_f32 v50, v50
    ds_read_b128 v[16:19], v2 offset:5120
    ds_read_b64 v[20:21], v3 offset:5120
    s_mov_b64 exec, s[50:51]
    ds_read_b128 v[32:35], v4 offset:2560
    ds_read_b128 v[36:39], v4 offset:3200
    s_mov_b64 exec, -1
    v_exp_f32 v51, v51
    v_cvt_pk_bf16_f32 v80, v48, v49
    v_exp_f32 v52, v52
    v_exp_f32 v53, v53
    v_mfma_f32_32x32x16_bf16 v[64:79], v[28:31], v[12:15], v[64:79]
    v_cvt_pk_bf16_f32 v81, v50, v51
    v_exp_f32 v54, v54
    v_exp_f32 v55, v55
    v_cvt_pk_bf16_f32 v82, v52, v53
    v_exp_f32 v56, v56
    v_exp_f32 v57, v57
    v_mfma_f32_32x32x16_bf16 v[96:111], v[40:43], v[88:91], v[96:111]
    v_cvt_pk_bf16_f32 v83, v54, v55
    v_exp_f32 v58, v58
    v_exp_f32 v59, v59
    v_cvt_pk_bf16_f32 v84, v56, v57
    v_exp_f32 v60, v60
    v_exp_f32 v61, v61
    v_mfma_f32_32x32x16_bf16 v[96:111], v[44:47], v[92:95], v[96:111]
    v_cvt_pk_bf16_f32 v85, v58, v59
    v_exp_f32 v62, v62
    v_exp_f32 v63, v63
    v_cvt_pk_bf16_f32 v86, v60, v61
    v_cvt_pk_bf16_f32 v87, v62, v63
    s_waitcnt lgkmcnt(0)
    v_exp_f32 v64, v64
    v_mfma_f32_32x32x16_bf16 v[48:63], v[16:19], v[8:11], 0
    v_exp_f32 v65, v65
    v_exp_f32 v66, v66
    ds_read_b128 v[24:27], v2 offset:6400
    ds_read_b64 v[28:29], v3 offset:6400
    s_mov_b64 exec, s[50:51]
    ds_read_b128 v[40:43], v4 offset:3840
    ds_read_b128 v[44:47], v4 offset:4480
    s_mov_b64 exec, -1
    v_exp_f32 v67, v67
    v_cvt_pk_bf16_f32 v88, v64, v65
    v_exp_f32 v68, v68
    v_exp_f32 v69, v69
    v_mfma_f32_32x32x16_bf16 v[48:63], v[20:23], v[12:15], v[48:63]
    v_cvt_pk_bf16_f32 v89, v66, v67
    v_exp_f32 v70, v70
    v_exp_f32 v71, v71
    v_cvt_pk_bf16_f32 v90, v68, v69
    v_exp_f32 v72, v72
    v_exp_f32 v73, v73
    v_mfma_f32_32x32x16_bf16 v[96:111], v[32:35], v[80:83], v[96:111]
    v_cvt_pk_bf16_f32 v91, v70, v71
    v_exp_f32 v74, v74
    v_exp_f32 v75, v75
    v_cvt_pk_bf16_f32 v92, v72, v73
    v_exp_f32 v76, v76
    v_exp_f32 v77, v77
    v_mfma_f32_32x32x16_bf16 v[96:111], v[36:39], v[84:87], v[96:111]
    v_cvt_pk_bf16_f32 v93, v74, v75
    v_exp_f32 v78, v78
    v_exp_f32 v79, v79
    v_cvt_pk_bf16_f32 v94, v76, v77
    v_cvt_pk_bf16_f32 v95, v78, v79
    s_waitcnt lgkmcnt(0)
    v_exp_f32 v48, v48
    v_mfma_f32_32x32x16_bf16 v[64:79], v[24:27], v[8:11], 0
    v_exp_f32 v49, v49
    v_exp_f32 v50, v50
    ds_read_b128 v[16:19], v2 offset:7680
    ds_read_b64 v[20:21], v3 offset:7680
    s_mov_b64 exec, s[50:51]
    ds_read_b128 v[32:35], v4 offset:5120
    ds_read_b128 v[36:39], v4 offset:5760
    s_mov_b64 exec, -1
    v_exp_f32 v51, v51
    v_cvt_pk_bf16_f32 v80, v48, v49
    v_exp_f32 v52, v52
    v_exp_f32 v53, v53
    v_mfma_f32_32x32x16_bf16 v[64:79], v[28:31], v[12:15], v[64:79]
    v_cvt_pk_bf16_f32 v81, v50, v51
    v_exp_f32 v54, v54
    v_exp_f32 v55, v55
    v_cvt_pk_bf16_f32 v82, v52, v53
    v_exp_f32 v56, v56
    v_exp_f32 v57, v57
    v_mfma_f32_32x32x16_bf16 v[96:111], v[40:43], v[88:91], v[96:111]
    v_cvt_pk_bf16_f32 v83, v54, v55
    v_exp_f32 v58, v58
    v_exp_f32 v59, v59
    v_cvt_pk_bf16_f32 v84, v56, v57
    v_exp_f32 v60, v60
    v_exp_f32 v61, v61
    v_mfma_f32_32x32x16_bf16 v[96:111], v[44:47], v[92:95], v[96:111]
    v_cvt_pk_bf16_f32 v85, v58, v59
    v_exp_f32 v62, v62
    v_exp_f32 v63, v63
    v_cvt_pk_bf16_f32 v86, v60, v61
    v_cvt_pk_bf16_f32 v87, v62, v63
    s_waitcnt lgkmcnt(0)
    v_exp_f32 v64, v64
    v_mfma_f32_32x32x16_bf16 v[48:63], v[16:19], v[8:11], 0
    v_exp_f32 v65, v65
    v_exp_f32 v66, v66
    ds_read_b128 v[24:27], v2 offset:8960
    ds_read_b64 v[28:29], v3 offset:8960
    s_mov_b64 exec, s[50:51]
    ds_read_b128 v[40:43], v4 offset:6400
    ds_read_b128 v[44:47], v4 offset:7040
    s_mov_b64 exec, -1
    v_exp_f32 v67, v67
    v_cvt_pk_bf16_f32 v88, v64, v65
    v_exp_f32 v68, v68
    v_exp_f32 v69, v69
    v_mfma_f32_32x32x16_bf16 v[48:63], v[20:23], v[12:15], v[48:63]
    v_cvt_pk_bf16_f32 v89, v66, v67
    v_exp_f32 v70, v70
    v_exp_f32 v71, v71
    v_cvt_pk_bf16_f32 v90, v68, v69
    v_exp_f32 v72, v72
    v_exp_f32 v73, v73
    v_mfma_f32_32x32x16_bf16 v[96:111], v[32:35], v[80:83], v[96:111]
    v_cvt_pk_bf16_f32 v91, v70, v71
    v_exp_f32 v74, v74
    v_exp_f32 v75, v75
    v_cvt_pk_bf16_f32 v92, v72, v73
    v_exp_f32 v76, v76
    v_exp_f32 v77, v77
    v_mfma_f32_32x32x16_bf16 v[96:111], v[36:39], v[84:87], v[96:111]
    v_cvt_pk_bf16_f32 v93, v74, v75
    v_exp_f32 v78, v78
    v_exp_f32 v79, v79
    v_cvt_pk_bf16_f32 v94, v76, v77
    v_cvt_pk_bf16_f32 v95, v78, v79
    s_waitcnt lgkmcnt(0)
    v_exp_f32 v48, v48
    v_mfma_f32_32x32x16_bf16 v[64:79], v[24:27], v[8:11], 0
    v_exp_f32 v49, v49
    v_exp_f32 v50, v50
    ds_read_b128 v[16:19], v2 offset:10240
    ds_read_b64 v[20:21], v3 offset:10240
    s_mov_b64 exec, s[50:51]
    ds_read_b128 v[32:35], v4 offset:7680
    ds_read_b128 v[36:39], v4 offset:8320
    s_mov_b64 exec, -1
    v_exp_f32 v51, v51
    v_cvt_pk_bf16_f32 v80, v48, v49
    v_exp_f32 v52, v52
    v_exp_f32 v53, v53
    v_mfma_f32_32x32x16_bf16 v[64:79], v[28:31], v[12:15], v[64:79]
    v_cvt_pk_bf16_f32 v81, v50, v51
    v_exp_f32 v54, v54
    v_exp_f32 v55, v55
    v_cvt_pk_bf16_f32 v82, v52, v53
    v_exp_f32 v56, v56
    v_exp_f32 v57, v57
    v_mfma_f32_32x32x16_bf16 v[96:111], v[40:43], v[88:91], v[96:111]
    v_cvt_pk_bf16_f32 v83, v54, v55
    v_exp_f32 v58, v58
    v_exp_f32 v59, v59
    v_cvt_pk_bf16_f32 v84, v56, v57
    v_exp_f32 v60, v60
    v_exp_f32 v61, v61
    v_mfma_f32_32x32x16_bf16 v[96:111], v[44:47], v[92:95], v[96:111]
    v_cvt_pk_bf16_f32 v85, v58, v59
    v_exp_f32 v62, v62
    v_exp_f32 v63, v63
    v_cvt_pk_bf16_f32 v86, v60, v61
    v_cvt_pk_bf16_f32 v87, v62, v63
    s_waitcnt lgkmcnt(0)
    v_exp_f32 v64, v64
    v_mfma_f32_32x32x16_bf16 v[48:63], v[16:19], v[8:11], 0
    v_exp_f32 v65, v65
    v_exp_f32 v66, v66
    ds_read_b128 v[24:27], v2 offset:11520
    ds_read_b64 v[28:29], v3 offset:11520
    s_mov_b64 exec, s[50:51]
    ds_read_b128 v[40:43], v4 offset:8960
    ds_read_b128 v[44:47], v4 offset:9600
    s_mov_b64 exec, -1
    v_exp_f32 v67, v67
    v_cvt_pk_bf16_f32 v88, v64, v65
    v_exp_f32 v68, v68
    v_exp_f32 v69, v69
    v_mfma_f32_32x32x16_bf16 v[48:63], v[20:23], v[12:15], v[48:63]
    v_cvt_pk_bf16_f32 v89, v66, v67
    v_exp_f32 v70, v70
    v_exp_f32 v71, v71
    v_cvt_pk_bf16_f32 v90, v68, v69
    v_exp_f32 v72, v72
    v_exp_f32 v73, v73
    v_mfma_f32_32x32x16_bf16 v[96:111], v[32:35], v[80:83], v[96:111]
    v_cvt_pk_bf16_f32 v91, v70, v71
    v_exp_f32 v74, v74
    v_exp_f32 v75, v75
    v_cvt_pk_bf16_f32 v92, v72, v73
    v_exp_f32 v76, v76
    v_exp_f32 v77, v77
    v_mfma_f32_32x32x16_bf16 v[96:111], v[36:39], v[84:87], v[96:111]
    v_cvt_pk_bf16_f32 v93, v74, v75
    v_exp_f32 v78, v78
    v_exp_f32 v79, v79
    v_cvt_pk_bf16_f32 v94, v76, v77
    v_cvt_pk_bf16_f32 v95, v78, v79
    v_add_u32 v2, 10240, v2
    v_add_u32 v3, 10240, v3
    v_add_u32 v4, 10240, v4
    s_waitcnt lgkmcnt(0)
    v_mfma_f32_32x32x16_bf16 v[96:111], v[40:43], v[88:91], v[96:111]
    v_mfma_f32_32x32x16_bf16 v[96:111], v[44:47], v[92:95], v[96:111]
    v_cmp_gt_u32 s[34:35], 32, v1
    s_nop 10
    v_cndmask_b32 v112, v104, v108, s[34:35]
    v_mov_b32 v117, 0x4e800000
    v_cmp_nle_f32 vcc, v112, v117
    s_cbranch_vccnz m2_kernel_slow
m2_kernel_store:
    v_rcp_f32 v112, v112
    s_nop 0
    v_pk_mul_f32 v[96:97], v[96:97], v[112:113] op_sel_hi:[1,0]
    v_pk_mul_f32 v[98:99], v[98:99], v[112:113] op_sel_hi:[1,0]
    v_cvt_pk_bf16_f32 v96, v96, v97
    v_cvt_pk_bf16_f32 v97, v98, v99
    buffer_store_dwordx2 v[96:97], v5, s[44:47], s52 offen sc1
    v_pk_mul_f32 v[100:101], v[100:101], v[112:113] op_sel_hi:[1,0]
    v_pk_mul_f32 v[102:103], v[102:103], v[112:113] op_sel_hi:[1,0]
    v_cvt_pk_bf16_f32 v100, v100, v101
    v_cvt_pk_bf16_f32 v101, v102, v103
    buffer_store_dwordx2 v[100:101], v6, s[44:47], s52 offen sc1
    v_pk_mul_f32 v[104:105], v[104:105], v[112:113] op_sel_hi:[1,0]
    v_pk_mul_f32 v[106:107], v[106:107], v[112:113] op_sel_hi:[1,0]
    v_cvt_pk_bf16_f32 v104, v104, v105
    v_cvt_pk_bf16_f32 v105, v106, v107
    buffer_store_dwordx2 v[104:105], v7, s[44:47], s52 offen sc1
    s_branch m2_kernel_p2fin
m2_kernel_slow:
    v_lshlrev_b32 v2, 4, v1
    v_and_b32 v116, 31, v1
    v_lshlrev_b32 v3, 3, v116
    v_add_u32 v3, 1024, v3
    v_mov_b32 v14, 0
    v_mov_b32 v112, 0xff800000
    s_mov_b32 s48, 0
m2_kernel_sl1:
    ds_read_b128 v[16:19], v2 offset:0
    ds_read_b64 v[20:21], v3 offset:0
    s_waitcnt lgkmcnt(0)
    v_mfma_f32_32x32x16_bf16 v[48:63], v[16:19], v[8:11], 0
    v_mfma_f32_32x32x16_bf16 v[48:63], v[20:23], v[12:15], v[48:63]
    s_nop 11
    v_max3_f32 v112, v112, v48, v49
    v_max3_f32 v112, v112, v50, v51
    v_max3_f32 v112, v112, v52, v53
    v_max3_f32 v112, v112, v54, v55
    v_max3_f32 v112, v112, v56, v57
    v_max3_f32 v112, v112, v58, v59
    v_max3_f32 v112, v112, v60, v61
    v_max3_f32 v112, v112, v62, v63
    v_add_u32 v2, 1280, v2
    v_add_u32 v3, 1280, v3
    s_add_u32 s48, s48, 1
    s_cmp_lt_u32 s48, 64
    s_cbranch_scc1 m2_kernel_sl1
    v_mov_b32 v114, v112
    s_nop 1
    v_permlane32_swap_b32 v114, v112
    v_max_f32 v112, v112, v114
    v_sub_f32 v112, 0, v112
    v_cvt_pk_bf16_f32 v112, v112, 0
    v_and_b32 v112, 0xffff, v112
    v_cmp_gt_u32 vcc, 32, v1
    s_nop 1
    v_cndmask_b32 v14, 0, v112, vcc
    v_lshlrev_b32 v2, 4, v1
    v_lshlrev_b32 v3, 3, v116
    v_add_u32 v3, 1024, v3
    v_lshrrev_b32 v117, 5, v1
    v_mul_u32_u24 v4, 320, v117
    v_lshl_add_u32 v4, v116, 4, v4
    v_add_u32 v4, 81920, v4
    s_mov_b32 s48, 0
    v_mov_b32 v96, 0
    v_mov_b32 v97, 0
    v_mov_b32 v98, 0
    v_mov_b32 v99, 0
    v_mov_b32 v100, 0
    v_mov_b32 v101, 0
    v_mov_b32 v102, 0
    v_mov_b32 v103, 0
    v_mov_b32 v104, 0
    v_mov_b32 v105, 0
    v_mov_b32 v106, 0
    v_mov_b32 v107, 0
    v_mov_b32 v108, 0
    v_mov_b32 v109, 0
    v_mov_b32 v110, 0
    v_mov_b32 v111, 0
m2_kernel_sl2:
    ds_read_b128 v[16:19], v2 offset:0
    ds_read_b64 v[20:21], v3 offset:0
    s_mov_b64 exec, s[50:51]
    ds_read_b128 v[32:35], v4 offset:0
    ds_read_b128 v[36:39], v4 offset:640
    s_mov_b64 exec, -1
    s_waitcnt lgkmcnt(0)
    v_mfma_f32_32x32x16_bf16 v[48:63], v[16:19], v[8:11], 0
    v_mfma_f32_32x32x16_bf16 v[48:63], v[20:23], v[12:15], v[48:63]
    s_nop 11
    v_exp_f32 v48, v48
    v_exp_f32 v49, v49
    v_exp_f32 v50, v50
    v_exp_f32 v51, v51
    v_exp_f32 v52, v52
    v_exp_f32 v53, v53
    v_exp_f32 v54, v54
    v_exp_f32 v55, v55
    v_exp_f32 v56, v56
    v_exp_f32 v57, v57
    v_exp_f32 v58, v58
    v_exp_f32 v59, v59
    v_exp_f32 v60, v60
    v_exp_f32 v61, v61
    v_exp_f32 v62, v62
    v_exp_f32 v63, v63
    v_cvt_pk_bf16_f32 v80, v48, v49
    v_cvt_pk_bf16_f32 v81, v50, v51
    v_cvt_pk_bf16_f32 v82, v52, v53
    v_cvt_pk_bf16_f32 v83, v54, v55
    v_cvt_pk_bf16_f32 v84, v56, v57
    v_cvt_pk_bf16_f32 v85, v58, v59
    v_cvt_pk_bf16_f32 v86, v60, v61
    v_cvt_pk_bf16_f32 v87, v62, v63
    v_mfma_f32_32x32x16_bf16 v[96:111], v[32:35], v[80:83], v[96:111]
    s_nop 0
    v_mfma_f32_32x32x16_bf16 v[96:111], v[36:39], v[84:87], v[96:111]
    v_add_u32 v2, 1280, v2
    v_add_u32 v3, 1280, v3
    v_add_u32 v4, 1280, v4
    s_add_u32 s48, s48, 1
    s_cmp_lt_u32 s48, 64
    s_cbranch_scc1 m2_kernel_sl2
    s_nop 15
    v_cmp_gt_u32 s[34:35], 32, v1
    s_nop 1
    v_cndmask_b32 v112, v104, v108, s[34:35]
    s_branch m2_kernel_store
m2_kernel_p2fin:
    s_waitcnt vmcnt(0) lgkmcnt(0)
    s_add_u32 s34, s23, 2654435761
    v_cmp_ne_u32 vcc, s34, v152
    v_cmp_ne_u32 s[36:37], s34, v153
    s_nop 3
    s_or_b64 vcc, vcc, s[36:37]
    v_cmp_ne_u32 s[36:37], s34, v154
    s_nop 3
    s_or_b64 vcc, vcc, s[36:37]
    v_cmp_ne_u32 s[36:37], s34, v155
    s_nop 3
    s_or_b64 vcc, vcc, s[36:37]
    s_cbranch_vccz m2_kernel_fwok
    s_add_u32 s34, s23, 2654435761
    s_mov_b32 s38, 0
m2_kernel_poll1:
    buffer_load_dword v152, v148, s[28:31], 0 offen sc1
    buffer_load_dword v153, v149, s[28:31], 0 offen sc1
    buffer_load_dword v154, v150, s[28:31], 0 offen sc1
    buffer_load_dword v155, v151, s[28:31], 0 offen sc1
    s_waitcnt vmcnt(0)
    v_cmp_ne_u32 vcc, s34, v152
    v_cmp_ne_u32 s[36:37], s34, v153
    s_nop 3
    s_or_b64 vcc, vcc, s[36:37]
    v_cmp_ne_u32 s[36:37], s34, v154
    s_nop 3
    s_or_b64 vcc, vcc, s[36:37]
    v_cmp_ne_u32 s[36:37], s34, v155
    s_nop 3
    s_or_b64 vcc, vcc, s[36:37]
    s_cbranch_vccz m2_kernel_pollok1
    s_add_u32 s38, s38, 1
    s_cmp_ge_u32 s38, 100000
    s_cbranch_scc1 m2_kernel_pollok1
    s_sleep 1
    s_branch m2_kernel_poll1
m2_kernel_pollok1:
m2_kernel_fwok:
    s_setprio 0
    s_cmp_lt_u32 s22, 4
    s_cbranch_scc1 m2_kernel_comp
    s_sub_u32 s22, s22, 4
    s_barrier
    s_cmp_lg_u32 s22, 0
    s_cbranch_scc1 m2_kernel_wo_nf
    s_add_u32 s34, s23, 1013904226
    v_mov_b32 v20, s34
    s_lshl_b32 s35, s2, 7
    s_add_u32 s35, s35, 32768
    v_mov_b32 v21, s35
    v_cmp_eq_u32 vcc, 0, v1
    s_nop 3
    s_and_saveexec_b64 s[36:37], vcc
    buffer_store_dword v20, v21, s[28:31], 0 offen sc1
    s_mov_b64 exec, s[36:37]
m2_kernel_wo_nf:
    s_add_u32 s40, s20, 7864320
    s_addc_u32 s41, s21, 0
    s_mov_b32 s42, 2621440
    s_mov_b32 s43, 0x00020000
    s_add_u32 s44, s20, 19816448
    s_addc_u32 s45, s21, 0
    s_mov_b32 s46, 819200
    s_mov_b32 s47, 0x00020000
    s_lshr_b32 s50, s22, 1
    s_and_b32 s51, s22, 1
    s_lshl_b32 s34, s26, 2
    s_and_b32 s35, s24, 3
    s_add_u32 s34, s34, s35
    s_lshl_b32 s34, s34, 2
    s_lshl_b32 s35, s51, 1
    s_add_u32 s34, s34, s35
    s_mul_i32 s34, s34, 20480
    s_mul_i32 s35, s50, 10240
    s_add_u32 s34, s34, s35
    v_lshlrev_b32 v2, 4, v1
    v_add_u32 v13, s34, v2
    v_add_u32 v14, 18432, v13
    s_lshl_b32 s52, s50, 13
    s_lshl_b32 s53, s51, 12
    s_add_u32 s52, s52, s53
    s_mul_i32 s53, s50, 10240
    s_mul_i32 s33, s51, 5120
    s_add_u32 s53, s53, s33
    s_mul_i32 s54, s27, 102400
    s_add_u32 s54, s54, s53
    s_add_u32 s53, s53, 65536
    s_mul_i32 s55, s27, 102400
    s_cmp_lg_u32 s22, 0
    s_cbranch_scc1 m2_kernel_wo_r1
    v_and_b32 v8, 31, v1
    s_lshl_b32 s35, s26, 5
    v_add_u32 v8, s35, v8
    v_lshlrev_b32 v8, 7, v8
    v_add_u32 v8, 32768, v8
    s_add_u32 s34, s23, 1013904226
    s_mov_b32 s38, 0
m2_kernel_poll2:
    buffer_load_dword v24, v8, s[28:31], 0 offen sc1
    s_waitcnt vmcnt(0)
    v_cmp_ne_u32 vcc, s34, v24
    s_cbranch_vccz m2_kernel_pollok2
    s_add_u32 s38, s38, 1
    s_cmp_ge_u32 s38, 100000
    s_cbranch_scc1 m2_kernel_pollok2
    s_sleep 1
    s_branch m2_kernel_poll2
m2_kernel_pollok2:
    s_barrier
    s_add_u32 m0, s52, 0
    s_movk_i32 s34, 0
    buffer_load_dwordx4 v13, s[40:43], s34 offen offset:0 lds
    buffer_load_dwordx4 v13, s[40:43], s34 offen offset:1024 lds
    buffer_load_dwordx4 v14, s[40:43], s34 offen offset:2048 lds
    buffer_load_dwordx4 v14, s[40:43], s34 offen offset:3072 lds
    s_add_u32 m0, s52, 16384
    s_movk_i32 s34, 2048
    buffer_load_dwordx4 v13, s[40:43], s34 offen offset:0 lds
    buffer_load_dwordx4 v13, s[40:43], s34 offen offset:1024 lds
    buffer_load_dwordx4 v14, s[40:43], s34 offen offset:2048 lds
    buffer_load_dwordx4 v14, s[40:43], s34 offen offset:3072 lds
    s_add_u32 m0, s52, 32768
    s_movk_i32 s34, 4096
    buffer_load_dwordx4 v13, s[40:43], s34 offen offset:0 lds
    buffer_load_dwordx4 v13, s[40:43], s34 offen offset:1024 lds
    buffer_load_dwordx4 v14, s[40:43], s34 offen offset:2048 lds
    buffer_load_dwordx4 v14, s[40:43], s34 offen offset:3072 lds
    s_add_u32 m0, s52, 49152
    s_movk_i32 s34, 6144
    buffer_load_dwordx4 v13, s[40:43], s34 offen offset:0 lds
    buffer_load_dwordx4 v13, s[40:43], s34 offen offset:1024 lds
    buffer_load_dwordx4 v14, s[40:43], s34 offen offset:2048 lds
    buffer_load_dwordx4 v14, s[40:43], s34 offen offset:3072 lds
    s_waitcnt vmcnt(12)
    s_barrier
    s_waitcnt vmcnt(8)
    s_barrier
    s_mov_b32 m0, 65536
    s_add_u32 s35, s55, 81920
    buffer_load_dwordx4 v2, s[44:47], s35 offen offset:0 lds
    buffer_load_dwordx4 v2, s[44:47], s35 offen offset:1024 lds
    buffer_load_dwordx4 v2, s[44:47], s35 offen offset:2048 lds
    buffer_load_dwordx4 v2, s[44:47], s35 offen offset:3072 lds
    s_mov_b32 m0, 69632
    s_add_u32 s35, s55, 86016
    buffer_load_dwordx4 v2, s[44:47], s35 offen offset:0 lds
    s_add_u32 m0, s52, 0
    s_movk_i32 s34, 8192
    buffer_load_dwordx4 v13, s[40:43], s34 offen offset:0 lds
    buffer_load_dwordx4 v13, s[40:43], s34 offen offset:1024 lds
    buffer_load_dwordx4 v14, s[40:43], s34 offen offset:2048 lds
    buffer_load_dwordx4 v14, s[40:43], s34 offen offset:3072 lds
    s_waitcnt vmcnt(13)
    s_barrier
    s_waitcnt vmcnt(9)
    s_barrier
    s_waitcnt vmcnt(0)
    s_barrier
    s_barrier
    s_barrier
    s_branch m2_kernel_wo_done
m2_kernel_wo_r1:
    s_cmp_lg_u32 s22, 1
    s_cbranch_scc1 m2_kernel_wo_r2
    s_mov_b32 m0, 65536
    s_add_u32 s35, s55, 0
    buffer_load_dwordx4 v2, s[44:47], s35 offen offset:0 lds
    buffer_load_dwordx4 v2, s[44:47], s35 offen offset:1024 lds
    buffer_load_dwordx4 v2, s[44:47], s35 offen offset:2048 lds
    buffer_load_dwordx4 v2, s[44:47], s35 offen offset:3072 lds
    s_mov_b32 m0, 69632
    s_add_u32 s35, s55, 4096
    buffer_load_dwordx4 v2, s[44:47], s35 offen offset:0 lds
    buffer_load_dwordx4 v2, s[44:47], s35 offen offset:1024 lds
    buffer_load_dwordx4 v2, s[44:47], s35 offen offset:2048 lds
    s_mov_b32 m0, 86016
    s_add_u32 s35, s55, 20480
    buffer_load_dwordx4 v2, s[44:47], s35 offen offset:0 lds
    buffer_load_dwordx4 v2, s[44:47], s35 offen offset:1024 lds
    buffer_load_dwordx4 v2, s[44:47], s35 offen offset:2048 lds
    buffer_load_dwordx4 v2, s[44:47], s35 offen offset:3072 lds
    s_mov_b32 m0, 90112
    s_add_u32 s35, s55, 24576
    buffer_load_dwordx4 v2, s[44:47], s35 offen offset:0 lds
    buffer_load_dwordx4 v2, s[44:47], s35 offen offset:1024 lds
    buffer_load_dwordx4 v2, s[44:47], s35 offen offset:2048 lds
    s_mov_b32 m0, 106496
    s_add_u32 s35, s55, 40960
    buffer_load_dwordx4 v2, s[44:47], s35 offen offset:0 lds
    buffer_load_dwordx4 v2, s[44:47], s35 offen offset:1024 lds
    buffer_load_dwordx4 v2, s[44:47], s35 offen offset:2048 lds
    buffer_load_dwordx4 v2, s[44:47], s35 offen offset:3072 lds
    s_mov_b32 m0, 110592
    s_add_u32 s35, s55, 45056
    buffer_load_dwordx4 v2, s[44:47], s35 offen offset:0 lds
    buffer_load_dwordx4 v2, s[44:47], s35 offen offset:1024 lds
    buffer_load_dwordx4 v2, s[44:47], s35 offen offset:2048 lds
    s_mov_b32 m0, 126976
    s_add_u32 s35, s55, 61440
    buffer_load_dwordx4 v2, s[44:47], s35 offen offset:0 lds
    buffer_load_dwordx4 v2, s[44:47], s35 offen offset:1024 lds
    buffer_load_dwordx4 v2, s[44:47], s35 offen offset:2048 lds
    buffer_load_dwordx4 v2, s[44:47], s35 offen offset:3072 lds
    s_mov_b32 m0, 131072
    s_add_u32 s35, s55, 65536
    buffer_load_dwordx4 v2, s[44:47], s35 offen offset:0 lds
    buffer_load_dwordx4 v2, s[44:47], s35 offen offset:1024 lds
    buffer_load_dwordx4 v2, s[44:47], s35 offen offset:2048 lds
    s_barrier
    s_add_u32 m0, s52, 0
    s_movk_i32 s34, 0
    buffer_load_dwordx4 v13, s[40:43], s34 offen offset:0 lds
    buffer_load_dwordx4 v13, s[40:43], s34 offen offset:1024 lds
    buffer_load_dwordx4 v14, s[40:43], s34 offen offset:2048 lds
    buffer_load_dwordx4 v14, s[40:43], s34 offen offset:3072 lds
    s_add_u32 m0, s52, 16384
    s_movk_i32 s34, 2048
    buffer_load_dwordx4 v13, s[40:43], s34 offen offset:0 lds
    buffer_load_dwordx4 v13, s[40:43], s34 offen offset:1024 lds
    buffer_load_dwordx4 v14, s[40:43], s34 offen offset:2048 lds
    buffer_load_dwordx4 v14, s[40:43], s34 offen offset:3072 lds
    s_add_u32 m0, s52, 32768
    s_movk_i32 s34, 4096
    buffer_load_dwordx4 v13, s[40:43], s34 offen offset:0 lds
    buffer_load_dwordx4 v13, s[40:43], s34 offen offset:1024 lds
    buffer_load_dwordx4 v14, s[40:43], s34 offen offset:2048 lds
    buffer_load_dwordx4 v14, s[40:43], s34 offen offset:3072 lds
    s_add_u32 m0, s52, 49152
    s_movk_i32 s34, 6144
    buffer_load_dwordx4 v13, s[40:43], s34 offen offset:0 lds
    buffer_load_dwordx4 v13, s[40:43], s34 offen offset:1024 lds
    buffer_load_dwordx4 v14, s[40:43], s34 offen offset:2048 lds
    buffer_load_dwordx4 v14, s[40:43], s34 offen offset:3072 lds
    s_waitcnt vmcnt(12)
    s_barrier
    s_waitcnt vmcnt(8)
    s_barrier
    s_mov_b32 m0, 70656
    s_add_u32 s35, s55, 87040
    buffer_load_dwordx4 v2, s[44:47], s35 offen offset:0 lds
    buffer_load_dwordx4 v2, s[44:47], s35 offen offset:1024 lds
    buffer_load_dwordx4 v2, s[44:47], s35 offen offset:2048 lds
    buffer_load_dwordx4 v2, s[44:47], s35 offen offset:3072 lds
    s_mov_b32 m0, 74752
    s_add_u32 s35, s55, 91136
    buffer_load_dwordx4 v2, s[44:47], s35 offen offset:0 lds
    s_add_u32 m0, s52, 0
    s_movk_i32 s34, 8192
    buffer_load_dwordx4 v13, s[40:43], s34 offen offset:0 lds
    buffer_load_dwordx4 v13, s[40:43], s34 offen offset:1024 lds
    buffer_load_dwordx4 v14, s[40:43], s34 offen offset:2048 lds
    buffer_load_dwordx4 v14, s[40:43], s34 offen offset:3072 lds
    s_waitcnt vmcnt(13)
    s_barrier
    s_waitcnt vmcnt(9)
    s_barrier
    s_waitcnt vmcnt(0)
    s_barrier
    s_barrier
    s_barrier
    s_branch m2_kernel_wo_done
m2_kernel_wo_r2:
    s_cmp_lg_u32 s22, 2
    s_cbranch_scc1 m2_kernel_wo_r3
    s_mov_b32 m0, 72704
    s_add_u32 s35, s55, 7168
    buffer_load_dwordx4 v2, s[44:47], s35 offen offset:0 lds
    buffer_load_dwordx4 v2, s[44:47], s35 offen offset:1024 lds
    buffer_load_dwordx4 v2, s[44:47], s35 offen offset:2048 lds
    buffer_load_dwordx4 v2, s[44:47], s35 offen offset:3072 lds
    s_mov_b32 m0, 76800
    s_add_u32 s35, s55, 11264
    buffer_load_dwordx4 v2, s[44:47], s35 offen offset:0 lds
    buffer_load_dwordx4 v2, s[44:47], s35 offen offset:1024 lds
    buffer_load_dwordx4 v2, s[44:47], s35 offen offset:2048 lds
    s_mov_b32 m0, 93184
    s_add_u32 s35, s55, 27648
    buffer_load_dwordx4 v2, s[44:47], s35 offen offset:0 lds
    buffer_load_dwordx4 v2, s[44:47], s35 offen offset:1024 lds
    buffer_load_dwordx4 v2, s[44:47], s35 offen offset:2048 lds
    buffer_load_dwordx4 v2, s[44:47], s35 offen offset:3072 lds
    s_mov_b32 m0, 97280
    s_add_u32 s35, s55, 31744
    buffer_load_dwordx4 v2, s[44:47], s35 offen offset:0 lds
    buffer_load_dwordx4 v2, s[44:47], s35 offen offset:1024 lds
    buffer_load_dwordx4 v2, s[44:47], s35 offen offset:2048 lds
    s_mov_b32 m0, 113664
    s_add_u32 s35, s55, 48128
    buffer_load_dwordx4 v2, s[44:47], s35 offen offset:0 lds
    buffer_load_dwordx4 v2, s[44:47], s35 offen offset:1024 lds
    buffer_load_dwordx4 v2, s[44:47], s35 offen offset:2048 lds
    buffer_load_dwordx4 v2, s[44:47], s35 offen offset:3072 lds
    s_mov_b32 m0, 117760
    s_add_u32 s35, s55, 52224
    buffer_load_dwordx4 v2, s[44:47], s35 offen offset:0 lds
    buffer_load_dwordx4 v2, s[44:47], s35 offen offset:1024 lds
    buffer_load_dwordx4 v2, s[44:47], s35 offen offset:2048 lds
    s_mov_b32 m0, 134144
    s_add_u32 s35, s55, 68608
    buffer_load_dwordx4 v2, s[44:47], s35 offen offset:0 lds
    buffer_load_dwordx4 v2, s[44:47], s35 offen offset:1024 lds
    buffer_load_dwordx4 v2, s[44:47], s35 offen offset:2048 lds
    buffer_load_dwordx4 v2, s[44:47], s35 offen offset:3072 lds
    s_mov_b32 m0, 138240
    s_add_u32 s35, s55, 72704
    buffer_load_dwordx4 v2, s[44:47], s35 offen offset:0 lds
    buffer_load_dwordx4 v2, s[44:47], s35 offen offset:1024 lds
    buffer_load_dwordx4 v2, s[44:47], s35 offen offset:2048 lds
    s_barrier
    s_add_u32 m0, s52, 0
    s_movk_i32 s34, 0
    buffer_load_dwordx4 v13, s[40:43], s34 offen offset:0 lds
    buffer_load_dwordx4 v13, s[40:43], s34 offen offset:1024 lds
    buffer_load_dwordx4 v14, s[40:43], s34 offen offset:2048 lds
    buffer_load_dwordx4 v14, s[40:43], s34 offen offset:3072 lds
    s_add_u32 m0, s52, 16384
    s_movk_i32 s34, 2048
    buffer_load_dwordx4 v13, s[40:43], s34 offen offset:0 lds
    buffer_load_dwordx4 v13, s[40:43], s34 offen offset:1024 lds
    buffer_load_dwordx4 v14, s[40:43], s34 offen offset:2048 lds
    buffer_load_dwordx4 v14, s[40:43], s34 offen offset:3072 lds
    s_add_u32 m0, s52, 32768
    s_movk_i32 s34, 4096
    buffer_load_dwordx4 v13, s[40:43], s34 offen offset:0 lds
    buffer_load_dwordx4 v13, s[40:43], s34 offen offset:1024 lds
    buffer_load_dwordx4 v14, s[40:43], s34 offen offset:2048 lds
    buffer_load_dwordx4 v14, s[40:43], s34 offen offset:3072 lds
    s_add_u32 m0, s52, 49152
    s_movk_i32 s34, 6144
    buffer_load_dwordx4 v13, s[40:43], s34 offen offset:0 lds
    buffer_load_dwordx4 v13, s[40:43], s34 offen offset:1024 lds
    buffer_load_dwordx4 v14, s[40:43], s34 offen offset:2048 lds
    buffer_load_dwordx4 v14, s[40:43], s34 offen offset:3072 lds
    s_waitcnt vmcnt(12)
    s_barrier
    s_waitcnt vmcnt(8)
    s_barrier
    s_mov_b32 m0, 75776
    s_add_u32 s35, s55, 92160
    buffer_load_dwordx4 v2, s[44:47], s35 offen offset:0 lds
    buffer_load_dwordx4 v2, s[44:47], s35 offen offset:1024 lds
    buffer_load_dwordx4 v2, s[44:47], s35 offen offset:2048 lds
    buffer_load_dwordx4 v2, s[44:47], s35 offen offset:3072 lds
    s_mov_b32 m0, 79872
    s_add_u32 s35, s55, 96256
    buffer_load_dwordx4 v2, s[44:47], s35 offen offset:0 lds
    s_add_u32 m0, s52, 0
    s_movk_i32 s34, 8192
    buffer_load_dwordx4 v13, s[40:43], s34 offen offset:0 lds
    buffer_load_dwordx4 v13, s[40:43], s34 offen offset:1024 lds
    buffer_load_dwordx4 v14, s[40:43], s34 offen offset:2048 lds
    buffer_load_dwordx4 v14, s[40:43], s34 offen offset:3072 lds
    s_waitcnt vmcnt(13)
    s_barrier
    s_waitcnt vmcnt(9)
    s_barrier
    s_waitcnt vmcnt(0)
    s_barrier
    s_barrier
    s_barrier
    s_branch m2_kernel_wo_done
m2_kernel_wo_r3:
    s_mov_b32 m0, 79872
    s_add_u32 s35, s55, 14336
    buffer_load_dwordx4 v2, s[44:47], s35 offen offset:0 lds
    buffer_load_dwordx4 v2, s[44:47], s35 offen offset:1024 lds
    buffer_load_dwordx4 v2, s[44:47], s35 offen offset:2048 lds
    buffer_load_dwordx4 v2, s[44:47], s35 offen offset:3072 lds
    s_mov_b32 m0, 83968
    s_add_u32 s35, s55, 18432
    buffer_load_dwordx4 v2, s[44:47], s35 offen offset:0 lds
    buffer_load_dwordx4 v2, s[44:47], s35 offen offset:1024 lds
    s_mov_b32 m0, 100352
    s_add_u32 s35, s55, 34816
    buffer_load_dwordx4 v2, s[44:47], s35 offen offset:0 lds
    buffer_load_dwordx4 v2, s[44:47], s35 offen offset:1024 lds
    buffer_load_dwordx4 v2, s[44:47], s35 offen offset:2048 lds
    buffer_load_dwordx4 v2, s[44:47], s35 offen offset:3072 lds
    s_mov_b32 m0, 104448
    s_add_u32 s35, s55, 38912
    buffer_load_dwordx4 v2, s[44:47], s35 offen offset:0 lds
    buffer_load_dwordx4 v2, s[44:47], s35 offen offset:1024 lds
    s_mov_b32 m0, 120832
    s_add_u32 s35, s55, 55296
    buffer_load_dwordx4 v2, s[44:47], s35 offen offset:0 lds
    buffer_load_dwordx4 v2, s[44:47], s35 offen offset:1024 lds
    buffer_load_dwordx4 v2, s[44:47], s35 offen offset:2048 lds
    buffer_load_dwordx4 v2, s[44:47], s35 offen offset:3072 lds
    s_mov_b32 m0, 124928
    s_add_u32 s35, s55, 59392
    buffer_load_dwordx4 v2, s[44:47], s35 offen offset:0 lds
    buffer_load_dwordx4 v2, s[44:47], s35 offen offset:1024 lds
    s_mov_b32 m0, 141312
    s_add_u32 s35, s55, 75776
    buffer_load_dwordx4 v2, s[44:47], s35 offen offset:0 lds
    buffer_load_dwordx4 v2, s[44:47], s35 offen offset:1024 lds
    buffer_load_dwordx4 v2, s[44:47], s35 offen offset:2048 lds
    buffer_load_dwordx4 v2, s[44:47], s35 offen offset:3072 lds
    s_mov_b32 m0, 145408
    s_add_u32 s35, s55, 79872
    buffer_load_dwordx4 v2, s[44:47], s35 offen offset:0 lds
    buffer_load_dwordx4 v2, s[44:47], s35 offen offset:1024 lds
    s_barrier
    s_add_u32 m0, s52, 0
    s_movk_i32 s34, 0
    buffer_load_dwordx4 v13, s[40:43], s34 offen offset:0 lds
    buffer_load_dwordx4 v13, s[40:43], s34 offen offset:1024 lds
    buffer_load_dwordx4 v14, s[40:43], s34 offen offset:2048 lds
    buffer_load_dwordx4 v14, s[40:43], s34 offen offset:3072 lds
    s_add_u32 m0, s52, 16384
    s_movk_i32 s34, 2048
    buffer_load_dwordx4 v13, s[40:43], s34 offen offset:0 lds
    buffer_load_dwordx4 v13, s[40:43], s34 offen offset:1024 lds
    buffer_load_dwordx4 v14, s[40:43], s34 offen offset:2048 lds
    buffer_load_dwordx4 v14, s[40:43], s34 offen offset:3072 lds
    s_add_u32 m0, s52, 32768
    s_movk_i32 s34, 4096
    buffer_load_dwordx4 v13, s[40:43], s34 offen offset:0 lds
    buffer_load_dwordx4 v13, s[40:43], s34 offen offset:1024 lds
    buffer_load_dwordx4 v14, s[40:43], s34 offen offset:2048 lds
    buffer_load_dwordx4 v14, s[40:43], s34 offen offset:3072 lds
    s_add_u32 m0, s52, 49152
    s_movk_i32 s34, 6144
    buffer_load_dwordx4 v13, s[40:43], s34 offen offset:0 lds
    buffer_load_dwordx4 v13, s[40:43], s34 offen offset:1024 lds
    buffer_load_dwordx4 v14, s[40:43], s34 offen offset:2048 lds
    buffer_load_dwordx4 v14, s[40:43], s34 offen offset:3072 lds
    s_waitcnt vmcnt(12)
    s_barrier
    s_waitcnt vmcnt(8)
    s_barrier
    s_mov_b32 m0, 80896
    s_add_u32 s35, s55, 97280
    buffer_load_dwordx4 v2, s[44:47], s35 offen offset:0 lds
    buffer_load_dwordx4 v2, s[44:47], s35 offen offset:1024 lds
    buffer_load_dwordx4 v2, s[44:47], s35 offen offset:2048 lds
    buffer_load_dwordx4 v2, s[44:47], s35 offen offset:3072 lds
    s_mov_b32 m0, 84992
    s_add_u32 s35, s55, 101376
    buffer_load_dwordx4 v2, s[44:47], s35 offen offset:0 lds
    s_add_u32 m0, s52, 0
    s_movk_i32 s34, 8192
    buffer_load_dwordx4 v13, s[40:43], s34 offen offset:0 lds
    buffer_load_dwordx4 v13, s[40:43], s34 offen offset:1024 lds
    buffer_load_dwordx4 v14, s[40:43], s34 offen offset:2048 lds
    buffer_load_dwordx4 v14, s[40:43], s34 offen offset:3072 lds
    s_waitcnt vmcnt(13)
    s_barrier
    s_waitcnt vmcnt(9)
    s_barrier
    s_waitcnt vmcnt(0)
    s_barrier
    s_barrier
    s_barrier
m2_kernel_wo_done:
    s_cmp_lg_u32 s22, 0
    s_cbranch_scc1 m2_kernel_p4_nf
    s_add_u32 s34, s23, 3668339987
    v_mov_b32 v20, s34
    s_lshl_b32 s35, s2, 7
    s_add_u32 s35, s35, 65536
    v_mov_b32 v21, s35
    v_cmp_eq_u32 vcc, 0, v1
    s_nop 3
    s_and_saveexec_b64 s[36:37], vcc
    buffer_store_dword v20, v21, s[28:31], 0 offen sc1
    s_mov_b64 exec, s[36:37]
m2_kernel_p4_nf:
    s_add_u32 s40, s20, 10485760
    s_addc_u32 s41, s21, 0
    s_mov_b32 s42, 2621440
    s_mov_b32 s43, 0x00020000
    s_add_u32 s44, s20, 20635648
    s_addc_u32 s45, s21, 0
    s_mov_b32 s46, 3932160
    s_mov_b32 s47, 0x00020000
    s_add_u32 s48, s20, 19398656
    s_addc_u32 s49, s21, 0
    s_mov_b32 s50, 262144
    s_mov_b32 s51, 0x00020000
    s_add_u32 s52, s20, 19685376
    s_addc_u32 s53, s21, 0
    s_mov_b32 s54, 61440
    s_mov_b32 s55, 0x00020000
    s_lshl_b32 s56, s26, 1
    s_and_b32 s34, s24, 1
    s_add_u32 s56, s56, s34
    s_lshr_b32 s57, s24, 1
    s_lshl_b32 s57, s57, 2
    s_add_u32 s57, s57, s25
    s_lshl_b32 s34, s56, 3
    s_lshl_b32 s35, s22, 1
    s_add_u32 s34, s34, s35
    s_mul_i32 s34, s34, 20480
    v_lshlrev_b32 v2, 4, v1
    v_add_u32 v14, s34, v2
    v_add_u32 v15, 18432, v14
    s_lshl_b32 s58, s22, 12
    s_mul_i32 s59, s22, 6144
    s_mul_i32 s60, s57, 245760
    s_add_u32 s60, s60, s59
    s_add_u32 s59, s59, 65536
    s_lshl_b32 s34, s56, 7
    s_lshl_b32 s35, s22, 6
    s_add_u32 s34, s34, s35
    v_add_u32 v16, s34, v1
    v_lshlrev_b32 v16, 7, v16
    v_cmp_gt_u32 vcc, 24, v1
    v_lshlrev_b32 v17, 4, v1
    v_add_u32 v18, 5760, v17
    v_cndmask_b32 v17, v18, v17, vcc
    s_mul_i32 s34, s57, 384
    v_add_u32 v17, s34, v17
    v_cmp_gt_u32 vcc, 48, v1
    v_mov_b32 v18, 0x7f000000
    s_nop 0
    v_cndmask_b32 v17, v18, v17, vcc
    s_mul_i32 s61, s57, 245760
    s_cmp_lg_u32 s22, 0
    s_cbranch_scc1 m2_kernel_p4r1
    v_bfe_u32 v8, v1, 2, 2
    v_lshlrev_b32 v8, 3, v8
    v_bfe_u32 v9, v1, 1, 1
    v_lshl_add_u32 v8, v9, 2, v8
    v_and_b32 v9, 1, v1
    v_add_u32 v8, v8, v9
    s_lshl_b32 s35, s26, 5
    s_and_b32 s34, s24, 1
    s_lshl_b32 s34, s34, 1
    s_add_u32 s35, s35, s34
    v_add_u32 v8, s35, v8
    v_lshlrev_b32 v8, 7, v8
    v_add_u32 v8, 65536, v8
    s_add_u32 s34, s23, 3668339987
    s_mov_b32 s38, 0
m2_kernel_poll3:
    buffer_load_dword v24, v8, s[28:31], 0 offen sc1
    s_waitcnt vmcnt(0)
    v_cmp_ne_u32 vcc, s34, v24
    s_cbranch_vccz m2_kernel_pollok3
    s_add_u32 s38, s38, 1
    s_cmp_ge_u32 s38, 100000
    s_cbranch_scc1 m2_kernel_pollok3
    s_sleep 1
    s_branch m2_kernel_poll3
m2_kernel_pollok3:
    s_barrier
    s_add_u32 m0, s58, 0
    s_movk_i32 s34, 0
    buffer_load_dwordx4 v14, s[40:43], s34 offen offset:0 lds
    buffer_load_dwordx4 v14, s[40:43], s34 offen offset:1024 lds
    buffer_load_dwordx4 v15, s[40:43], s34 offen offset:2048 lds
    buffer_load_dwordx4 v15, s[40:43], s34 offen offset:3072 lds
    s_add_u32 m0, s58, 16384
    s_movk_i32 s34, 2048
    buffer_load_dwordx4 v14, s[40:43], s34 offen offset:0 lds
    buffer_load_dwordx4 v14, s[40:43], s34 offen offset:1024 lds
    buffer_load_dwordx4 v15, s[40:43], s34 offen offset:2048 lds
    buffer_load_dwordx4 v15, s[40:43], s34 offen offset:3072 lds
    s_add_u32 m0, s58, 32768
    s_movk_i32 s34, 4096
    buffer_load_dwordx4 v14, s[40:43], s34 offen offset:0 lds
    buffer_load_dwordx4 v14, s[40:43], s34 offen offset:1024 lds
    buffer_load_dwordx4 v15, s[40:43], s34 offen offset:2048 lds
    buffer_load_dwordx4 v15, s[40:43], s34 offen offset:3072 lds
    s_add_u32 m0, s58, 49152
    s_movk_i32 s34, 6144
    buffer_load_dwordx4 v14, s[40:43], s34 offen offset:0 lds
    buffer_load_dwordx4 v14, s[40:43], s34 offen offset:1024 lds
    buffer_load_dwordx4 v15, s[40:43], s34 offen offset:2048 lds
    buffer_load_dwordx4 v15, s[40:43], s34 offen offset:3072 lds
    buffer_load_dwordx4 v[32:35], v16, s[48:51], 0 offen offset:0 sc1
    buffer_load_dwordx4 v[36:39], v16, s[48:51], 0 offen offset:16 sc1
    buffer_load_dwordx4 v[40:43], v16, s[48:51], 0 offen offset:32 sc1
    buffer_load_dwordx4 v[44:47], v16, s[48:51], 0 offen offset:48 sc1
    buffer_load_dwordx4 v[48:51], v16, s[48:51], 0 offen offset:64 sc1
    buffer_load_dwordx4 v[52:55], v16, s[48:51], 0 offen offset:80 sc1
    buffer_load_dwordx4 v[56:59], v16, s[48:51], 0 offen offset:96 sc1
    buffer_load_dwordx4 v[60:63], v16, s[48:51], 0 offen offset:112 sc1
    s_waitcnt vmcnt(20)
    s_barrier
    s_waitcnt vmcnt(16)
    s_barrier
    s_mov_b32 m0, 65536
    s_add_u32 s35, s61, 98304
    buffer_load_dwordx4 v2, s[44:47], s35 offen offset:0 lds
    buffer_load_dwordx4 v2, s[44:47], s35 offen offset:1024 lds
    buffer_load_dwordx4 v2, s[44:47], s35 offen offset:2048 lds
    buffer_load_dwordx4 v2, s[44:47], s35 offen offset:3072 lds
    s_mov_b32 m0, 69632
    s_add_u32 s35, s61, 102400
    buffer_load_dwordx4 v2, s[44:47], s35 offen offset:0 lds
    buffer_load_dwordx4 v2, s[44:47], s35 offen offset:1024 lds
    s_add_u32 m0, s58, 0
    s_movk_i32 s34, 8192
    buffer_load_dwordx4 v14, s[40:43], s34 offen offset:0 lds
    buffer_load_dwordx4 v14, s[40:43], s34 offen offset:1024 lds
    buffer_load_dwordx4 v15, s[40:43], s34 offen offset:2048 lds
    buffer_load_dwordx4 v15, s[40:43], s34 offen offset:3072 lds
    s_waitcnt vmcnt(22)
    s_barrier
    s_mov_b32 m0, 90112
    s_add_u32 s35, s61, 122880
    buffer_load_dwordx4 v2, s[44:47], s35 offen offset:0 lds
    buffer_load_dwordx4 v2, s[44:47], s35 offen offset:1024 lds
    buffer_load_dwordx4 v2, s[44:47], s35 offen offset:2048 lds
    buffer_load_dwordx4 v2, s[44:47], s35 offen offset:3072 lds
    s_mov_b32 m0, 94208
    s_add_u32 s35, s61, 126976
    buffer_load_dwordx4 v2, s[44:47], s35 offen offset:0 lds
    buffer_load_dwordx4 v2, s[44:47], s35 offen offset:1024 lds
    s_add_u32 m0, s58, 16384
    s_movk_i32 s34, 10240
    buffer_load_dwordx4 v14, s[40:43], s34 offen offset:0 lds
    buffer_load_dwordx4 v14, s[40:43], s34 offen offset:1024 lds
    buffer_load_dwordx4 v15, s[40:43], s34 offen offset:2048 lds
    buffer_load_dwordx4 v15, s[40:43], s34 offen offset:3072 lds
    s_waitcnt vmcnt(28)
    s_barrier
    s_mov_b32 m0, 114688
    s_add_u32 s35, s61, 147456
    buffer_load_dwordx4 v2, s[44:47], s35 offen offset:0 lds
    buffer_load_dwordx4 v2, s[44:47], s35 offen offset:1024 lds
    buffer_load_dwordx4 v2, s[44:47], s35 offen offset:2048 lds
    buffer_load_dwordx4 v2, s[44:47], s35 offen offset:3072 lds
    s_mov_b32 m0, 118784
    s_add_u32 s35, s61, 151552
    buffer_load_dwordx4 v2, s[44:47], s35 offen offset:0 lds
    buffer_load_dwordx4 v2, s[44:47], s35 offen offset:1024 lds
    s_add_u32 m0, s58, 32768
    s_movk_i32 s34, 12288
    buffer_load_dwordx4 v14, s[40:43], s34 offen offset:0 lds
    buffer_load_dwordx4 v14, s[40:43], s34 offen offset:1024 lds
    buffer_load_dwordx4 v15, s[40:43], s34 offen offset:2048 lds
    buffer_load_dwordx4 v15, s[40:43], s34 offen offset:3072 lds
    s_waitcnt vmcnt(20)
    s_barrier
    s_mov_b32 m0, 139264
    s_add_u32 s35, s61, 172032
    buffer_load_dwordx4 v2, s[44:47], s35 offen offset:0 lds
    buffer_load_dwordx4 v2, s[44:47], s35 offen offset:1024 lds
    buffer_load_dwordx4 v2, s[44:47], s35 offen offset:2048 lds
    buffer_load_dwordx4 v2, s[44:47], s35 offen offset:3072 lds
    s_mov_b32 m0, 143360
    s_add_u32 s35, s61, 176128
    buffer_load_dwordx4 v2, s[44:47], s35 offen offset:0 lds
    buffer_load_dwordx4 v2, s[44:47], s35 offen offset:1024 lds
    s_add_u32 m0, s58, 49152
    s_movk_i32 s34, 14336
    buffer_load_dwordx4 v14, s[40:43], s34 offen offset:0 lds
    buffer_load_dwordx4 v14, s[40:43], s34 offen offset:1024 lds
    buffer_load_dwordx4 v15, s[40:43], s34 offen offset:2048 lds
    buffer_load_dwordx4 v15, s[40:43], s34 offen offset:3072 lds
    s_waitcnt vmcnt(20)
    s_barrier
    s_mov_b32 m0, 65536
    s_add_u32 s35, s61, 196608
    buffer_load_dwordx4 v2, s[44:47], s35 offen offset:0 lds
    buffer_load_dwordx4 v2, s[44:47], s35 offen offset:1024 lds
    buffer_load_dwordx4 v2, s[44:47], s35 offen offset:2048 lds
    buffer_load_dwordx4 v2, s[44:47], s35 offen offset:3072 lds
    s_mov_b32 m0, 69632
    s_add_u32 s35, s61, 200704
    buffer_load_dwordx4 v2, s[44:47], s35 offen offset:0 lds
    buffer_load_dwordx4 v2, s[44:47], s35 offen offset:1024 lds
    s_add_u32 m0, s58, 0
    s_movk_i32 s34, 16384
    buffer_load_dwordx4 v14, s[40:43], s34 offen offset:0 lds
    buffer_load_dwordx4 v14, s[40:43], s34 offen offset:1024 lds
    buffer_load_dwordx4 v15, s[40:43], s34 offen offset:2048 lds
    buffer_load_dwordx4 v15, s[40:43], s34 offen offset:3072 lds
    s_waitcnt vmcnt(20)
    s_barrier
    s_mov_b32 m0, 90112
    s_add_u32 s35, s61, 221184
    buffer_load_dwordx4 v2, s[44:47], s35 offen offset:0 lds
    buffer_load_dwordx4 v2, s[44:47], s35 offen offset:1024 lds
    buffer_load_dwordx4 v2, s[44:47], s35 offen offset:2048 lds
    buffer_load_dwordx4 v2, s[44:47], s35 offen offset:3072 lds
    s_mov_b32 m0, 94208
    s_add_u32 s35, s61, 225280
    buffer_load_dwordx4 v2, s[44:47], s35 offen offset:0 lds
    buffer_load_dwordx4 v2, s[44:47], s35 offen offset:1024 lds
    s_add_u32 m0, s58, 16384
    s_movk_i32 s34, 18432
    buffer_load_dwordx4 v14, s[40:43], s34 offen offset:0 lds
    buffer_load_dwordx4 v14, s[40:43], s34 offen offset:1024 lds
    buffer_load_dwordx4 v15, s[40:43], s34 offen offset:2048 lds
    buffer_load_dwordx4 v15, s[40:43], s34 offen offset:3072 lds
    s_waitcnt vmcnt(20)
    s_barrier
    s_waitcnt vmcnt(10)
    s_barrier
    s_waitcnt vmcnt(0)
    s_waitcnt vmcnt(0)
    v_pk_add_f32 v[32:33], v[32:33], v[34:35]
    v_pk_add_f32 v[32:33], v[32:33], v[36:37]
    v_pk_add_f32 v[32:33], v[32:33], v[38:39]
    v_pk_add_f32 v[32:33], v[32:33], v[40:41]
    v_pk_add_f32 v[32:33], v[32:33], v[42:43]
    v_pk_add_f32 v[32:33], v[32:33], v[44:45]
    v_pk_add_f32 v[32:33], v[32:33], v[46:47]
    v_pk_add_f32 v[32:33], v[32:33], v[48:49]
    v_pk_add_f32 v[32:33], v[32:33], v[50:51]
    v_pk_add_f32 v[32:33], v[32:33], v[52:53]
    v_pk_add_f32 v[32:33], v[32:33], v[54:55]
    v_pk_add_f32 v[32:33], v[32:33], v[56:57]
    v_pk_add_f32 v[32:33], v[32:33], v[58:59]
    v_pk_add_f32 v[32:33], v[32:33], v[60:61]
    v_pk_add_f32 v[32:33], v[32:33], v[62:63]
    v_mul_f32 v32, 0x3acccccd, v32
    v_mul_f32 v33, 0x3acccccd, v33
    v_fma_f32 v33, -v32, v32, v33
    v_max_f32 v33, 0, v33
    v_add_f32 v33, 0x3727c5ac, v33
    v_rsq_f32 v33, v33
    s_nop 0
    v_mul_f32 v32, v32, v33
    s_lshl_b32 s34, s22, 8
    v_lshlrev_b32 v16, 2, v1
    v_add_u32 v16, s34, v16
    s_barrier
    ds_write_b32 v16, v33 offset:0
    ds_write_b32 v16, v32 offset:512
    s_waitcnt lgkmcnt(0)
    s_barrier
    s_branch m2_kernel_p4done
m2_kernel_p4r1:
    s_cmp_lg_u32 s22, 1
    s_cbranch_scc1 m2_kernel_p4r2
    s_mov_b32 m0, 65536
    s_add_u32 s35, s61, 0
    buffer_load_dwordx4 v2, s[44:47], s35 offen offset:0 lds
    buffer_load_dwordx4 v2, s[44:47], s35 offen offset:1024 lds
    buffer_load_dwordx4 v2, s[44:47], s35 offen offset:2048 lds
    buffer_load_dwordx4 v2, s[44:47], s35 offen offset:3072 lds
    s_mov_b32 m0, 69632
    s_add_u32 s35, s61, 4096
    buffer_load_dwordx4 v2, s[44:47], s35 offen offset:0 lds
    buffer_load_dwordx4 v2, s[44:47], s35 offen offset:1024 lds
    buffer_load_dwordx4 v2, s[44:47], s35 offen offset:2048 lds
    buffer_load_dwordx4 v2, s[44:47], s35 offen offset:3072 lds
    s_mov_b32 m0, 90112
    s_add_u32 s35, s61, 24576
    buffer_load_dwordx4 v2, s[44:47], s35 offen offset:0 lds
    buffer_load_dwordx4 v2, s[44:47], s35 offen offset:1024 lds
    buffer_load_dwordx4 v2, s[44:47], s35 offen offset:2048 lds
    buffer_load_dwordx4 v2, s[44:47], s35 offen offset:3072 lds
    s_mov_b32 m0, 94208
    s_add_u32 s35, s61, 28672
    buffer_load_dwordx4 v2, s[44:47], s35 offen offset:0 lds
    buffer_load_dwordx4 v2, s[44:47], s35 offen offset:1024 lds
    buffer_load_dwordx4 v2, s[44:47], s35 offen offset:2048 lds
    buffer_load_dwordx4 v2, s[44:47], s35 offen offset:3072 lds
    s_mov_b32 m0, 114688
    s_add_u32 s35, s61, 49152
    buffer_load_dwordx4 v2, s[44:47], s35 offen offset:0 lds
    buffer_load_dwordx4 v2, s[44:47], s35 offen offset:1024 lds
    buffer_load_dwordx4 v2, s[44:47], s35 offen offset:2048 lds
    buffer_load_dwordx4 v2, s[44:47], s35 offen offset:3072 lds
    s_mov_b32 m0, 118784
    s_add_u32 s35, s61, 53248
    buffer_load_dwordx4 v2, s[44:47], s35 offen offset:0 lds
    buffer_load_dwordx4 v2, s[44:47], s35 offen offset:1024 lds
    buffer_load_dwordx4 v2, s[44:47], s35 offen offset:2048 lds
    buffer_load_dwordx4 v2, s[44:47], s35 offen offset:3072 lds
    s_mov_b32 m0, 139264
    s_add_u32 s35, s61, 73728
    buffer_load_dwordx4 v2, s[44:47], s35 offen offset:0 lds
    buffer_load_dwordx4 v2, s[44:47], s35 offen offset:1024 lds
    buffer_load_dwordx4 v2, s[44:47], s35 offen offset:2048 lds
    buffer_load_dwordx4 v2, s[44:47], s35 offen offset:3072 lds
    s_mov_b32 m0, 143360
    s_add_u32 s35, s61, 77824
    buffer_load_dwordx4 v2, s[44:47], s35 offen offset:0 lds
    buffer_load_dwordx4 v2, s[44:47], s35 offen offset:1024 lds
    buffer_load_dwordx4 v2, s[44:47], s35 offen offset:2048 lds
    buffer_load_dwordx4 v2, s[44:47], s35 offen offset:3072 lds
    s_barrier
    s_add_u32 m0, s58, 0
    s_movk_i32 s34, 0
    buffer_load_dwordx4 v14, s[40:43], s34 offen offset:0 lds
    buffer_load_dwordx4 v14, s[40:43], s34 offen offset:1024 lds
    buffer_load_dwordx4 v15, s[40:43], s34 offen offset:2048 lds
    buffer_load_dwordx4 v15, s[40:43], s34 offen offset:3072 lds
    s_add_u32 m0, s58, 16384
    s_movk_i32 s34, 2048
    buffer_load_dwordx4 v14, s[40:43], s34 offen offset:0 lds
    buffer_load_dwordx4 v14, s[40:43], s34 offen offset:1024 lds
    buffer_load_dwordx4 v15, s[40:43], s34 offen offset:2048 lds
    buffer_load_dwordx4 v15, s[40:43], s34 offen offset:3072 lds
    s_add_u32 m0, s58, 32768
    s_movk_i32 s34, 4096
    buffer_load_dwordx4 v14, s[40:43], s34 offen offset:0 lds
    buffer_load_dwordx4 v14, s[40:43], s34 offen offset:1024 lds
    buffer_load_dwordx4 v15, s[40:43], s34 offen offset:2048 lds
    buffer_load_dwordx4 v15, s[40:43], s34 offen offset:3072 lds
    s_add_u32 m0, s58, 49152
    s_movk_i32 s34, 6144
    buffer_load_dwordx4 v14, s[40:43], s34 offen offset:0 lds
    buffer_load_dwordx4 v14, s[40:43], s34 offen offset:1024 lds
    buffer_load_dwordx4 v15, s[40:43], s34 offen offset:2048 lds
    buffer_load_dwordx4 v15, s[40:43], s34 offen offset:3072 lds
    buffer_load_dwordx4 v[32:35], v16, s[48:51], 0 offen offset:0 sc1
    buffer_load_dwordx4 v[36:39], v16, s[48:51], 0 offen offset:16 sc1
    buffer_load_dwordx4 v[40:43], v16, s[48:51], 0 offen offset:32 sc1
    buffer_load_dwordx4 v[44:47], v16, s[48:51], 0 offen offset:48 sc1
    buffer_load_dwordx4 v[48:51], v16, s[48:51], 0 offen offset:64 sc1
    buffer_load_dwordx4 v[52:55], v16, s[48:51], 0 offen offset:80 sc1
    buffer_load_dwordx4 v[56:59], v16, s[48:51], 0 offen offset:96 sc1
    buffer_load_dwordx4 v[60:63], v16, s[48:51], 0 offen offset:112 sc1
    s_waitcnt vmcnt(20)
    s_barrier
    s_waitcnt vmcnt(16)
    s_barrier
    s_mov_b32 m0, 71680
    s_add_u32 s35, s61, 104448
    buffer_load_dwordx4 v2, s[44:47], s35 offen offset:0 lds
    buffer_load_dwordx4 v2, s[44:47], s35 offen offset:1024 lds
    buffer_load_dwordx4 v2, s[44:47], s35 offen offset:2048 lds
    buffer_load_dwordx4 v2, s[44:47], s35 offen offset:3072 lds
    s_mov_b32 m0, 75776
    s_add_u32 s35, s61, 108544
    buffer_load_dwordx4 v2, s[44:47], s35 offen offset:0 lds
    buffer_load_dwordx4 v2, s[44:47], s35 offen offset:1024 lds
    s_add_u32 m0, s58, 0
    s_movk_i32 s34, 8192
    buffer_load_dwordx4 v14, s[40:43], s34 offen offset:0 lds
    buffer_load_dwordx4 v14, s[40:43], s34 offen offset:1024 lds
    buffer_load_dwordx4 v15, s[40:43], s34 offen offset:2048 lds
    buffer_load_dwordx4 v15, s[40:43], s34 offen offset:3072 lds
    s_waitcnt vmcnt(22)
    s_barrier
    s_mov_b32 m0, 96256
    s_add_u32 s35, s61, 129024
    buffer_load_dwordx4 v2, s[44:47], s35 offen offset:0 lds
    buffer_load_dwordx4 v2, s[44:47], s35 offen offset:1024 lds
    buffer_load_dwordx4 v2, s[44:47], s35 offen offset:2048 lds
    buffer_load_dwordx4 v2, s[44:47], s35 offen offset:3072 lds
    s_mov_b32 m0, 100352
    s_add_u32 s35, s61, 133120
    buffer_load_dwordx4 v2, s[44:47], s35 offen offset:0 lds
    buffer_load_dwordx4 v2, s[44:47], s35 offen offset:1024 lds
    s_add_u32 m0, s58, 16384
    s_movk_i32 s34, 10240
    buffer_load_dwordx4 v14, s[40:43], s34 offen offset:0 lds
    buffer_load_dwordx4 v14, s[40:43], s34 offen offset:1024 lds
    buffer_load_dwordx4 v15, s[40:43], s34 offen offset:2048 lds
    buffer_load_dwordx4 v15, s[40:43], s34 offen offset:3072 lds
    s_waitcnt vmcnt(28)
    s_barrier
    s_mov_b32 m0, 120832
    s_add_u32 s35, s61, 153600
    buffer_load_dwordx4 v2, s[44:47], s35 offen offset:0 lds
    buffer_load_dwordx4 v2, s[44:47], s35 offen offset:1024 lds
    buffer_load_dwordx4 v2, s[44:47], s35 offen offset:2048 lds
    buffer_load_dwordx4 v2, s[44:47], s35 offen offset:3072 lds
    s_mov_b32 m0, 124928
    s_add_u32 s35, s61, 157696
    buffer_load_dwordx4 v2, s[44:47], s35 offen offset:0 lds
    buffer_load_dwordx4 v2, s[44:47], s35 offen offset:1024 lds
    s_add_u32 m0, s58, 32768
    s_movk_i32 s34, 12288
    buffer_load_dwordx4 v14, s[40:43], s34 offen offset:0 lds
    buffer_load_dwordx4 v14, s[40:43], s34 offen offset:1024 lds
    buffer_load_dwordx4 v15, s[40:43], s34 offen offset:2048 lds
    buffer_load_dwordx4 v15, s[40:43], s34 offen offset:3072 lds
    s_waitcnt vmcnt(20)
    s_barrier
    s_mov_b32 m0, 145408
    s_add_u32 s35, s61, 178176
    buffer_load_dwordx4 v2, s[44:47], s35 offen offset:0 lds
    buffer_load_dwordx4 v2, s[44:47], s35 offen offset:1024 lds
    buffer_load_dwordx4 v2, s[44:47], s35 offen offset:2048 lds
    buffer_load_dwordx4 v2, s[44:47], s35 offen offset:3072 lds
    s_mov_b32 m0, 149504
    s_add_u32 s35, s61, 182272
    buffer_load_dwordx4 v2, s[44:47], s35 offen offset:0 lds
    buffer_load_dwordx4 v2, s[44:47], s35 offen offset:1024 lds
    s_add_u32 m0, s58, 49152
    s_movk_i32 s34, 14336
    buffer_load_dwordx4 v14, s[40:43], s34 offen offset:0 lds
    buffer_load_dwordx4 v14, s[40:43], s34 offen offset:1024 lds
    buffer_load_dwordx4 v15, s[40:43], s34 offen offset:2048 lds
    buffer_load_dwordx4 v15, s[40:43], s34 offen offset:3072 lds
    s_waitcnt vmcnt(20)
    s_barrier
    s_mov_b32 m0, 71680
    s_add_u32 s35, s61, 202752
    buffer_load_dwordx4 v2, s[44:47], s35 offen offset:0 lds
    buffer_load_dwordx4 v2, s[44:47], s35 offen offset:1024 lds
    buffer_load_dwordx4 v2, s[44:47], s35 offen offset:2048 lds
    buffer_load_dwordx4 v2, s[44:47], s35 offen offset:3072 lds
    s_mov_b32 m0, 75776
    s_add_u32 s35, s61, 206848
    buffer_load_dwordx4 v2, s[44:47], s35 offen offset:0 lds
    buffer_load_dwordx4 v2, s[44:47], s35 offen offset:1024 lds
    s_add_u32 m0, s58, 0
    s_movk_i32 s34, 16384
    buffer_load_dwordx4 v14, s[40:43], s34 offen offset:0 lds
    buffer_load_dwordx4 v14, s[40:43], s34 offen offset:1024 lds
    buffer_load_dwordx4 v15, s[40:43], s34 offen offset:2048 lds
    buffer_load_dwordx4 v15, s[40:43], s34 offen offset:3072 lds
    s_waitcnt vmcnt(20)
    s_barrier
    s_mov_b32 m0, 96256
    s_add_u32 s35, s61, 227328
    buffer_load_dwordx4 v2, s[44:47], s35 offen offset:0 lds
    buffer_load_dwordx4 v2, s[44:47], s35 offen offset:1024 lds
    buffer_load_dwordx4 v2, s[44:47], s35 offen offset:2048 lds
    buffer_load_dwordx4 v2, s[44:47], s35 offen offset:3072 lds
    s_mov_b32 m0, 100352
    s_add_u32 s35, s61, 231424
    buffer_load_dwordx4 v2, s[44:47], s35 offen offset:0 lds
    buffer_load_dwordx4 v2, s[44:47], s35 offen offset:1024 lds
    s_add_u32 m0, s58, 16384
    s_movk_i32 s34, 18432
    buffer_load_dwordx4 v14, s[40:43], s34 offen offset:0 lds
    buffer_load_dwordx4 v14, s[40:43], s34 offen offset:1024 lds
    buffer_load_dwordx4 v15, s[40:43], s34 offen offset:2048 lds
    buffer_load_dwordx4 v15, s[40:43], s34 offen offset:3072 lds
    s_waitcnt vmcnt(20)
    s_barrier
    s_waitcnt vmcnt(10)
    s_barrier
    s_waitcnt vmcnt(0)
    s_waitcnt vmcnt(0)
    v_pk_add_f32 v[32:33], v[32:33], v[34:35]
    v_pk_add_f32 v[32:33], v[32:33], v[36:37]
    v_pk_add_f32 v[32:33], v[32:33], v[38:39]
    v_pk_add_f32 v[32:33], v[32:33], v[40:41]
    v_pk_add_f32 v[32:33], v[32:33], v[42:43]
    v_pk_add_f32 v[32:33], v[32:33], v[44:45]
    v_pk_add_f32 v[32:33], v[32:33], v[46:47]
    v_pk_add_f32 v[32:33], v[32:33], v[48:49]
    v_pk_add_f32 v[32:33], v[32:33], v[50:51]
    v_pk_add_f32 v[32:33], v[32:33], v[52:53]
    v_pk_add_f32 v[32:33], v[32:33], v[54:55]
    v_pk_add_f32 v[32:33], v[32:33], v[56:57]
    v_pk_add_f32 v[32:33], v[32:33], v[58:59]
    v_pk_add_f32 v[32:33], v[32:33], v[60:61]
    v_pk_add_f32 v[32:33], v[32:33], v[62:63]
    v_mul_f32 v32, 0x3acccccd, v32
    v_mul_f32 v33, 0x3acccccd, v33
    v_fma_f32 v33, -v32, v32, v33
    v_max_f32 v33, 0, v33
    v_add_f32 v33, 0x3727c5ac, v33
    v_rsq_f32 v33, v33
    s_nop 0
    v_mul_f32 v32, v32, v33
    s_lshl_b32 s34, s22, 8
    v_lshlrev_b32 v16, 2, v1
    v_add_u32 v16, s34, v16
    s_barrier
    ds_write_b32 v16, v33 offset:0
    ds_write_b32 v16, v32 offset:512
    s_waitcnt lgkmcnt(0)
    s_barrier
    s_branch m2_kernel_p4done
m2_kernel_p4r2:
    s_cmp_lg_u32 s22, 2
    s_cbranch_scc1 m2_kernel_p4r3
    s_mov_b32 s34, 0
    buffer_load_dwordx4 v[32:35], v17, s[52:55], s34 offen
    s_mov_b32 s34, 12288
    buffer_load_dwordx4 v[36:39], v17, s[52:55], s34 offen
    s_mov_b32 s34, 24576
    buffer_load_dwordx4 v[40:43], v17, s[52:55], s34 offen
    s_mov_b32 s34, 36864
    buffer_load_dwordx4 v[44:47], v17, s[52:55], s34 offen
    s_mov_b32 s34, 49152
    buffer_load_dwordx4 v[48:51], v17, s[52:55], s34 offen
    s_mov_b32 m0, 73728
    s_add_u32 s35, s61, 8192
    buffer_load_dwordx4 v2, s[44:47], s35 offen offset:0 lds
    buffer_load_dwordx4 v2, s[44:47], s35 offen offset:1024 lds
    buffer_load_dwordx4 v2, s[44:47], s35 offen offset:2048 lds
    buffer_load_dwordx4 v2, s[44:47], s35 offen offset:3072 lds
    s_mov_b32 m0, 77824
    s_add_u32 s35, s61, 12288
    buffer_load_dwordx4 v2, s[44:47], s35 offen offset:0 lds
    buffer_load_dwordx4 v2, s[44:47], s35 offen offset:1024 lds
    buffer_load_dwordx4 v2, s[44:47], s35 offen offset:2048 lds
    buffer_load_dwordx4 v2, s[44:47], s35 offen offset:3072 lds
    s_mov_b32 m0, 98304
    s_add_u32 s35, s61, 32768
    buffer_load_dwordx4 v2, s[44:47], s35 offen offset:0 lds
    buffer_load_dwordx4 v2, s[44:47], s35 offen offset:1024 lds
    buffer_load_dwordx4 v2, s[44:47], s35 offen offset:2048 lds
    buffer_load_dwordx4 v2, s[44:47], s35 offen offset:3072 lds
    s_mov_b32 m0, 102400
    s_add_u32 s35, s61, 36864
    buffer_load_dwordx4 v2, s[44:47], s35 offen offset:0 lds
    buffer_load_dwordx4 v2, s[44:47], s35 offen offset:1024 lds
    buffer_load_dwordx4 v2, s[44:47], s35 offen offset:2048 lds
    buffer_load_dwordx4 v2, s[44:47], s35 offen offset:3072 lds
    s_mov_b32 m0, 122880
    s_add_u32 s35, s61, 57344
    buffer_load_dwordx4 v2, s[44:47], s35 offen offset:0 lds
    buffer_load_dwordx4 v2, s[44:47], s35 offen offset:1024 lds
    buffer_load_dwordx4 v2, s[44:47], s35 offen offset:2048 lds
    buffer_load_dwordx4 v2, s[44:47], s35 offen offset:3072 lds
    s_mov_b32 m0, 126976
    s_add_u32 s35, s61, 61440
    buffer_load_dwordx4 v2, s[44:47], s35 offen offset:0 lds
    buffer_load_dwordx4 v2, s[44:47], s35 offen offset:1024 lds
    buffer_load_dwordx4 v2, s[44:47], s35 offen offset:2048 lds
    buffer_load_dwordx4 v2, s[44:47], s35 offen offset:3072 lds
    s_mov_b32 m0, 147456
    s_add_u32 s35, s61, 81920
    buffer_load_dwordx4 v2, s[44:47], s35 offen offset:0 lds
    buffer_load_dwordx4 v2, s[44:47], s35 offen offset:1024 lds
    buffer_load_dwordx4 v2, s[44:47], s35 offen offset:2048 lds
    buffer_load_dwordx4 v2, s[44:47], s35 offen offset:3072 lds
    s_mov_b32 m0, 151552
    s_add_u32 s35, s61, 86016
    buffer_load_dwordx4 v2, s[44:47], s35 offen offset:0 lds
    buffer_load_dwordx4 v2, s[44:47], s35 offen offset:1024 lds
    buffer_load_dwordx4 v2, s[44:47], s35 offen offset:2048 lds
    buffer_load_dwordx4 v2, s[44:47], s35 offen offset:3072 lds
    s_barrier
    s_add_u32 m0, s58, 0
    s_movk_i32 s34, 0
    buffer_load_dwordx4 v14, s[40:43], s34 offen offset:0 lds
    buffer_load_dwordx4 v14, s[40:43], s34 offen offset:1024 lds
    buffer_load_dwordx4 v15, s[40:43], s34 offen offset:2048 lds
    buffer_load_dwordx4 v15, s[40:43], s34 offen offset:3072 lds
    s_add_u32 m0, s58, 16384
    s_movk_i32 s34, 2048
    buffer_load_dwordx4 v14, s[40:43], s34 offen offset:0 lds
    buffer_load_dwordx4 v14, s[40:43], s34 offen offset:1024 lds
    buffer_load_dwordx4 v15, s[40:43], s34 offen offset:2048 lds
    buffer_load_dwordx4 v15, s[40:43], s34 offen offset:3072 lds
    s_add_u32 m0, s58, 32768
    s_movk_i32 s34, 4096
    buffer_load_dwordx4 v14, s[40:43], s34 offen offset:0 lds
    buffer_load_dwordx4 v14, s[40:43], s34 offen offset:1024 lds
    buffer_load_dwordx4 v15, s[40:43], s34 offen offset:2048 lds
    buffer_load_dwordx4 v15, s[40:43], s34 offen offset:3072 lds
    s_add_u32 m0, s58, 49152
    s_movk_i32 s34, 6144
    buffer_load_dwordx4 v14, s[40:43], s34 offen offset:0 lds
    buffer_load_dwordx4 v14, s[40:43], s34 offen offset:1024 lds
    buffer_load_dwordx4 v15, s[40:43], s34 offen offset:2048 lds
    buffer_load_dwordx4 v15, s[40:43], s34 offen offset:3072 lds
    s_waitcnt vmcnt(12)
    s_barrier
    s_waitcnt vmcnt(8)
    s_barrier
    s_mov_b32 m0, 77824
    s_add_u32 s35, s61, 110592
    buffer_load_dwordx4 v2, s[44:47], s35 offen offset:0 lds
    buffer_load_dwordx4 v2, s[44:47], s35 offen offset:1024 lds
    buffer_load_dwordx4 v2, s[44:47], s35 offen offset:2048 lds
    buffer_load_dwordx4 v2, s[44:47], s35 offen offset:3072 lds
    s_mov_b32 m0, 81920
    s_add_u32 s35, s61, 114688
    buffer_load_dwordx4 v2, s[44:47], s35 offen offset:0 lds
    buffer_load_dwordx4 v2, s[44:47], s35 offen offset:1024 lds
    s_add_u32 m0, s58, 0
    s_movk_i32 s34, 8192
    buffer_load_dwordx4 v14, s[40:43], s34 offen offset:0 lds
    buffer_load_dwordx4 v14, s[40:43], s34 offen offset:1024 lds
    buffer_load_dwordx4 v15, s[40:43], s34 offen offset:2048 lds
    buffer_load_dwordx4 v15, s[40:43], s34 offen offset:3072 lds
    s_waitcnt vmcnt(14)
    s_barrier
    s_mov_b32 m0, 102400
    s_add_u32 s35, s61, 135168
    buffer_load_dwordx4 v2, s[44:47], s35 offen offset:0 lds
    buffer_load_dwordx4 v2, s[44:47], s35 offen offset:1024 lds
    buffer_load_dwordx4 v2, s[44:47], s35 offen offset:2048 lds
    buffer_load_dwordx4 v2, s[44:47], s35 offen offset:3072 lds
    s_mov_b32 m0, 106496
    s_add_u32 s35, s61, 139264
    buffer_load_dwordx4 v2, s[44:47], s35 offen offset:0 lds
    buffer_load_dwordx4 v2, s[44:47], s35 offen offset:1024 lds
    s_add_u32 m0, s58, 16384
    s_movk_i32 s34, 10240
    buffer_load_dwordx4 v14, s[40:43], s34 offen offset:0 lds
    buffer_load_dwordx4 v14, s[40:43], s34 offen offset:1024 lds
    buffer_load_dwordx4 v15, s[40:43], s34 offen offset:2048 lds
    buffer_load_dwordx4 v15, s[40:43], s34 offen offset:3072 lds
    s_waitcnt vmcnt(20)
    s_barrier
    s_mov_b32 m0, 126976
    s_add_u32 s35, s61, 159744
    buffer_load_dwordx4 v2, s[44:47], s35 offen offset:0 lds
    buffer_load_dwordx4 v2, s[44:47], s35 offen offset:1024 lds
    buffer_load_dwordx4 v2, s[44:47], s35 offen offset:2048 lds
    buffer_load_dwordx4 v2, s[44:47], s35 offen offset:3072 lds
    s_mov_b32 m0, 131072
    s_add_u32 s35, s61, 163840
    buffer_load_dwordx4 v2, s[44:47], s35 offen offset:0 lds
    buffer_load_dwordx4 v2, s[44:47], s35 offen offset:1024 lds
    s_add_u32 m0, s58, 32768
    s_movk_i32 s34, 12288
    buffer_load_dwordx4 v14, s[40:43], s34 offen offset:0 lds
    buffer_load_dwordx4 v14, s[40:43], s34 offen offset:1024 lds
    buffer_load_dwordx4 v15, s[40:43], s34 offen offset:2048 lds
    buffer_load_dwordx4 v15, s[40:43], s34 offen offset:3072 lds
    s_waitcnt vmcnt(20)
    s_barrier
    s_mov_b32 m0, 151552
    s_add_u32 s35, s61, 184320
    buffer_load_dwordx4 v2, s[44:47], s35 offen offset:0 lds
    buffer_load_dwordx4 v2, s[44:47], s35 offen offset:1024 lds
    buffer_load_dwordx4 v2, s[44:47], s35 offen offset:2048 lds
    buffer_load_dwordx4 v2, s[44:47], s35 offen offset:3072 lds
    s_mov_b32 m0, 155648
    s_add_u32 s35, s61, 188416
    buffer_load_dwordx4 v2, s[44:47], s35 offen offset:0 lds
    buffer_load_dwordx4 v2, s[44:47], s35 offen offset:1024 lds
    s_add_u32 m0, s58, 49152
    s_movk_i32 s34, 14336
    buffer_load_dwordx4 v14, s[40:43], s34 offen offset:0 lds
    buffer_load_dwordx4 v14, s[40:43], s34 offen offset:1024 lds
    buffer_load_dwordx4 v15, s[40:43], s34 offen offset:2048 lds
    buffer_load_dwordx4 v15, s[40:43], s34 offen offset:3072 lds
    s_waitcnt vmcnt(20)
    s_barrier
    s_mov_b32 m0, 77824
    s_add_u32 s35, s61, 208896
    buffer_load_dwordx4 v2, s[44:47], s35 offen offset:0 lds
    buffer_load_dwordx4 v2, s[44:47], s35 offen offset:1024 lds
    buffer_load_dwordx4 v2, s[44:47], s35 offen offset:2048 lds
    buffer_load_dwordx4 v2, s[44:47], s35 offen offset:3072 lds
    s_mov_b32 m0, 81920
    s_add_u32 s35, s61, 212992
    buffer_load_dwordx4 v2, s[44:47], s35 offen offset:0 lds
    buffer_load_dwordx4 v2, s[44:47], s35 offen offset:1024 lds
    s_add_u32 m0, s58, 0
    s_movk_i32 s34, 16384
    buffer_load_dwordx4 v14, s[40:43], s34 offen offset:0 lds
    buffer_load_dwordx4 v14, s[40:43], s34 offen offset:1024 lds
    buffer_load_dwordx4 v15, s[40:43], s34 offen offset:2048 lds
    buffer_load_dwordx4 v15, s[40:43], s34 offen offset:3072 lds
    s_waitcnt vmcnt(20)
    s_barrier
    s_mov_b32 m0, 102400
    s_add_u32 s35, s61, 233472
    buffer_load_dwordx4 v2, s[44:47], s35 offen offset:0 lds
    buffer_load_dwordx4 v2, s[44:47], s35 offen offset:1024 lds
    buffer_load_dwordx4 v2, s[44:47], s35 offen offset:2048 lds
    buffer_load_dwordx4 v2, s[44:47], s35 offen offset:3072 lds
    s_mov_b32 m0, 106496
    s_add_u32 s35, s61, 237568
    buffer_load_dwordx4 v2, s[44:47], s35 offen offset:0 lds
    buffer_load_dwordx4 v2, s[44:47], s35 offen offset:1024 lds
    s_add_u32 m0, s58, 16384
    s_movk_i32 s34, 18432
    buffer_load_dwordx4 v14, s[40:43], s34 offen offset:0 lds
    buffer_load_dwordx4 v14, s[40:43], s34 offen offset:1024 lds
    buffer_load_dwordx4 v15, s[40:43], s34 offen offset:2048 lds
    buffer_load_dwordx4 v15, s[40:43], s34 offen offset:3072 lds
    s_waitcnt vmcnt(20)
    s_barrier
    s_waitcnt vmcnt(10)
    s_barrier
    s_waitcnt vmcnt(0)
    s_waitcnt vmcnt(0)
    v_pk_add_f32 v[32:33], v[32:33], v[36:37]
    v_pk_add_f32 v[34:35], v[34:35], v[38:39]
    v_pk_add_f32 v[32:33], v[32:33], v[40:41]
    v_pk_add_f32 v[34:35], v[34:35], v[42:43]
    v_pk_add_f32 v[32:33], v[32:33], v[44:45]
    v_pk_add_f32 v[34:35], v[34:35], v[46:47]
    v_pk_add_f32 v[32:33], v[32:33], v[48:49]
    v_pk_add_f32 v[34:35], v[34:35], v[50:51]
    v_lshlrev_b32 v16, 4, v1
    v_cmp_gt_u32 vcc, 48, v1
    s_barrier
    s_nop 2
    s_and_saveexec_b64 s[34:35], vcc
    ds_write_b128 v16, v[32:35] offset:1024
    s_waitcnt lgkmcnt(0)
    s_mov_b64 exec, s[34:35]
    s_barrier
    s_branch m2_kernel_p4done
m2_kernel_p4r3:
    s_mov_b32 m0, 81920
    s_add_u32 s35, s61, 16384
    buffer_load_dwordx4 v2, s[44:47], s35 offen offset:0 lds
    buffer_load_dwordx4 v2, s[44:47], s35 offen offset:1024 lds
    buffer_load_dwordx4 v2, s[44:47], s35 offen offset:2048 lds
    buffer_load_dwordx4 v2, s[44:47], s35 offen offset:3072 lds
    s_mov_b32 m0, 86016
    s_add_u32 s35, s61, 20480
    buffer_load_dwordx4 v2, s[44:47], s35 offen offset:0 lds
    buffer_load_dwordx4 v2, s[44:47], s35 offen offset:1024 lds
    buffer_load_dwordx4 v2, s[44:47], s35 offen offset:2048 lds
    buffer_load_dwordx4 v2, s[44:47], s35 offen offset:3072 lds
    s_mov_b32 m0, 106496
    s_add_u32 s35, s61, 40960
    buffer_load_dwordx4 v2, s[44:47], s35 offen offset:0 lds
    buffer_load_dwordx4 v2, s[44:47], s35 offen offset:1024 lds
    buffer_load_dwordx4 v2, s[44:47], s35 offen offset:2048 lds
    buffer_load_dwordx4 v2, s[44:47], s35 offen offset:3072 lds
    s_mov_b32 m0, 110592
    s_add_u32 s35, s61, 45056
    buffer_load_dwordx4 v2, s[44:47], s35 offen offset:0 lds
    buffer_load_dwordx4 v2, s[44:47], s35 offen offset:1024 lds
    buffer_load_dwordx4 v2, s[44:47], s35 offen offset:2048 lds
    buffer_load_dwordx4 v2, s[44:47], s35 offen offset:3072 lds
    s_mov_b32 m0, 131072
    s_add_u32 s35, s61, 65536
    buffer_load_dwordx4 v2, s[44:47], s35 offen offset:0 lds
    buffer_load_dwordx4 v2, s[44:47], s35 offen offset:1024 lds
    buffer_load_dwordx4 v2, s[44:47], s35 offen offset:2048 lds
    buffer_load_dwordx4 v2, s[44:47], s35 offen offset:3072 lds
    s_mov_b32 m0, 135168
    s_add_u32 s35, s61, 69632
    buffer_load_dwordx4 v2, s[44:47], s35 offen offset:0 lds
    buffer_load_dwordx4 v2, s[44:47], s35 offen offset:1024 lds
    buffer_load_dwordx4 v2, s[44:47], s35 offen offset:2048 lds
    buffer_load_dwordx4 v2, s[44:47], s35 offen offset:3072 lds
    s_mov_b32 m0, 155648
    s_add_u32 s35, s61, 90112
    buffer_load_dwordx4 v2, s[44:47], s35 offen offset:0 lds
    buffer_load_dwordx4 v2, s[44:47], s35 offen offset:1024 lds
    buffer_load_dwordx4 v2, s[44:47], s35 offen offset:2048 lds
    buffer_load_dwordx4 v2, s[44:47], s35 offen offset:3072 lds
    s_mov_b32 m0, 159744
    s_add_u32 s35, s61, 94208
    buffer_load_dwordx4 v2, s[44:47], s35 offen offset:0 lds
    buffer_load_dwordx4 v2, s[44:47], s35 offen offset:1024 lds
    buffer_load_dwordx4 v2, s[44:47], s35 offen offset:2048 lds
    buffer_load_dwordx4 v2, s[44:47], s35 offen offset:3072 lds
    s_barrier
    s_add_u32 m0, s58, 0
    s_movk_i32 s34, 0
    buffer_load_dwordx4 v14, s[40:43], s34 offen offset:0 lds
    buffer_load_dwordx4 v14, s[40:43], s34 offen offset:1024 lds
    buffer_load_dwordx4 v15, s[40:43], s34 offen offset:2048 lds
    buffer_load_dwordx4 v15, s[40:43], s34 offen offset:3072 lds
    s_add_u32 m0, s58, 16384
    s_movk_i32 s34, 2048
    buffer_load_dwordx4 v14, s[40:43], s34 offen offset:0 lds
    buffer_load_dwordx4 v14, s[40:43], s34 offen offset:1024 lds
    buffer_load_dwordx4 v15, s[40:43], s34 offen offset:2048 lds
    buffer_load_dwordx4 v15, s[40:43], s34 offen offset:3072 lds
    s_add_u32 m0, s58, 32768
    s_movk_i32 s34, 4096
    buffer_load_dwordx4 v14, s[40:43], s34 offen offset:0 lds
    buffer_load_dwordx4 v14, s[40:43], s34 offen offset:1024 lds
    buffer_load_dwordx4 v15, s[40:43], s34 offen offset:2048 lds
    buffer_load_dwordx4 v15, s[40:43], s34 offen offset:3072 lds
    s_add_u32 m0, s58, 49152
    s_movk_i32 s34, 6144
    buffer_load_dwordx4 v14, s[40:43], s34 offen offset:0 lds
    buffer_load_dwordx4 v14, s[40:43], s34 offen offset:1024 lds
    buffer_load_dwordx4 v15, s[40:43], s34 offen offset:2048 lds
    buffer_load_dwordx4 v15, s[40:43], s34 offen offset:3072 lds
    s_waitcnt vmcnt(12)
    s_barrier
    s_waitcnt vmcnt(8)
    s_barrier
    s_mov_b32 m0, 83968
    s_add_u32 s35, s61, 116736
    buffer_load_dwordx4 v2, s[44:47], s35 offen offset:0 lds
    buffer_load_dwordx4 v2, s[44:47], s35 offen offset:1024 lds
    buffer_load_dwordx4 v2, s[44:47], s35 offen offset:2048 lds
    buffer_load_dwordx4 v2, s[44:47], s35 offen offset:3072 lds
    s_mov_b32 m0, 88064
    s_add_u32 s35, s61, 120832
    buffer_load_dwordx4 v2, s[44:47], s35 offen offset:0 lds
    buffer_load_dwordx4 v2, s[44:47], s35 offen offset:1024 lds
    s_add_u32 m0, s58, 0
    s_movk_i32 s34, 8192
    buffer_load_dwordx4 v14, s[40:43], s34 offen offset:0 lds
    buffer_load_dwordx4 v14, s[40:43], s34 offen offset:1024 lds
    buffer_load_dwordx4 v15, s[40:43], s34 offen offset:2048 lds
    buffer_load_dwordx4 v15, s[40:43], s34 offen offset:3072 lds
    s_waitcnt vmcnt(14)
    s_barrier
    s_mov_b32 m0, 108544
    s_add_u32 s35, s61, 141312
    buffer_load_dwordx4 v2, s[44:47], s35 offen offset:0 lds
    buffer_load_dwordx4 v2, s[44:47], s35 offen offset:1024 lds
    buffer_load_dwordx4 v2, s[44:47], s35 offen offset:2048 lds
    buffer_load_dwordx4 v2, s[44:47], s35 offen offset:3072 lds
    s_mov_b32 m0, 112640
    s_add_u32 s35, s61, 145408
    buffer_load_dwordx4 v2, s[44:47], s35 offen offset:0 lds
    buffer_load_dwordx4 v2, s[44:47], s35 offen offset:1024 lds
    s_add_u32 m0, s58, 16384
    s_movk_i32 s34, 10240
    buffer_load_dwordx4 v14, s[40:43], s34 offen offset:0 lds
    buffer_load_dwordx4 v14, s[40:43], s34 offen offset:1024 lds
    buffer_load_dwordx4 v15, s[40:43], s34 offen offset:2048 lds
    buffer_load_dwordx4 v15, s[40:43], s34 offen offset:3072 lds
    s_waitcnt vmcnt(20)
    s_barrier
    s_mov_b32 m0, 133120
    s_add_u32 s35, s61, 165888
    buffer_load_dwordx4 v2, s[44:47], s35 offen offset:0 lds
    buffer_load_dwordx4 v2, s[44:47], s35 offen offset:1024 lds
    buffer_load_dwordx4 v2, s[44:47], s35 offen offset:2048 lds
    buffer_load_dwordx4 v2, s[44:47], s35 offen offset:3072 lds
    s_mov_b32 m0, 137216
    s_add_u32 s35, s61, 169984
    buffer_load_dwordx4 v2, s[44:47], s35 offen offset:0 lds
    buffer_load_dwordx4 v2, s[44:47], s35 offen offset:1024 lds
    s_add_u32 m0, s58, 32768
    s_movk_i32 s34, 12288
    buffer_load_dwordx4 v14, s[40:43], s34 offen offset:0 lds
    buffer_load_dwordx4 v14, s[40:43], s34 offen offset:1024 lds
    buffer_load_dwordx4 v15, s[40:43], s34 offen offset:2048 lds
    buffer_load_dwordx4 v15, s[40:43], s34 offen offset:3072 lds
    s_waitcnt vmcnt(20)
    s_barrier
    s_mov_b32 m0, 157696
    s_add_u32 s35, s61, 190464
    buffer_load_dwordx4 v2, s[44:47], s35 offen offset:0 lds
    buffer_load_dwordx4 v2, s[44:47], s35 offen offset:1024 lds
    buffer_load_dwordx4 v2, s[44:47], s35 offen offset:2048 lds
    buffer_load_dwordx4 v2, s[44:47], s35 offen offset:3072 lds
    s_mov_b32 m0, 161792
    s_add_u32 s35, s61, 194560
    buffer_load_dwordx4 v2, s[44:47], s35 offen offset:0 lds
    buffer_load_dwordx4 v2, s[44:47], s35 offen offset:1024 lds
    s_add_u32 m0, s58, 49152
    s_movk_i32 s34, 14336
    buffer_load_dwordx4 v14, s[40:43], s34 offen offset:0 lds
    buffer_load_dwordx4 v14, s[40:43], s34 offen offset:1024 lds
    buffer_load_dwordx4 v15, s[40:43], s34 offen offset:2048 lds
    buffer_load_dwordx4 v15, s[40:43], s34 offen offset:3072 lds
    s_waitcnt vmcnt(20)
    s_barrier
    s_mov_b32 m0, 83968
    s_add_u32 s35, s61, 215040
    buffer_load_dwordx4 v2, s[44:47], s35 offen offset:0 lds
    buffer_load_dwordx4 v2, s[44:47], s35 offen offset:1024 lds
    buffer_load_dwordx4 v2, s[44:47], s35 offen offset:2048 lds
    buffer_load_dwordx4 v2, s[44:47], s35 offen offset:3072 lds
    s_mov_b32 m0, 88064
    s_add_u32 s35, s61, 219136
    buffer_load_dwordx4 v2, s[44:47], s35 offen offset:0 lds
    buffer_load_dwordx4 v2, s[44:47], s35 offen offset:1024 lds
    s_add_u32 m0, s58, 0
    s_movk_i32 s34, 16384
    buffer_load_dwordx4 v14, s[40:43], s34 offen offset:0 lds
    buffer_load_dwordx4 v14, s[40:43], s34 offen offset:1024 lds
    buffer_load_dwordx4 v15, s[40:43], s34 offen offset:2048 lds
    buffer_load_dwordx4 v15, s[40:43], s34 offen offset:3072 lds
    s_waitcnt vmcnt(20)
    s_barrier
    s_mov_b32 m0, 108544
    s_add_u32 s35, s61, 239616
    buffer_load_dwordx4 v2, s[44:47], s35 offen offset:0 lds
    buffer_load_dwordx4 v2, s[44:47], s35 offen offset:1024 lds
    buffer_load_dwordx4 v2, s[44:47], s35 offen offset:2048 lds
    buffer_load_dwordx4 v2, s[44:47], s35 offen offset:3072 lds
    s_mov_b32 m0, 112640
    s_add_u32 s35, s61, 243712
    buffer_load_dwordx4 v2, s[44:47], s35 offen offset:0 lds
    buffer_load_dwordx4 v2, s[44:47], s35 offen offset:1024 lds
    s_add_u32 m0, s58, 16384
    s_movk_i32 s34, 18432
    buffer_load_dwordx4 v14, s[40:43], s34 offen offset:0 lds
    buffer_load_dwordx4 v14, s[40:43], s34 offen offset:1024 lds
    buffer_load_dwordx4 v15, s[40:43], s34 offen offset:2048 lds
    buffer_load_dwordx4 v15, s[40:43], s34 offen offset:3072 lds
    s_waitcnt vmcnt(20)
    s_barrier
    s_waitcnt vmcnt(10)
    s_barrier
    s_waitcnt vmcnt(0)
    s_waitcnt vmcnt(0)
    s_barrier
    s_barrier
m2_kernel_p4done:
    s_barrier
    s_cmp_lg_u32 s22, 0
    s_cbranch_scc1 m2_kernel_wd_nf
    s_add_u32 s34, s23, 2027808452
    v_mov_b32 v20, s34
    s_lshl_b32 s35, s2, 7
    s_add_u32 s35, s35, 98304
    v_mov_b32 v21, s35
    v_cmp_eq_u32 vcc, 0, v1
    s_nop 3
    s_and_saveexec_b64 s[36:37], vcc
    buffer_store_dword v20, v21, s[28:31], 0 offen sc1
    s_mov_b64 exec, s[36:37]
m2_kernel_wd_nf:
    s_add_u32 s40, s20, 13107200
    s_addc_u32 s41, s21, 0
    s_mov_b32 s42, 6291456
    s_mov_b32 s43, 0x00020000
    s_add_u32 s44, s20, 24567808
    s_addc_u32 s45, s21, 0
    s_mov_b32 s46, 1966080
    s_mov_b32 s47, 0x00020000
    s_lshr_b32 s50, s22, 1
    s_and_b32 s51, s22, 1
    s_lshl_b32 s34, s26, 2
    s_and_b32 s35, s24, 3
    s_add_u32 s34, s34, s35
    s_lshl_b32 s34, s34, 2
    s_lshl_b32 s35, s51, 1
    s_add_u32 s34, s34, s35
    s_mul_i32 s34, s34, 49152
    s_mul_i32 s35, s50, 24576
    s_add_u32 s34, s34, s35
    v_lshlrev_b32 v2, 4, v1
    v_add_u32 v13, s34, v2
    v_add_u32 v14, 47104, v13
    s_lshl_b32 s52, s50, 13
    s_lshl_b32 s53, s51, 12
    s_add_u32 s52, s52, s53
    s_mul_i32 s53, s50, 10240
    s_mul_i32 s33, s51, 5120
    s_add_u32 s53, s53, s33
    s_mul_i32 s54, s27, 245760
    s_add_u32 s54, s54, s53
    s_add_u32 s53, s53, 65536
    s_mul_i32 s55, s27, 245760
    s_cmp_lg_u32 s22, 0
    s_cbranch_scc1 m2_kernel_wd_r1
    v_bfe_u32 v8, v1, 2, 2
    v_lshlrev_b32 v8, 3, v8
    v_and_b32 v9, 3, v1
    v_lshl_add_u32 v8, v9, 1, v8
    s_lshl_b32 s35, s26, 5
    s_bfe_u32 s34, s24, 0x10001
    s_add_u32 s35, s35, s34
    v_add_u32 v8, s35, v8
    v_lshlrev_b32 v8, 7, v8
    v_add_u32 v8, 98304, v8
    s_add_u32 s34, s23, 2027808452
    s_mov_b32 s38, 0
m2_kernel_poll4:
    buffer_load_dword v24, v8, s[28:31], 0 offen sc1
    s_waitcnt vmcnt(0)
    v_cmp_ne_u32 vcc, s34, v24
    s_cbranch_vccz m2_kernel_pollok4
    s_add_u32 s38, s38, 1
    s_cmp_ge_u32 s38, 100000
    s_cbranch_scc1 m2_kernel_pollok4
    s_sleep 1
    s_branch m2_kernel_poll4
m2_kernel_pollok4:
    s_barrier
    s_add_u32 m0, s52, 0
    s_movk_i32 s34, 0
    buffer_load_dwordx4 v13, s[40:43], s34 offen offset:0 lds
    buffer_load_dwordx4 v13, s[40:43], s34 offen offset:1024 lds
    buffer_load_dwordx4 v14, s[40:43], s34 offen offset:2048 lds
    buffer_load_dwordx4 v14, s[40:43], s34 offen offset:3072 lds
    s_add_u32 m0, s52, 16384
    s_movk_i32 s34, 2048
    buffer_load_dwordx4 v13, s[40:43], s34 offen offset:0 lds
    buffer_load_dwordx4 v13, s[40:43], s34 offen offset:1024 lds
    buffer_load_dwordx4 v14, s[40:43], s34 offen offset:2048 lds
    buffer_load_dwordx4 v14, s[40:43], s34 offen offset:3072 lds
    s_add_u32 m0, s52, 32768
    s_movk_i32 s34, 4096
    buffer_load_dwordx4 v13, s[40:43], s34 offen offset:0 lds
    buffer_load_dwordx4 v13, s[40:43], s34 offen offset:1024 lds
    buffer_load_dwordx4 v14, s[40:43], s34 offen offset:2048 lds
    buffer_load_dwordx4 v14, s[40:43], s34 offen offset:3072 lds
    s_add_u32 m0, s52, 49152
    s_movk_i32 s34, 6144
    buffer_load_dwordx4 v13, s[40:43], s34 offen offset:0 lds
    buffer_load_dwordx4 v13, s[40:43], s34 offen offset:1024 lds
    buffer_load_dwordx4 v14, s[40:43], s34 offen offset:2048 lds
    buffer_load_dwordx4 v14, s[40:43], s34 offen offset:3072 lds
    s_waitcnt vmcnt(12)
    s_barrier
    s_waitcnt vmcnt(8)
    s_barrier
    s_mov_b32 m0, 65536
    s_add_u32 s35, s55, 81920
    buffer_load_dwordx4 v2, s[44:47], s35 offen offset:0 lds
    buffer_load_dwordx4 v2, s[44:47], s35 offen offset:1024 lds
    buffer_load_dwordx4 v2, s[44:47], s35 offen offset:2048 lds
    buffer_load_dwordx4 v2, s[44:47], s35 offen offset:3072 lds
    s_mov_b32 m0, 69632
    s_add_u32 s35, s55, 86016
    buffer_load_dwordx4 v2, s[44:47], s35 offen offset:0 lds
    s_add_u32 m0, s52, 0
    s_movk_i32 s34, 8192
    buffer_load_dwordx4 v13, s[40:43], s34 offen offset:0 lds
    buffer_load_dwordx4 v13, s[40:43], s34 offen offset:1024 lds
    buffer_load_dwordx4 v14, s[40:43], s34 offen offset:2048 lds
    buffer_load_dwordx4 v14, s[40:43], s34 offen offset:3072 lds
    s_waitcnt vmcnt(13)
    s_barrier
    s_mov_b32 m0, 86016
    s_add_u32 s35, s55, 102400
    buffer_load_dwordx4 v2, s[44:47], s35 offen offset:0 lds
    buffer_load_dwordx4 v2, s[44:47], s35 offen offset:1024 lds
    buffer_load_dwordx4 v2, s[44:47], s35 offen offset:2048 lds
    buffer_load_dwordx4 v2, s[44:47], s35 offen offset:3072 lds
    s_mov_b32 m0, 90112
    s_add_u32 s35, s55, 106496
    buffer_load_dwordx4 v2, s[44:47], s35 offen offset:0 lds
    s_add_u32 m0, s52, 16384
    s_movk_i32 s34, 10240
    buffer_load_dwordx4 v13, s[40:43], s34 offen offset:0 lds
    buffer_load_dwordx4 v13, s[40:43], s34 offen offset:1024 lds
    buffer_load_dwordx4 v14, s[40:43], s34 offen offset:2048 lds
    buffer_load_dwordx4 v14, s[40:43], s34 offen offset:3072 lds
    s_waitcnt vmcnt(18)
    s_barrier
    s_mov_b32 m0, 106496
    s_add_u32 s35, s55, 122880
    buffer_load_dwordx4 v2, s[44:47], s35 offen offset:0 lds
    buffer_load_dwordx4 v2, s[44:47], s35 offen offset:1024 lds
    buffer_load_dwordx4 v2, s[44:47], s35 offen offset:2048 lds
    buffer_load_dwordx4 v2, s[44:47], s35 offen offset:3072 lds
    s_mov_b32 m0, 110592
    s_add_u32 s35, s55, 126976
    buffer_load_dwordx4 v2, s[44:47], s35 offen offset:0 lds
    s_add_u32 m0, s52, 32768
    s_movk_i32 s34, 12288
    buffer_load_dwordx4 v13, s[40:43], s34 offen offset:0 lds
    buffer_load_dwordx4 v13, s[40:43], s34 offen offset:1024 lds
    buffer_load_dwordx4 v14, s[40:43], s34 offen offset:2048 lds
    buffer_load_dwordx4 v14, s[40:43], s34 offen offset:3072 lds
    s_waitcnt vmcnt(18)
    s_barrier
    s_mov_b32 m0, 126976
    s_add_u32 s35, s55, 143360
    buffer_load_dwordx4 v2, s[44:47], s35 offen offset:0 lds
    buffer_load_dwordx4 v2, s[44:47], s35 offen offset:1024 lds
    buffer_load_dwordx4 v2, s[44:47], s35 offen offset:2048 lds
    buffer_load_dwordx4 v2, s[44:47], s35 offen offset:3072 lds
    s_mov_b32 m0, 131072
    s_add_u32 s35, s55, 147456
    buffer_load_dwordx4 v2, s[44:47], s35 offen offset:0 lds
    s_add_u32 m0, s52, 49152
    s_movk_i32 s34, 14336
    buffer_load_dwordx4 v13, s[40:43], s34 offen offset:0 lds
    buffer_load_dwordx4 v13, s[40:43], s34 offen offset:1024 lds
    buffer_load_dwordx4 v14, s[40:43], s34 offen offset:2048 lds
    buffer_load_dwordx4 v14, s[40:43], s34 offen offset:3072 lds
    s_waitcnt vmcnt(18)
    s_barrier
    s_mov_b32 m0, 65536
    s_add_u32 s35, s55, 163840
    buffer_load_dwordx4 v2, s[44:47], s35 offen offset:0 lds
    buffer_load_dwordx4 v2, s[44:47], s35 offen offset:1024 lds
    buffer_load_dwordx4 v2, s[44:47], s35 offen offset:2048 lds
    buffer_load_dwordx4 v2, s[44:47], s35 offen offset:3072 lds
    s_mov_b32 m0, 69632
    s_add_u32 s35, s55, 167936
    buffer_load_dwordx4 v2, s[44:47], s35 offen offset:0 lds
    s_add_u32 m0, s52, 0
    s_movk_i32 s34, 16384
    buffer_load_dwordx4 v13, s[40:43], s34 offen offset:0 lds
    buffer_load_dwordx4 v13, s[40:43], s34 offen offset:1024 lds
    buffer_load_dwordx4 v14, s[40:43], s34 offen offset:2048 lds
    buffer_load_dwordx4 v14, s[40:43], s34 offen offset:3072 lds
    s_waitcnt vmcnt(18)
    s_barrier
    s_mov_b32 m0, 86016
    s_add_u32 s35, s55, 184320
    buffer_load_dwordx4 v2, s[44:47], s35 offen offset:0 lds
    buffer_load_dwordx4 v2, s[44:47], s35 offen offset:1024 lds
    buffer_load_dwordx4 v2, s[44:47], s35 offen offset:2048 lds
    buffer_load_dwordx4 v2, s[44:47], s35 offen offset:3072 lds
    s_mov_b32 m0, 90112
    s_add_u32 s35, s55, 188416
    buffer_load_dwordx4 v2, s[44:47], s35 offen offset:0 lds
    s_add_u32 m0, s52, 16384
    s_movk_i32 s34, 18432
    buffer_load_dwordx4 v13, s[40:43], s34 offen offset:0 lds
    buffer_load_dwordx4 v13, s[40:43], s34 offen offset:1024 lds
    buffer_load_dwordx4 v14, s[40:43], s34 offen offset:2048 lds
    buffer_load_dwordx4 v14, s[40:43], s34 offen offset:3072 lds
    s_waitcnt vmcnt(18)
    s_barrier
    s_mov_b32 m0, 106496
    s_add_u32 s35, s55, 204800
    buffer_load_dwordx4 v2, s[44:47], s35 offen offset:0 lds
    buffer_load_dwordx4 v2, s[44:47], s35 offen offset:1024 lds
    buffer_load_dwordx4 v2, s[44:47], s35 offen offset:2048 lds
    buffer_load_dwordx4 v2, s[44:47], s35 offen offset:3072 lds
    s_mov_b32 m0, 110592
    s_add_u32 s35, s55, 208896
    buffer_load_dwordx4 v2, s[44:47], s35 offen offset:0 lds
    s_add_u32 m0, s52, 32768
    s_movk_i32 s34, 20480
    buffer_load_dwordx4 v13, s[40:43], s34 offen offset:0 lds
    buffer_load_dwordx4 v13, s[40:43], s34 offen offset:1024 lds
    buffer_load_dwordx4 v14, s[40:43], s34 offen offset:2048 lds
    buffer_load_dwordx4 v14, s[40:43], s34 offen offset:3072 lds
    s_waitcnt vmcnt(18)
    s_barrier
    s_mov_b32 m0, 126976
    s_add_u32 s35, s55, 225280
    buffer_load_dwordx4 v2, s[44:47], s35 offen offset:0 lds
    buffer_load_dwordx4 v2, s[44:47], s35 offen offset:1024 lds
    buffer_load_dwordx4 v2, s[44:47], s35 offen offset:2048 lds
    buffer_load_dwordx4 v2, s[44:47], s35 offen offset:3072 lds
    s_mov_b32 m0, 131072
    s_add_u32 s35, s55, 229376
    buffer_load_dwordx4 v2, s[44:47], s35 offen offset:0 lds
    s_add_u32 m0, s52, 49152
    s_movk_i32 s34, 22528
    buffer_load_dwordx4 v13, s[40:43], s34 offen offset:0 lds
    buffer_load_dwordx4 v13, s[40:43], s34 offen offset:1024 lds
    buffer_load_dwordx4 v14, s[40:43], s34 offen offset:2048 lds
    buffer_load_dwordx4 v14, s[40:43], s34 offen offset:3072 lds
    s_waitcnt vmcnt(18)
    s_barrier
    s_waitcnt vmcnt(9)
    s_barrier
    s_waitcnt vmcnt(0)
    s_barrier
    s_barrier
    s_barrier
    s_branch m2_kernel_wd_done
m2_kernel_wd_r1:
    s_cmp_lg_u32 s22, 1
    s_cbranch_scc1 m2_kernel_wd_r2
    s_mov_b32 m0, 65536
    s_add_u32 s35, s55, 0
    buffer_load_dwordx4 v2, s[44:47], s35 offen offset:0 lds
    buffer_load_dwordx4 v2, s[44:47], s35 offen offset:1024 lds
    buffer_load_dwordx4 v2, s[44:47], s35 offen offset:2048 lds
    buffer_load_dwordx4 v2, s[44:47], s35 offen offset:3072 lds
    s_mov_b32 m0, 69632
    s_add_u32 s35, s55, 4096
    buffer_load_dwordx4 v2, s[44:47], s35 offen offset:0 lds
    buffer_load_dwordx4 v2, s[44:47], s35 offen offset:1024 lds
    buffer_load_dwordx4 v2, s[44:47], s35 offen offset:2048 lds
    s_mov_b32 m0, 86016
    s_add_u32 s35, s55, 20480
    buffer_load_dwordx4 v2, s[44:47], s35 offen offset:0 lds
    buffer_load_dwordx4 v2, s[44:47], s35 offen offset:1024 lds
    buffer_load_dwordx4 v2, s[44:47], s35 offen offset:2048 lds
    buffer_load_dwordx4 v2, s[44:47], s35 offen offset:3072 lds
    s_mov_b32 m0, 90112
    s_add_u32 s35, s55, 24576
    buffer_load_dwordx4 v2, s[44:47], s35 offen offset:0 lds
    buffer_load_dwordx4 v2, s[44:47], s35 offen offset:1024 lds
    buffer_load_dwordx4 v2, s[44:47], s35 offen offset:2048 lds
    s_mov_b32 m0, 106496
    s_add_u32 s35, s55, 40960
    buffer_load_dwordx4 v2, s[44:47], s35 offen offset:0 lds
    buffer_load_dwordx4 v2, s[44:47], s35 offen offset:1024 lds
    buffer_load_dwordx4 v2, s[44:47], s35 offen offset:2048 lds
    buffer_load_dwordx4 v2, s[44:47], s35 offen offset:3072 lds
    s_mov_b32 m0, 110592
    s_add_u32 s35, s55, 45056
    buffer_load_dwordx4 v2, s[44:47], s35 offen offset:0 lds
    buffer_load_dwordx4 v2, s[44:47], s35 offen offset:1024 lds
    buffer_load_dwordx4 v2, s[44:47], s35 offen offset:2048 lds
    s_mov_b32 m0, 126976
    s_add_u32 s35, s55, 61440
    buffer_load_dwordx4 v2, s[44:47], s35 offen offset:0 lds
    buffer_load_dwordx4 v2, s[44:47], s35 offen offset:1024 lds
    buffer_load_dwordx4 v2, s[44:47], s35 offen offset:2048 lds
    buffer_load_dwordx4 v2, s[44:47], s35 offen offset:3072 lds
    s_mov_b32 m0, 131072
    s_add_u32 s35, s55, 65536
    buffer_load_dwordx4 v2, s[44:47], s35 offen offset:0 lds
    buffer_load_dwordx4 v2, s[44:47], s35 offen offset:1024 lds
    buffer_load_dwordx4 v2, s[44:47], s35 offen offset:2048 lds
    s_barrier
    s_add_u32 m0, s52, 0
    s_movk_i32 s34, 0
    buffer_load_dwordx4 v13, s[40:43], s34 offen offset:0 lds
    buffer_load_dwordx4 v13, s[40:43], s34 offen offset:1024 lds
    buffer_load_dwordx4 v14, s[40:43], s34 offen offset:2048 lds
    buffer_load_dwordx4 v14, s[40:43], s34 offen offset:3072 lds
    s_add_u32 m0, s52, 16384
    s_movk_i32 s34, 2048
    buffer_load_dwordx4 v13, s[40:43], s34 offen offset:0 lds
    buffer_load_dwordx4 v13, s[40:43], s34 offen offset:1024 lds
    buffer_load_dwordx4 v14, s[40:43], s34 offen offset:2048 lds
    buffer_load_dwordx4 v14, s[40:43], s34 offen offset:3072 lds
    s_add_u32 m0, s52, 32768
    s_movk_i32 s34, 4096
    buffer_load_dwordx4 v13, s[40:43], s34 offen offset:0 lds
    buffer_load_dwordx4 v13, s[40:43], s34 offen offset:1024 lds
    buffer_load_dwordx4 v14, s[40:43], s34 offen offset:2048 lds
    buffer_load_dwordx4 v14, s[40:43], s34 offen offset:3072 lds
    s_add_u32 m0, s52, 49152
    s_movk_i32 s34, 6144
    buffer_load_dwordx4 v13, s[40:43], s34 offen offset:0 lds
    buffer_load_dwordx4 v13, s[40:43], s34 offen offset:1024 lds
    buffer_load_dwordx4 v14, s[40:43], s34 offen offset:2048 lds
    buffer_load_dwordx4 v14, s[40:43], s34 offen offset:3072 lds
    s_waitcnt vmcnt(12)
    s_barrier
    s_waitcnt vmcnt(8)
    s_barrier
    s_mov_b32 m0, 70656
    s_add_u32 s35, s55, 87040
    buffer_load_dwordx4 v2, s[44:47], s35 offen offset:0 lds
    buffer_load_dwordx4 v2, s[44:47], s35 offen offset:1024 lds
    buffer_load_dwordx4 v2, s[44:47], s35 offen offset:2048 lds
    buffer_load_dwordx4 v2, s[44:47], s35 offen offset:3072 lds
    s_mov_b32 m0, 74752
    s_add_u32 s35, s55, 91136
    buffer_load_dwordx4 v2, s[44:47], s35 offen offset:0 lds
    s_add_u32 m0, s52, 0
    s_movk_i32 s34, 8192
    buffer_load_dwordx4 v13, s[40:43], s34 offen offset:0 lds
    buffer_load_dwordx4 v13, s[40:43], s34 offen offset:1024 lds
    buffer_load_dwordx4 v14, s[40:43], s34 offen offset:2048 lds
    buffer_load_dwordx4 v14, s[40:43], s34 offen offset:3072 lds
    s_waitcnt vmcnt(13)
    s_barrier
    s_mov_b32 m0, 91136
    s_add_u32 s35, s55, 107520
    buffer_load_dwordx4 v2, s[44:47], s35 offen offset:0 lds
    buffer_load_dwordx4 v2, s[44:47], s35 offen offset:1024 lds
    buffer_load_dwordx4 v2, s[44:47], s35 offen offset:2048 lds
    buffer_load_dwordx4 v2, s[44:47], s35 offen offset:3072 lds
    s_mov_b32 m0, 95232
    s_add_u32 s35, s55, 111616
    buffer_load_dwordx4 v2, s[44:47], s35 offen offset:0 lds
    s_add_u32 m0, s52, 16384
    s_movk_i32 s34, 10240
    buffer_load_dwordx4 v13, s[40:43], s34 offen offset:0 lds
    buffer_load_dwordx4 v13, s[40:43], s34 offen offset:1024 lds
    buffer_load_dwordx4 v14, s[40:43], s34 offen offset:2048 lds
    buffer_load_dwordx4 v14, s[40:43], s34 offen offset:3072 lds
    s_waitcnt vmcnt(18)
    s_barrier
    s_mov_b32 m0, 111616
    s_add_u32 s35, s55, 128000
    buffer_load_dwordx4 v2, s[44:47], s35 offen offset:0 lds
    buffer_load_dwordx4 v2, s[44:47], s35 offen offset:1024 lds
    buffer_load_dwordx4 v2, s[44:47], s35 offen offset:2048 lds
    buffer_load_dwordx4 v2, s[44:47], s35 offen offset:3072 lds
    s_mov_b32 m0, 115712
    s_add_u32 s35, s55, 132096
    buffer_load_dwordx4 v2, s[44:47], s35 offen offset:0 lds
    s_add_u32 m0, s52, 32768
    s_movk_i32 s34, 12288
    buffer_load_dwordx4 v13, s[40:43], s34 offen offset:0 lds
    buffer_load_dwordx4 v13, s[40:43], s34 offen offset:1024 lds
    buffer_load_dwordx4 v14, s[40:43], s34 offen offset:2048 lds
    buffer_load_dwordx4 v14, s[40:43], s34 offen offset:3072 lds
    s_waitcnt vmcnt(18)
    s_barrier
    s_mov_b32 m0, 132096
    s_add_u32 s35, s55, 148480
    buffer_load_dwordx4 v2, s[44:47], s35 offen offset:0 lds
    buffer_load_dwordx4 v2, s[44:47], s35 offen offset:1024 lds
    buffer_load_dwordx4 v2, s[44:47], s35 offen offset:2048 lds
    buffer_load_dwordx4 v2, s[44:47], s35 offen offset:3072 lds
    s_mov_b32 m0, 136192
    s_add_u32 s35, s55, 152576
    buffer_load_dwordx4 v2, s[44:47], s35 offen offset:0 lds
    s_add_u32 m0, s52, 49152
    s_movk_i32 s34, 14336
    buffer_load_dwordx4 v13, s[40:43], s34 offen offset:0 lds
    buffer_load_dwordx4 v13, s[40:43], s34 offen offset:1024 lds
    buffer_load_dwordx4 v14, s[40:43], s34 offen offset:2048 lds
    buffer_load_dwordx4 v14, s[40:43], s34 offen offset:3072 lds
    s_waitcnt vmcnt(18)
    s_barrier
    s_mov_b32 m0, 70656
    s_add_u32 s35, s55, 168960
    buffer_load_dwordx4 v2, s[44:47], s35 offen offset:0 lds
    buffer_load_dwordx4 v2, s[44:47], s35 offen offset:1024 lds
    buffer_load_dwordx4 v2, s[44:47], s35 offen offset:2048 lds
    buffer_load_dwordx4 v2, s[44:47], s35 offen offset:3072 lds
    s_mov_b32 m0, 74752
    s_add_u32 s35, s55, 173056
    buffer_load_dwordx4 v2, s[44:47], s35 offen offset:0 lds
    s_add_u32 m0, s52, 0
    s_movk_i32 s34, 16384
    buffer_load_dwordx4 v13, s[40:43], s34 offen offset:0 lds
    buffer_load_dwordx4 v13, s[40:43], s34 offen offset:1024 lds
    buffer_load_dwordx4 v14, s[40:43], s34 offen offset:2048 lds
    buffer_load_dwordx4 v14, s[40:43], s34 offen offset:3072 lds
    s_waitcnt vmcnt(18)
    s_barrier
    s_mov_b32 m0, 91136
    s_add_u32 s35, s55, 189440
    buffer_load_dwordx4 v2, s[44:47], s35 offen offset:0 lds
    buffer_load_dwordx4 v2, s[44:47], s35 offen offset:1024 lds
    buffer_load_dwordx4 v2, s[44:47], s35 offen offset:2048 lds
    buffer_load_dwordx4 v2, s[44:47], s35 offen offset:3072 lds
    s_mov_b32 m0, 95232
    s_add_u32 s35, s55, 193536
    buffer_load_dwordx4 v2, s[44:47], s35 offen offset:0 lds
    s_add_u32 m0, s52, 16384
    s_movk_i32 s34, 18432
    buffer_load_dwordx4 v13, s[40:43], s34 offen offset:0 lds
    buffer_load_dwordx4 v13, s[40:43], s34 offen offset:1024 lds
    buffer_load_dwordx4 v14, s[40:43], s34 offen offset:2048 lds
    buffer_load_dwordx4 v14, s[40:43], s34 offen offset:3072 lds
    s_waitcnt vmcnt(18)
    s_barrier
    s_mov_b32 m0, 111616
    s_add_u32 s35, s55, 209920
    buffer_load_dwordx4 v2, s[44:47], s35 offen offset:0 lds
    buffer_load_dwordx4 v2, s[44:47], s35 offen offset:1024 lds
    buffer_load_dwordx4 v2, s[44:47], s35 offen offset:2048 lds
    buffer_load_dwordx4 v2, s[44:47], s35 offen offset:3072 lds
    s_mov_b32 m0, 115712
    s_add_u32 s35, s55, 214016
    buffer_load_dwordx4 v2, s[44:47], s35 offen offset:0 lds
    s_add_u32 m0, s52, 32768
    s_movk_i32 s34, 20480
    buffer_load_dwordx4 v13, s[40:43], s34 offen offset:0 lds
    buffer_load_dwordx4 v13, s[40:43], s34 offen offset:1024 lds
    buffer_load_dwordx4 v14, s[40:43], s34 offen offset:2048 lds
    buffer_load_dwordx4 v14, s[40:43], s34 offen offset:3072 lds
    s_waitcnt vmcnt(18)
    s_barrier
    s_mov_b32 m0, 132096
    s_add_u32 s35, s55, 230400
    buffer_load_dwordx4 v2, s[44:47], s35 offen offset:0 lds
    buffer_load_dwordx4 v2, s[44:47], s35 offen offset:1024 lds
    buffer_load_dwordx4 v2, s[44:47], s35 offen offset:2048 lds
    buffer_load_dwordx4 v2, s[44:47], s35 offen offset:3072 lds
    s_mov_b32 m0, 136192
    s_add_u32 s35, s55, 234496
    buffer_load_dwordx4 v2, s[44:47], s35 offen offset:0 lds
    s_add_u32 m0, s52, 49152
    s_movk_i32 s34, 22528
    buffer_load_dwordx4 v13, s[40:43], s34 offen offset:0 lds
    buffer_load_dwordx4 v13, s[40:43], s34 offen offset:1024 lds
    buffer_load_dwordx4 v14, s[40:43], s34 offen offset:2048 lds
    buffer_load_dwordx4 v14, s[40:43], s34 offen offset:3072 lds
    s_waitcnt vmcnt(18)
    s_barrier
    s_waitcnt vmcnt(9)
    s_barrier
    s_waitcnt vmcnt(0)
    s_barrier
    s_barrier
    s_barrier
    s_branch m2_kernel_wd_done
m2_kernel_wd_r2:
    s_cmp_lg_u32 s22, 2
    s_cbranch_scc1 m2_kernel_wd_r3
    s_mov_b32 m0, 72704
    s_add_u32 s35, s55, 7168
    buffer_load_dwordx4 v2, s[44:47], s35 offen offset:0 lds
    buffer_load_dwordx4 v2, s[44:47], s35 offen offset:1024 lds
    buffer_load_dwordx4 v2, s[44:47], s35 offen offset:2048 lds
    buffer_load_dwordx4 v2, s[44:47], s35 offen offset:3072 lds
    s_mov_b32 m0, 76800
    s_add_u32 s35, s55, 11264
    buffer_load_dwordx4 v2, s[44:47], s35 offen offset:0 lds
    buffer_load_dwordx4 v2, s[44:47], s35 offen offset:1024 lds
    buffer_load_dwordx4 v2, s[44:47], s35 offen offset:2048 lds
    s_mov_b32 m0, 93184
    s_add_u32 s35, s55, 27648
    buffer_load_dwordx4 v2, s[44:47], s35 offen offset:0 lds
    buffer_load_dwordx4 v2, s[44:47], s35 offen offset:1024 lds
    buffer_load_dwordx4 v2, s[44:47], s35 offen offset:2048 lds
    buffer_load_dwordx4 v2, s[44:47], s35 offen offset:3072 lds
    s_mov_b32 m0, 97280
    s_add_u32 s35, s55, 31744
    buffer_load_dwordx4 v2, s[44:47], s35 offen offset:0 lds
    buffer_load_dwordx4 v2, s[44:47], s35 offen offset:1024 lds
    buffer_load_dwordx4 v2, s[44:47], s35 offen offset:2048 lds
    s_mov_b32 m0, 113664
    s_add_u32 s35, s55, 48128
    buffer_load_dwordx4 v2, s[44:47], s35 offen offset:0 lds
    buffer_load_dwordx4 v2, s[44:47], s35 offen offset:1024 lds
    buffer_load_dwordx4 v2, s[44:47], s35 offen offset:2048 lds
    buffer_load_dwordx4 v2, s[44:47], s35 offen offset:3072 lds
    s_mov_b32 m0, 117760
    s_add_u32 s35, s55, 52224
    buffer_load_dwordx4 v2, s[44:47], s35 offen offset:0 lds
    buffer_load_dwordx4 v2, s[44:47], s35 offen offset:1024 lds
    buffer_load_dwordx4 v2, s[44:47], s35 offen offset:2048 lds
    s_mov_b32 m0, 134144
    s_add_u32 s35, s55, 68608
    buffer_load_dwordx4 v2, s[44:47], s35 offen offset:0 lds
    buffer_load_dwordx4 v2, s[44:47], s35 offen offset:1024 lds
    buffer_load_dwordx4 v2, s[44:47], s35 offen offset:2048 lds
    buffer_load_dwordx4 v2, s[44:47], s35 offen offset:3072 lds
    s_mov_b32 m0, 138240
    s_add_u32 s35, s55, 72704
    buffer_load_dwordx4 v2, s[44:47], s35 offen offset:0 lds
    buffer_load_dwordx4 v2, s[44:47], s35 offen offset:1024 lds
    buffer_load_dwordx4 v2, s[44:47], s35 offen offset:2048 lds
    s_barrier
    s_add_u32 m0, s52, 0
    s_movk_i32 s34, 0
    buffer_load_dwordx4 v13, s[40:43], s34 offen offset:0 lds
    buffer_load_dwordx4 v13, s[40:43], s34 offen offset:1024 lds
    buffer_load_dwordx4 v14, s[40:43], s34 offen offset:2048 lds
    buffer_load_dwordx4 v14, s[40:43], s34 offen offset:3072 lds
    s_add_u32 m0, s52, 16384
    s_movk_i32 s34, 2048
    buffer_load_dwordx4 v13, s[40:43], s34 offen offset:0 lds
    buffer_load_dwordx4 v13, s[40:43], s34 offen offset:1024 lds
    buffer_load_dwordx4 v14, s[40:43], s34 offen offset:2048 lds
    buffer_load_dwordx4 v14, s[40:43], s34 offen offset:3072 lds
    s_add_u32 m0, s52, 32768
    s_movk_i32 s34, 4096
    buffer_load_dwordx4 v13, s[40:43], s34 offen offset:0 lds
    buffer_load_dwordx4 v13, s[40:43], s34 offen offset:1024 lds
    buffer_load_dwordx4 v14, s[40:43], s34 offen offset:2048 lds
    buffer_load_dwordx4 v14, s[40:43], s34 offen offset:3072 lds
    s_add_u32 m0, s52, 49152
    s_movk_i32 s34, 6144
    buffer_load_dwordx4 v13, s[40:43], s34 offen offset:0 lds
    buffer_load_dwordx4 v13, s[40:43], s34 offen offset:1024 lds
    buffer_load_dwordx4 v14, s[40:43], s34 offen offset:2048 lds
    buffer_load_dwordx4 v14, s[40:43], s34 offen offset:3072 lds
    s_waitcnt vmcnt(12)
    s_barrier
    s_waitcnt vmcnt(8)
    s_barrier
    s_mov_b32 m0, 75776
    s_add_u32 s35, s55, 92160
    buffer_load_dwordx4 v2, s[44:47], s35 offen offset:0 lds
    buffer_load_dwordx4 v2, s[44:47], s35 offen offset:1024 lds
    buffer_load_dwordx4 v2, s[44:47], s35 offen offset:2048 lds
    buffer_load_dwordx4 v2, s[44:47], s35 offen offset:3072 lds
    s_mov_b32 m0, 79872
    s_add_u32 s35, s55, 96256
    buffer_load_dwordx4 v2, s[44:47], s35 offen offset:0 lds
    s_add_u32 m0, s52, 0
    s_movk_i32 s34, 8192
    buffer_load_dwordx4 v13, s[40:43], s34 offen offset:0 lds
    buffer_load_dwordx4 v13, s[40:43], s34 offen offset:1024 lds
    buffer_load_dwordx4 v14, s[40:43], s34 offen offset:2048 lds
    buffer_load_dwordx4 v14, s[40:43], s34 offen offset:3072 lds
    s_waitcnt vmcnt(13)
    s_barrier
    s_mov_b32 m0, 96256
    s_add_u32 s35, s55, 112640
    buffer_load_dwordx4 v2, s[44:47], s35 offen offset:0 lds
    buffer_load_dwordx4 v2, s[44:47], s35 offen offset:1024 lds
    buffer_load_dwordx4 v2, s[44:47], s35 offen offset:2048 lds
    buffer_load_dwordx4 v2, s[44:47], s35 offen offset:3072 lds
    s_mov_b32 m0, 100352
    s_add_u32 s35, s55, 116736
    buffer_load_dwordx4 v2, s[44:47], s35 offen offset:0 lds
    s_add_u32 m0, s52, 16384
    s_movk_i32 s34, 10240
    buffer_load_dwordx4 v13, s[40:43], s34 offen offset:0 lds
    buffer_load_dwordx4 v13, s[40:43], s34 offen offset:1024 lds
    buffer_load_dwordx4 v14, s[40:43], s34 offen offset:2048 lds
    buffer_load_dwordx4 v14, s[40:43], s34 offen offset:3072 lds
    s_waitcnt vmcnt(18)
    s_barrier
    s_mov_b32 m0, 116736
    s_add_u32 s35, s55, 133120
    buffer_load_dwordx4 v2, s[44:47], s35 offen offset:0 lds
    buffer_load_dwordx4 v2, s[44:47], s35 offen offset:1024 lds
    buffer_load_dwordx4 v2, s[44:47], s35 offen offset:2048 lds
    buffer_load_dwordx4 v2, s[44:47], s35 offen offset:3072 lds
    s_mov_b32 m0, 120832
    s_add_u32 s35, s55, 137216
    buffer_load_dwordx4 v2, s[44:47], s35 offen offset:0 lds
    s_add_u32 m0, s52, 32768
    s_movk_i32 s34, 12288
    buffer_load_dwordx4 v13, s[40:43], s34 offen offset:0 lds
    buffer_load_dwordx4 v13, s[40:43], s34 offen offset:1024 lds
    buffer_load_dwordx4 v14, s[40:43], s34 offen offset:2048 lds
    buffer_load_dwordx4 v14, s[40:43], s34 offen offset:3072 lds
    s_waitcnt vmcnt(18)
    s_barrier
    s_mov_b32 m0, 137216
    s_add_u32 s35, s55, 153600
    buffer_load_dwordx4 v2, s[44:47], s35 offen offset:0 lds
    buffer_load_dwordx4 v2, s[44:47], s35 offen offset:1024 lds
    buffer_load_dwordx4 v2, s[44:47], s35 offen offset:2048 lds
    buffer_load_dwordx4 v2, s[44:47], s35 offen offset:3072 lds
    s_mov_b32 m0, 141312
    s_add_u32 s35, s55, 157696
    buffer_load_dwordx4 v2, s[44:47], s35 offen offset:0 lds
    s_add_u32 m0, s52, 49152
    s_movk_i32 s34, 14336
    buffer_load_dwordx4 v13, s[40:43], s34 offen offset:0 lds
    buffer_load_dwordx4 v13, s[40:43], s34 offen offset:1024 lds
    buffer_load_dwordx4 v14, s[40:43], s34 offen offset:2048 lds
    buffer_load_dwordx4 v14, s[40:43], s34 offen offset:3072 lds
    s_waitcnt vmcnt(18)
    s_barrier
    s_mov_b32 m0, 75776
    s_add_u32 s35, s55, 174080
    buffer_load_dwordx4 v2, s[44:47], s35 offen offset:0 lds
    buffer_load_dwordx4 v2, s[44:47], s35 offen offset:1024 lds
    buffer_load_dwordx4 v2, s[44:47], s35 offen offset:2048 lds
    buffer_load_dwordx4 v2, s[44:47], s35 offen offset:3072 lds
    s_mov_b32 m0, 79872
    s_add_u32 s35, s55, 178176
    buffer_load_dwordx4 v2, s[44:47], s35 offen offset:0 lds
    s_add_u32 m0, s52, 0
    s_movk_i32 s34, 16384
    buffer_load_dwordx4 v13, s[40:43], s34 offen offset:0 lds
    buffer_load_dwordx4 v13, s[40:43], s34 offen offset:1024 lds
    buffer_load_dwordx4 v14, s[40:43], s34 offen offset:2048 lds
    buffer_load_dwordx4 v14, s[40:43], s34 offen offset:3072 lds
    s_waitcnt vmcnt(18)
    s_barrier
    s_mov_b32 m0, 96256
    s_add_u32 s35, s55, 194560
    buffer_load_dwordx4 v2, s[44:47], s35 offen offset:0 lds
    buffer_load_dwordx4 v2, s[44:47], s35 offen offset:1024 lds
    buffer_load_dwordx4 v2, s[44:47], s35 offen offset:2048 lds
    buffer_load_dwordx4 v2, s[44:47], s35 offen offset:3072 lds
    s_mov_b32 m0, 100352
    s_add_u32 s35, s55, 198656
    buffer_load_dwordx4 v2, s[44:47], s35 offen offset:0 lds
    s_add_u32 m0, s52, 16384
    s_movk_i32 s34, 18432
    buffer_load_dwordx4 v13, s[40:43], s34 offen offset:0 lds
    buffer_load_dwordx4 v13, s[40:43], s34 offen offset:1024 lds
    buffer_load_dwordx4 v14, s[40:43], s34 offen offset:2048 lds
    buffer_load_dwordx4 v14, s[40:43], s34 offen offset:3072 lds
    s_waitcnt vmcnt(18)
    s_barrier
    s_mov_b32 m0, 116736
    s_add_u32 s35, s55, 215040
    buffer_load_dwordx4 v2, s[44:47], s35 offen offset:0 lds
    buffer_load_dwordx4 v2, s[44:47], s35 offen offset:1024 lds
    buffer_load_dwordx4 v2, s[44:47], s35 offen offset:2048 lds
    buffer_load_dwordx4 v2, s[44:47], s35 offen offset:3072 lds
    s_mov_b32 m0, 120832
    s_add_u32 s35, s55, 219136
    buffer_load_dwordx4 v2, s[44:47], s35 offen offset:0 lds
    s_add_u32 m0, s52, 32768
    s_movk_i32 s34, 20480
    buffer_load_dwordx4 v13, s[40:43], s34 offen offset:0 lds
    buffer_load_dwordx4 v13, s[40:43], s34 offen offset:1024 lds
    buffer_load_dwordx4 v14, s[40:43], s34 offen offset:2048 lds
    buffer_load_dwordx4 v14, s[40:43], s34 offen offset:3072 lds
    s_waitcnt vmcnt(18)
    s_barrier
    s_mov_b32 m0, 137216
    s_add_u32 s35, s55, 235520
    buffer_load_dwordx4 v2, s[44:47], s35 offen offset:0 lds
    buffer_load_dwordx4 v2, s[44:47], s35 offen offset:1024 lds
    buffer_load_dwordx4 v2, s[44:47], s35 offen offset:2048 lds
    buffer_load_dwordx4 v2, s[44:47], s35 offen offset:3072 lds
    s_mov_b32 m0, 141312
    s_add_u32 s35, s55, 239616
    buffer_load_dwordx4 v2, s[44:47], s35 offen offset:0 lds
    s_add_u32 m0, s52, 49152
    s_movk_i32 s34, 22528
    buffer_load_dwordx4 v13, s[40:43], s34 offen offset:0 lds
    buffer_load_dwordx4 v13, s[40:43], s34 offen offset:1024 lds
    buffer_load_dwordx4 v14, s[40:43], s34 offen offset:2048 lds
    buffer_load_dwordx4 v14, s[40:43], s34 offen offset:3072 lds
    s_waitcnt vmcnt(18)
    s_barrier
    s_waitcnt vmcnt(9)
    s_barrier
    s_waitcnt vmcnt(0)
    s_barrier
    s_barrier
    s_barrier
    s_branch m2_kernel_wd_done
m2_kernel_wd_r3:
    s_mov_b32 m0, 79872
    s_add_u32 s35, s55, 14336
    buffer_load_dwordx4 v2, s[44:47], s35 offen offset:0 lds
    buffer_load_dwordx4 v2, s[44:47], s35 offen offset:1024 lds
    buffer_load_dwordx4 v2, s[44:47], s35 offen offset:2048 lds
    buffer_load_dwordx4 v2, s[44:47], s35 offen offset:3072 lds
    s_mov_b32 m0, 83968
    s_add_u32 s35, s55, 18432
    buffer_load_dwordx4 v2, s[44:47], s35 offen offset:0 lds
    buffer_load_dwordx4 v2, s[44:47], s35 offen offset:1024 lds
    s_mov_b32 m0, 100352
    s_add_u32 s35, s55, 34816
    buffer_load_dwordx4 v2, s[44:47], s35 offen offset:0 lds
    buffer_load_dwordx4 v2, s[44:47], s35 offen offset:1024 lds
    buffer_load_dwordx4 v2, s[44:47], s35 offen offset:2048 lds
    buffer_load_dwordx4 v2, s[44:47], s35 offen offset:3072 lds
    s_mov_b32 m0, 104448
    s_add_u32 s35, s55, 38912
    buffer_load_dwordx4 v2, s[44:47], s35 offen offset:0 lds
    buffer_load_dwordx4 v2, s[44:47], s35 offen offset:1024 lds
    s_mov_b32 m0, 120832
    s_add_u32 s35, s55, 55296
    buffer_load_dwordx4 v2, s[44:47], s35 offen offset:0 lds
    buffer_load_dwordx4 v2, s[44:47], s35 offen offset:1024 lds
    buffer_load_dwordx4 v2, s[44:47], s35 offen offset:2048 lds
    buffer_load_dwordx4 v2, s[44:47], s35 offen offset:3072 lds
    s_mov_b32 m0, 124928
    s_add_u32 s35, s55, 59392
    buffer_load_dwordx4 v2, s[44:47], s35 offen offset:0 lds
    buffer_load_dwordx4 v2, s[44:47], s35 offen offset:1024 lds
    s_mov_b32 m0, 141312
    s_add_u32 s35, s55, 75776
    buffer_load_dwordx4 v2, s[44:47], s35 offen offset:0 lds
    buffer_load_dwordx4 v2, s[44:47], s35 offen offset:1024 lds
    buffer_load_dwordx4 v2, s[44:47], s35 offen offset:2048 lds
    buffer_load_dwordx4 v2, s[44:47], s35 offen offset:3072 lds
    s_mov_b32 m0, 145408
    s_add_u32 s35, s55, 79872
    buffer_load_dwordx4 v2, s[44:47], s35 offen offset:0 lds
    buffer_load_dwordx4 v2, s[44:47], s35 offen offset:1024 lds
    s_barrier
    s_add_u32 m0, s52, 0
    s_movk_i32 s34, 0
    buffer_load_dwordx4 v13, s[40:43], s34 offen offset:0 lds
    buffer_load_dwordx4 v13, s[40:43], s34 offen offset:1024 lds
    buffer_load_dwordx4 v14, s[40:43], s34 offen offset:2048 lds
    buffer_load_dwordx4 v14, s[40:43], s34 offen offset:3072 lds
    s_add_u32 m0, s52, 16384
    s_movk_i32 s34, 2048
    buffer_load_dwordx4 v13, s[40:43], s34 offen offset:0 lds
    buffer_load_dwordx4 v13, s[40:43], s34 offen offset:1024 lds
    buffer_load_dwordx4 v14, s[40:43], s34 offen offset:2048 lds
    buffer_load_dwordx4 v14, s[40:43], s34 offen offset:3072 lds
    s_add_u32 m0, s52, 32768
    s_movk_i32 s34, 4096
    buffer_load_dwordx4 v13, s[40:43], s34 offen offset:0 lds
    buffer_load_dwordx4 v13, s[40:43], s34 offen offset:1024 lds
    buffer_load_dwordx4 v14, s[40:43], s34 offen offset:2048 lds
    buffer_load_dwordx4 v14, s[40:43], s34 offen offset:3072 lds
    s_add_u32 m0, s52, 49152
    s_movk_i32 s34, 6144
    buffer_load_dwordx4 v13, s[40:43], s34 offen offset:0 lds
    buffer_load_dwordx4 v13, s[40:43], s34 offen offset:1024 lds
    buffer_load_dwordx4 v14, s[40:43], s34 offen offset:2048 lds
    buffer_load_dwordx4 v14, s[40:43], s34 offen offset:3072 lds
    s_waitcnt vmcnt(12)
    s_barrier
    s_waitcnt vmcnt(8)
    s_barrier
    s_mov_b32 m0, 80896
    s_add_u32 s35, s55, 97280
    buffer_load_dwordx4 v2, s[44:47], s35 offen offset:0 lds
    buffer_load_dwordx4 v2, s[44:47], s35 offen offset:1024 lds
    buffer_load_dwordx4 v2, s[44:47], s35 offen offset:2048 lds
    buffer_load_dwordx4 v2, s[44:47], s35 offen offset:3072 lds
    s_mov_b32 m0, 84992
    s_add_u32 s35, s55, 101376
    buffer_load_dwordx4 v2, s[44:47], s35 offen offset:0 lds
    s_add_u32 m0, s52, 0
    s_movk_i32 s34, 8192
    buffer_load_dwordx4 v13, s[40:43], s34 offen offset:0 lds
    buffer_load_dwordx4 v13, s[40:43], s34 offen offset:1024 lds
    buffer_load_dwordx4 v14, s[40:43], s34 offen offset:2048 lds
    buffer_load_dwordx4 v14, s[40:43], s34 offen offset:3072 lds
    s_waitcnt vmcnt(13)
    s_barrier
    s_mov_b32 m0, 101376
    s_add_u32 s35, s55, 117760
    buffer_load_dwordx4 v2, s[44:47], s35 offen offset:0 lds
    buffer_load_dwordx4 v2, s[44:47], s35 offen offset:1024 lds
    buffer_load_dwordx4 v2, s[44:47], s35 offen offset:2048 lds
    buffer_load_dwordx4 v2, s[44:47], s35 offen offset:3072 lds
    s_mov_b32 m0, 105472
    s_add_u32 s35, s55, 121856
    buffer_load_dwordx4 v2, s[44:47], s35 offen offset:0 lds
    s_add_u32 m0, s52, 16384
    s_movk_i32 s34, 10240
    buffer_load_dwordx4 v13, s[40:43], s34 offen offset:0 lds
    buffer_load_dwordx4 v13, s[40:43], s34 offen offset:1024 lds
    buffer_load_dwordx4 v14, s[40:43], s34 offen offset:2048 lds
    buffer_load_dwordx4 v14, s[40:43], s34 offen offset:3072 lds
    s_waitcnt vmcnt(18)
    s_barrier
    s_mov_b32 m0, 121856
    s_add_u32 s35, s55, 138240
    buffer_load_dwordx4 v2, s[44:47], s35 offen offset:0 lds
    buffer_load_dwordx4 v2, s[44:47], s35 offen offset:1024 lds
    buffer_load_dwordx4 v2, s[44:47], s35 offen offset:2048 lds
    buffer_load_dwordx4 v2, s[44:47], s35 offen offset:3072 lds
    s_mov_b32 m0, 125952
    s_add_u32 s35, s55, 142336
    buffer_load_dwordx4 v2, s[44:47], s35 offen offset:0 lds
    s_add_u32 m0, s52, 32768
    s_movk_i32 s34, 12288
    buffer_load_dwordx4 v13, s[40:43], s34 offen offset:0 lds
    buffer_load_dwordx4 v13, s[40:43], s34 offen offset:1024 lds
    buffer_load_dwordx4 v14, s[40:43], s34 offen offset:2048 lds
    buffer_load_dwordx4 v14, s[40:43], s34 offen offset:3072 lds
    s_waitcnt vmcnt(18)
    s_barrier
    s_mov_b32 m0, 142336
    s_add_u32 s35, s55, 158720
    buffer_load_dwordx4 v2, s[44:47], s35 offen offset:0 lds
    buffer_load_dwordx4 v2, s[44:47], s35 offen offset:1024 lds
    buffer_load_dwordx4 v2, s[44:47], s35 offen offset:2048 lds
    buffer_load_dwordx4 v2, s[44:47], s35 offen offset:3072 lds
    s_mov_b32 m0, 146432
    s_add_u32 s35, s55, 162816
    buffer_load_dwordx4 v2, s[44:47], s35 offen offset:0 lds
    s_add_u32 m0, s52, 49152
    s_movk_i32 s34, 14336
    buffer_load_dwordx4 v13, s[40:43], s34 offen offset:0 lds
    buffer_load_dwordx4 v13, s[40:43], s34 offen offset:1024 lds
    buffer_load_dwordx4 v14, s[40:43], s34 offen offset:2048 lds
    buffer_load_dwordx4 v14, s[40:43], s34 offen offset:3072 lds
    s_waitcnt vmcnt(18)
    s_barrier
    s_mov_b32 m0, 80896
    s_add_u32 s35, s55, 179200
    buffer_load_dwordx4 v2, s[44:47], s35 offen offset:0 lds
    buffer_load_dwordx4 v2, s[44:47], s35 offen offset:1024 lds
    buffer_load_dwordx4 v2, s[44:47], s35 offen offset:2048 lds
    buffer_load_dwordx4 v2, s[44:47], s35 offen offset:3072 lds
    s_mov_b32 m0, 84992
    s_add_u32 s35, s55, 183296
    buffer_load_dwordx4 v2, s[44:47], s35 offen offset:0 lds
    s_add_u32 m0, s52, 0
    s_movk_i32 s34, 16384
    buffer_load_dwordx4 v13, s[40:43], s34 offen offset:0 lds
    buffer_load_dwordx4 v13, s[40:43], s34 offen offset:1024 lds
    buffer_load_dwordx4 v14, s[40:43], s34 offen offset:2048 lds
    buffer_load_dwordx4 v14, s[40:43], s34 offen offset:3072 lds
    s_waitcnt vmcnt(18)
    s_barrier
    s_mov_b32 m0, 101376
    s_add_u32 s35, s55, 199680
    buffer_load_dwordx4 v2, s[44:47], s35 offen offset:0 lds
    buffer_load_dwordx4 v2, s[44:47], s35 offen offset:1024 lds
    buffer_load_dwordx4 v2, s[44:47], s35 offen offset:2048 lds
    buffer_load_dwordx4 v2, s[44:47], s35 offen offset:3072 lds
    s_mov_b32 m0, 105472
    s_add_u32 s35, s55, 203776
    buffer_load_dwordx4 v2, s[44:47], s35 offen offset:0 lds
    s_add_u32 m0, s52, 16384
    s_movk_i32 s34, 18432
    buffer_load_dwordx4 v13, s[40:43], s34 offen offset:0 lds
    buffer_load_dwordx4 v13, s[40:43], s34 offen offset:1024 lds
    buffer_load_dwordx4 v14, s[40:43], s34 offen offset:2048 lds
    buffer_load_dwordx4 v14, s[40:43], s34 offen offset:3072 lds
    s_waitcnt vmcnt(18)
    s_barrier
    s_mov_b32 m0, 121856
    s_add_u32 s35, s55, 220160
    buffer_load_dwordx4 v2, s[44:47], s35 offen offset:0 lds
    buffer_load_dwordx4 v2, s[44:47], s35 offen offset:1024 lds
    buffer_load_dwordx4 v2, s[44:47], s35 offen offset:2048 lds
    buffer_load_dwordx4 v2, s[44:47], s35 offen offset:3072 lds
    s_mov_b32 m0, 125952
    s_add_u32 s35, s55, 224256
    buffer_load_dwordx4 v2, s[44:47], s35 offen offset:0 lds
    s_add_u32 m0, s52, 32768
    s_movk_i32 s34, 20480
    buffer_load_dwordx4 v13, s[40:43], s34 offen offset:0 lds
    buffer_load_dwordx4 v13, s[40:43], s34 offen offset:1024 lds
    buffer_load_dwordx4 v14, s[40:43], s34 offen offset:2048 lds
    buffer_load_dwordx4 v14, s[40:43], s34 offen offset:3072 lds
    s_waitcnt vmcnt(18)
    s_barrier
    s_mov_b32 m0, 142336
    s_add_u32 s35, s55, 240640
    buffer_load_dwordx4 v2, s[44:47], s35 offen offset:0 lds
    buffer_load_dwordx4 v2, s[44:47], s35 offen offset:1024 lds
    buffer_load_dwordx4 v2, s[44:47], s35 offen offset:2048 lds
    buffer_load_dwordx4 v2, s[44:47], s35 offen offset:3072 lds
    s_mov_b32 m0, 146432
    s_add_u32 s35, s55, 244736
    buffer_load_dwordx4 v2, s[44:47], s35 offen offset:0 lds
    s_add_u32 m0, s52, 49152
    s_movk_i32 s34, 22528
    buffer_load_dwordx4 v13, s[40:43], s34 offen offset:0 lds
    buffer_load_dwordx4 v13, s[40:43], s34 offen offset:1024 lds
    buffer_load_dwordx4 v14, s[40:43], s34 offen offset:2048 lds
    buffer_load_dwordx4 v14, s[40:43], s34 offen offset:3072 lds
    s_waitcnt vmcnt(18)
    s_barrier
    s_waitcnt vmcnt(9)
    s_barrier
    s_waitcnt vmcnt(0)
    s_barrier
    s_barrier
    s_barrier
m2_kernel_wd_done:
    s_branch m2_kernel_end
m2_kernel_comp:
    s_lshr_b32 s52, s22, 1
    s_and_b32 s53, s22, 1
    v_lshlrev_b32 v2, 3, v1
    s_lshl_b32 s34, s53, 13
    s_lshl_b32 s35, s52, 12
    s_add_u32 s34, s34, s35
    v_add_u32 v2, s34, v2
    v_lshrrev_b32 v124, 4, v1
    v_bfe_u32 v125, v1, 2, 2
    v_and_b32 v126, 3, v1
    v_lshl_add_u32 v127, v124, 2, v125
    v_mul_u32_u24 v127, 160, v127
    v_lshl_add_u32 v127, v126, 3, v127
    s_mul_i32 s34, s53, 10336
    s_add_u32 s34, s34, 65536
    v_add_u32 v3, s34, v127
    s_mul_i32 s34, s53, 10176
    s_add_u32 s34, s34, 65536
    v_add_u32 v4, s34, v127
    v_and_b32 v128, 15, v1
    s_lshl_b32 s34, s26, 2
    s_and_b32 s35, s24, 3
    s_add_u32 s34, s34, s35
    s_lshl_b32 s34, s34, 6
    s_lshl_b32 s35, s52, 5
    s_add_u32 s34, s34, s35
    v_add_u32 v129, s34, v128
    v_mul_u32_u24 v130, 1280, v129
    v_lshl_add_u32 v130, v124, 3, v130
    s_mul_i32 s35, s27, 160
    v_add_u32 v130, s35, v130
    v_lshlrev_b32 v131, 3, v1
    s_lshr_b32 s35, s34, 4
    s_mul_i32 s35, s35, 20480
    v_add_u32 v131, s35, v131
    s_mul_i32 s36, s27, 5
    s_mov_b32 s40, s4
    s_mov_b32 s41, s5
    s_mov_b32 s42, 2621440
    s_mov_b32 s43, 0x00020000
    s_add_u32 s44, s20, 10485760
    s_addc_u32 s45, s21, 0
    s_mov_b32 s46, 2621440
    s_mov_b32 s47, 0x00020000
    s_add_u32 s48, s20, 19398656
    s_addc_u32 s49, s21, 0
    s_mov_b32 s50, 262144
    s_mov_b32 s51, 0x00020000
    v_mov_b32 v117, v130
    v_mov_b32 v116, v131
    s_mul_i32 s34, s53, 3
    s_add_u32 s34, s34, 0
    s_lshl_b32 s60, s34, 5
    s_add_u32 s34, s34, s36
    s_lshl_b32 s64, s34, 9
    s_mul_i32 s34, s53, 3
    s_add_u32 s34, s34, 1
    s_lshl_b32 s61, s34, 5
    s_add_u32 s34, s34, s36
    s_lshl_b32 s65, s34, 9
    s_mul_i32 s34, s53, 3
    s_add_u32 s34, s34, 2
    s_lshl_b32 s62, s34, 5
    s_add_u32 s34, s34, s36
    s_lshl_b32 s66, s34, 9
    s_mul_i32 s34, s52, 10240
    s_add_u32 s34, s34, 126976
    s_cmp_eq_u32 s53, 0
    s_movk_i32 s33, 4096
    s_cselect_b32 s35, 4294965248, s33
    s_cselect_b32 s33, 4096, 0
    s_add_u32 s35, s35, s34
    s_add_u32 s33, s33, s34
    v_lshlrev_b32 v124, 4, v1
    v_add_u32 v119, s35, v124
    v_add_u32 v120, s33, v124
    v_lshlrev_b32 v118, 7, v129
    s_lshl_b32 s34, s27, 4
    s_lshl_b32 s35, s53, 3
    s_add_u32 s34, s34, s35
    v_add_u32 v118, s34, v118
    s_mov_b32 s54, 0
    s_mov_b32 s68, 16384
    s_mov_b32 s69, 4294918144
    s_mov_b32 s70, 20480
    s_mov_b32 s71, 4294905856
    v_mov_b32 v64, 0
    v_mov_b32 v65, 0
    v_mov_b32 v66, 0
    v_mov_b32 v67, 0
    v_mov_b32 v68, 0
    v_mov_b32 v69, 0
    v_mov_b32 v70, 0
    v_mov_b32 v71, 0
    v_mov_b32 v72, 0
    v_mov_b32 v73, 0
    v_mov_b32 v74, 0
    v_mov_b32 v75, 0
    v_mov_b32 v76, 0
    v_mov_b32 v77, 0
    v_mov_b32 v78, 0
    v_mov_b32 v79, 0
    v_mov_b32 v80, 0
    v_mov_b32 v81, 0
    v_mov_b32 v82, 0
    v_mov_b32 v83, 0
    v_mov_b32 v84, 0
    v_mov_b32 v85, 0
    v_mov_b32 v86, 0
    v_mov_b32 v87, 0
    v_mov_b32 v88, 0
    v_mov_b32 v89, 0
    v_mov_b32 v90, 0
    v_mov_b32 v91, 0
    v_mov_b32 v92, 0
    v_mov_b32 v93, 0
    v_mov_b32 v94, 0
    v_mov_b32 v95, 0
    v_mov_b32 v96, 0
    v_mov_b32 v97, 0
    v_mov_b32 v98, 0
    v_mov_b32 v99, 0
    v_mov_b32 v100, 0
    v_mov_b32 v101, 0
    v_mov_b32 v102, 0
    v_mov_b32 v103, 0
    s_waitcnt vmcnt(0)
    s_barrier
    s_add_u32 s34, s60, 0
    buffer_load_dwordx2 v[104:105], v117, s[40:43], s34 offen
    s_add_u32 s34, s60, 20480
    buffer_load_dwordx2 v[106:107], v117, s[40:43], s34 offen
    s_add_u32 s34, s61, 0
    buffer_load_dwordx2 v[108:109], v117, s[40:43], s34 offen
    s_add_u32 s34, s61, 20480
    buffer_load_dwordx2 v[110:111], v117, s[40:43], s34 offen
    s_add_u32 s34, s62, 0
    buffer_load_dwordx2 v[112:113], v117, s[40:43], s34 offen
    s_add_u32 s34, s62, 20480
    buffer_load_dwordx2 v[114:115], v117, s[40:43], s34 offen
    s_barrier
    s_barrier
    ds_read_b64 v[8:9], v2 offset:0
    ds_read_b64 v[10:11], v2 offset:512
    ds_read_b64 v[12:13], v2 offset:2048
    ds_read_b64 v[14:15], v2 offset:2560
    ds_read_b64_tr_b16 v[24:25], v3 offset:0
    ds_read_b64_tr_b16 v[26:27], v3 offset:2560
    ds_read_b64_tr_b16 v[28:29], v3 offset:32
    ds_read_b64_tr_b16 v[30:31], v3 offset:2592
    ds_read_b64_tr_b16 v[32:33], v4 offset:64
    ds_read_b64_tr_b16 v[34:35], v4 offset:2624
    ds_read_b64_tr_b16 v[36:37], v4 offset:96
    ds_read_b64_tr_b16 v[38:39], v4 offset:2656
    ds_read_b64_tr_b16 v[40:41], v4 offset:128
    ds_read_b64_tr_b16 v[42:43], v4 offset:2688
    s_waitcnt lgkmcnt(8)
    v_mfma_f32_16x16x32_bf16 v[64:67], v[24:27], v[8:11], v[64:67]
    ds_read_b64 v[16:17], v2 offset:1024
    ds_read_b64 v[18:19], v2 offset:1536
    v_mfma_f32_16x16x32_bf16 v[68:71], v[24:27], v[12:15], v[68:71]
    ds_read_b64 v[20:21], v2 offset:3072
    ds_read_b64 v[22:23], v2 offset:3584
    s_waitcnt lgkmcnt(10)
    v_mfma_f32_16x16x32_bf16 v[72:75], v[28:31], v[8:11], v[72:75]
    ds_read_b64_tr_b16 v[44:45], v3 offset:5120
    ds_read_b64_tr_b16 v[46:47], v3 offset:7680
    v_mfma_f32_16x16x32_bf16 v[76:79], v[28:31], v[12:15], v[76:79]
    ds_read_b64_tr_b16 v[48:49], v3 offset:5152
    ds_read_b64_tr_b16 v[50:51], v3 offset:7712
    s_waitcnt lgkmcnt(12)
    v_mfma_f32_16x16x32_bf16 v[80:83], v[32:35], v[8:11], v[80:83]
    ds_read_b64_tr_b16 v[52:53], v4 offset:5184
    ds_read_b64_tr_b16 v[54:55], v4 offset:7744
    v_mfma_f32_16x16x32_bf16 v[84:87], v[32:35], v[12:15], v[84:87]
    ds_read_b64_tr_b16 v[56:57], v4 offset:5216
    ds_read_b64_tr_b16 v[58:59], v4 offset:7776
    s_waitcnt lgkmcnt(14)
    v_mfma_f32_16x16x32_bf16 v[88:91], v[36:39], v[8:11], v[88:91]
    ds_read_b64_tr_b16 v[60:61], v4 offset:5248
    ds_read_b64_tr_b16 v[62:63], v4 offset:7808
    v_mfma_f32_16x16x32_bf16 v[92:95], v[36:39], v[12:15], v[92:95]
    s_waitcnt lgkmcnt(14)
    v_mfma_f32_16x16x32_bf16 v[96:99], v[40:43], v[8:11], v[96:99]
    v_mfma_f32_16x16x32_bf16 v[100:103], v[40:43], v[12:15], v[100:103]
    s_waitcnt lgkmcnt(0)
    s_barrier
    v_add_u32 v2, 16384, v2
    v_add_u32 v3, 20480, v3
    v_add_u32 v4, 20480, v4
    v_mfma_f32_16x16x32_bf16 v[64:67], v[44:47], v[16:19], v[64:67]
    ds_read_b64 v[8:9], v2 offset:0
    ds_read_b64 v[10:11], v2 offset:512
    v_mfma_f32_16x16x32_bf16 v[68:71], v[44:47], v[20:23], v[68:71]
    ds_read_b64 v[12:13], v2 offset:2048
    ds_read_b64 v[14:15], v2 offset:2560
    v_mfma_f32_16x16x32_bf16 v[72:75], v[48:51], v[16:19], v[72:75]
    ds_read_b64_tr_b16 v[24:25], v3 offset:0
    ds_read_b64_tr_b16 v[26:27], v3 offset:2560
    v_mfma_f32_16x16x32_bf16 v[76:79], v[48:51], v[20:23], v[76:79]
    ds_read_b64_tr_b16 v[28:29], v3 offset:32
    ds_read_b64_tr_b16 v[30:31], v3 offset:2592
    v_mfma_f32_16x16x32_bf16 v[80:83], v[52:55], v[16:19], v[80:83]
    ds_read_b64_tr_b16 v[32:33], v4 offset:64
    ds_read_b64_tr_b16 v[34:35], v4 offset:2624
    v_mfma_f32_16x16x32_bf16 v[84:87], v[52:55], v[20:23], v[84:87]
    ds_read_b64_tr_b16 v[36:37], v4 offset:96
    ds_read_b64_tr_b16 v[38:39], v4 offset:2656
    v_mfma_f32_16x16x32_bf16 v[88:91], v[56:59], v[16:19], v[88:91]
    ds_read_b64_tr_b16 v[40:41], v4 offset:128
    ds_read_b64_tr_b16 v[42:43], v4 offset:2688
    v_mfma_f32_16x16x32_bf16 v[92:95], v[56:59], v[20:23], v[92:95]
    v_mfma_f32_16x16x32_bf16 v[96:99], v[60:63], v[16:19], v[96:99]
    v_mfma_f32_16x16x32_bf16 v[100:103], v[60:63], v[20:23], v[100:103]
    s_waitcnt lgkmcnt(8)
    v_mfma_f32_16x16x32_bf16 v[64:67], v[24:27], v[8:11], v[64:67]
    ds_read_b64 v[16:17], v2 offset:1024
    ds_read_b64 v[18:19], v2 offset:1536
    v_mfma_f32_16x16x32_bf16 v[68:71], v[24:27], v[12:15], v[68:71]
    ds_read_b64 v[20:21], v2 offset:3072
    ds_read_b64 v[22:23], v2 offset:3584
    s_waitcnt lgkmcnt(10)
    v_mfma_f32_16x16x32_bf16 v[72:75], v[28:31], v[8:11], v[72:75]
    ds_read_b64_tr_b16 v[44:45], v3 offset:5120
    ds_read_b64_tr_b16 v[46:47], v3 offset:7680
    v_mfma_f32_16x16x32_bf16 v[76:79], v[28:31], v[12:15], v[76:79]
    ds_read_b64_tr_b16 v[48:49], v3 offset:5152
    ds_read_b64_tr_b16 v[50:51], v3 offset:7712
    s_waitcnt lgkmcnt(12)
    v_mfma_f32_16x16x32_bf16 v[80:83], v[32:35], v[8:11], v[80:83]
    ds_read_b64_tr_b16 v[52:53], v4 offset:5184
    ds_read_b64_tr_b16 v[54:55], v4 offset:7744
    v_mfma_f32_16x16x32_bf16 v[84:87], v[32:35], v[12:15], v[84:87]
    ds_read_b64_tr_b16 v[56:57], v4 offset:5216
    ds_read_b64_tr_b16 v[58:59], v4 offset:7776
    s_waitcnt lgkmcnt(14)
    v_mfma_f32_16x16x32_bf16 v[88:91], v[36:39], v[8:11], v[88:91]
    ds_read_b64_tr_b16 v[60:61], v4 offset:5248
    ds_read_b64_tr_b16 v[62:63], v4 offset:7808
    v_mfma_f32_16x16x32_bf16 v[92:95], v[36:39], v[12:15], v[92:95]
    s_waitcnt lgkmcnt(14)
    v_mfma_f32_16x16x32_bf16 v[96:99], v[40:43], v[8:11], v[96:99]
    v_mfma_f32_16x16x32_bf16 v[100:103], v[40:43], v[12:15], v[100:103]
    s_waitcnt lgkmcnt(0)
    s_barrier
    v_add_u32 v2, 16384, v2
    v_add_u32 v3, 20480, v3
    v_add_u32 v4, 20480, v4
    v_mfma_f32_16x16x32_bf16 v[64:67], v[44:47], v[16:19], v[64:67]
    ds_read_b64 v[8:9], v2 offset:0
    ds_read_b64 v[10:11], v2 offset:512
    v_mfma_f32_16x16x32_bf16 v[68:71], v[44:47], v[20:23], v[68:71]
    ds_read_b64 v[12:13], v2 offset:2048
    ds_read_b64 v[14:15], v2 offset:2560
    v_mfma_f32_16x16x32_bf16 v[72:75], v[48:51], v[16:19], v[72:75]
    ds_read_b64_tr_b16 v[24:25], v3 offset:0
    ds_read_b64_tr_b16 v[26:27], v3 offset:2560
    v_mfma_f32_16x16x32_bf16 v[76:79], v[48:51], v[20:23], v[76:79]
    ds_read_b64_tr_b16 v[28:29], v3 offset:32
    ds_read_b64_tr_b16 v[30:31], v3 offset:2592
    v_mfma_f32_16x16x32_bf16 v[80:83], v[52:55], v[16:19], v[80:83]
    ds_read_b64_tr_b16 v[32:33], v4 offset:64
    ds_read_b64_tr_b16 v[34:35], v4 offset:2624
    v_mfma_f32_16x16x32_bf16 v[84:87], v[52:55], v[20:23], v[84:87]
    ds_read_b64_tr_b16 v[36:37], v4 offset:96
    ds_read_b64_tr_b16 v[38:39], v4 offset:2656
    v_mfma_f32_16x16x32_bf16 v[88:91], v[56:59], v[16:19], v[88:91]
    ds_read_b64_tr_b16 v[40:41], v4 offset:128
    ds_read_b64_tr_b16 v[42:43], v4 offset:2688
    v_mfma_f32_16x16x32_bf16 v[92:95], v[56:59], v[20:23], v[92:95]
    v_mfma_f32_16x16x32_bf16 v[96:99], v[60:63], v[16:19], v[96:99]
    v_mfma_f32_16x16x32_bf16 v[100:103], v[60:63], v[20:23], v[100:103]
    s_waitcnt lgkmcnt(8)
    v_mfma_f32_16x16x32_bf16 v[64:67], v[24:27], v[8:11], v[64:67]
    ds_read_b64 v[16:17], v2 offset:1024
    ds_read_b64 v[18:19], v2 offset:1536
    v_mfma_f32_16x16x32_bf16 v[68:71], v[24:27], v[12:15], v[68:71]
    ds_read_b64 v[20:21], v2 offset:3072
    ds_read_b64 v[22:23], v2 offset:3584
    s_waitcnt lgkmcnt(10)
    v_mfma_f32_16x16x32_bf16 v[72:75], v[28:31], v[8:11], v[72:75]
    ds_read_b64_tr_b16 v[44:45], v3 offset:5120
    ds_read_b64_tr_b16 v[46:47], v3 offset:7680
    v_mfma_f32_16x16x32_bf16 v[76:79], v[28:31], v[12:15], v[76:79]
    ds_read_b64_tr_b16 v[48:49], v3 offset:5152
    ds_read_b64_tr_b16 v[50:51], v3 offset:7712
    s_waitcnt lgkmcnt(12)
    v_mfma_f32_16x16x32_bf16 v[80:83], v[32:35], v[8:11], v[80:83]
    ds_read_b64_tr_b16 v[52:53], v4 offset:5184
    ds_read_b64_tr_b16 v[54:55], v4 offset:7744
    v_mfma_f32_16x16x32_bf16 v[84:87], v[32:35], v[12:15], v[84:87]
    ds_read_b64_tr_b16 v[56:57], v4 offset:5216
    ds_read_b64_tr_b16 v[58:59], v4 offset:7776
    s_waitcnt lgkmcnt(14)
    v_mfma_f32_16x16x32_bf16 v[88:91], v[36:39], v[8:11], v[88:91]
    ds_read_b64_tr_b16 v[60:61], v4 offset:5248
    ds_read_b64_tr_b16 v[62:63], v4 offset:7808
    v_mfma_f32_16x16x32_bf16 v[92:95], v[36:39], v[12:15], v[92:95]
    s_waitcnt lgkmcnt(14)
    v_mfma_f32_16x16x32_bf16 v[96:99], v[40:43], v[8:11], v[96:99]
    v_mfma_f32_16x16x32_bf16 v[100:103], v[40:43], v[12:15], v[100:103]
    s_waitcnt lgkmcnt(0)
    s_barrier
    v_add_u32 v2, 16384, v2
    v_add_u32 v3, 20480, v3
    v_add_u32 v4, 20480, v4
    v_mfma_f32_16x16x32_bf16 v[64:67], v[44:47], v[16:19], v[64:67]
    ds_read_b64 v[8:9], v2 offset:0
    ds_read_b64 v[10:11], v2 offset:512
    v_mfma_f32_16x16x32_bf16 v[68:71], v[44:47], v[20:23], v[68:71]
    ds_read_b64 v[12:13], v2 offset:2048
    ds_read_b64 v[14:15], v2 offset:2560
    v_mfma_f32_16x16x32_bf16 v[72:75], v[48:51], v[16:19], v[72:75]
    ds_read_b64_tr_b16 v[24:25], v3 offset:0
    ds_read_b64_tr_b16 v[26:27], v3 offset:2560
    v_mfma_f32_16x16x32_bf16 v[76:79], v[48:51], v[20:23], v[76:79]
    ds_read_b64_tr_b16 v[28:29], v3 offset:32
    ds_read_b64_tr_b16 v[30:31], v3 offset:2592
    v_mfma_f32_16x16x32_bf16 v[80:83], v[52:55], v[16:19], v[80:83]
    ds_read_b64_tr_b16 v[32:33], v4 offset:64
    ds_read_b64_tr_b16 v[34:35], v4 offset:2624
    v_mfma_f32_16x16x32_bf16 v[84:87], v[52:55], v[20:23], v[84:87]
    ds_read_b64_tr_b16 v[36:37], v4 offset:96
    ds_read_b64_tr_b16 v[38:39], v4 offset:2656
    v_mfma_f32_16x16x32_bf16 v[88:91], v[56:59], v[16:19], v[88:91]
    ds_read_b64_tr_b16 v[40:41], v4 offset:128
    ds_read_b64_tr_b16 v[42:43], v4 offset:2688
    v_mfma_f32_16x16x32_bf16 v[92:95], v[56:59], v[20:23], v[92:95]
    v_mfma_f32_16x16x32_bf16 v[96:99], v[60:63], v[16:19], v[96:99]
    v_mfma_f32_16x16x32_bf16 v[100:103], v[60:63], v[20:23], v[100:103]
    s_waitcnt lgkmcnt(8)
    v_mfma_f32_16x16x32_bf16 v[64:67], v[24:27], v[8:11], v[64:67]
    ds_read_b64 v[16:17], v2 offset:1024
    ds_read_b64 v[18:19], v2 offset:1536
    v_mfma_f32_16x16x32_bf16 v[68:71], v[24:27], v[12:15], v[68:71]
    ds_read_b64 v[20:21], v2 offset:3072
    ds_read_b64 v[22:23], v2 offset:3584
    s_waitcnt lgkmcnt(10)
    v_mfma_f32_16x16x32_bf16 v[72:75], v[28:31], v[8:11], v[72:75]
    ds_read_b64_tr_b16 v[44:45], v3 offset:5120
    ds_read_b64_tr_b16 v[46:47], v3 offset:7680
    v_mfma_f32_16x16x32_bf16 v[76:79], v[28:31], v[12:15], v[76:79]
    ds_read_b64_tr_b16 v[48:49], v3 offset:5152
    ds_read_b64_tr_b16 v[50:51], v3 offset:7712
    s_waitcnt lgkmcnt(12)
    v_mfma_f32_16x16x32_bf16 v[80:83], v[32:35], v[8:11], v[80:83]
    ds_read_b64_tr_b16 v[52:53], v4 offset:5184
    ds_read_b64_tr_b16 v[54:55], v4 offset:7744
    v_mfma_f32_16x16x32_bf16 v[84:87], v[32:35], v[12:15], v[84:87]
    ds_read_b64_tr_b16 v[56:57], v4 offset:5216
    ds_read_b64_tr_b16 v[58:59], v4 offset:7776
    s_waitcnt lgkmcnt(14)
    v_mfma_f32_16x16x32_bf16 v[88:91], v[36:39], v[8:11], v[88:91]
    ds_read_b64_tr_b16 v[60:61], v4 offset:5248
    ds_read_b64_tr_b16 v[62:63], v4 offset:7808
    v_mfma_f32_16x16x32_bf16 v[92:95], v[36:39], v[12:15], v[92:95]
    s_waitcnt lgkmcnt(14)
    v_mfma_f32_16x16x32_bf16 v[96:99], v[40:43], v[8:11], v[96:99]
    v_mfma_f32_16x16x32_bf16 v[100:103], v[40:43], v[12:15], v[100:103]
    s_waitcnt lgkmcnt(0)
    s_barrier
    v_add_u32 v2, 4294918144, v2
    v_add_u32 v3, 4294905856, v3
    v_add_u32 v4, 4294905856, v4
    v_mfma_f32_16x16x32_bf16 v[64:67], v[44:47], v[16:19], v[64:67]
    ds_read_b64 v[8:9], v2 offset:0
    ds_read_b64 v[10:11], v2 offset:512
    v_mfma_f32_16x16x32_bf16 v[68:71], v[44:47], v[20:23], v[68:71]
    ds_read_b64 v[12:13], v2 offset:2048
    ds_read_b64 v[14:15], v2 offset:2560
    v_mfma_f32_16x16x32_bf16 v[72:75], v[48:51], v[16:19], v[72:75]
    ds_read_b64_tr_b16 v[24:25], v3 offset:0
    ds_read_b64_tr_b16 v[26:27], v3 offset:2560
    v_mfma_f32_16x16x32_bf16 v[76:79], v[48:51], v[20:23], v[76:79]
    ds_read_b64_tr_b16 v[28:29], v3 offset:32
    ds_read_b64_tr_b16 v[30:31], v3 offset:2592
    v_mfma_f32_16x16x32_bf16 v[80:83], v[52:55], v[16:19], v[80:83]
    ds_read_b64_tr_b16 v[32:33], v4 offset:64
    ds_read_b64_tr_b16 v[34:35], v4 offset:2624
    v_mfma_f32_16x16x32_bf16 v[84:87], v[52:55], v[20:23], v[84:87]
    ds_read_b64_tr_b16 v[36:37], v4 offset:96
    ds_read_b64_tr_b16 v[38:39], v4 offset:2656
    v_mfma_f32_16x16x32_bf16 v[88:91], v[56:59], v[16:19], v[88:91]
    ds_read_b64_tr_b16 v[40:41], v4 offset:128
    ds_read_b64_tr_b16 v[42:43], v4 offset:2688
    v_mfma_f32_16x16x32_bf16 v[92:95], v[56:59], v[20:23], v[92:95]
    v_mfma_f32_16x16x32_bf16 v[96:99], v[60:63], v[16:19], v[96:99]
    v_mfma_f32_16x16x32_bf16 v[100:103], v[60:63], v[20:23], v[100:103]
    s_waitcnt lgkmcnt(8)
    v_mfma_f32_16x16x32_bf16 v[64:67], v[24:27], v[8:11], v[64:67]
    ds_read_b64 v[16:17], v2 offset:1024
    ds_read_b64 v[18:19], v2 offset:1536
    v_mfma_f32_16x16x32_bf16 v[68:71], v[24:27], v[12:15], v[68:71]
    ds_read_b64 v[20:21], v2 offset:3072
    ds_read_b64 v[22:23], v2 offset:3584
    s_waitcnt lgkmcnt(10)
    v_mfma_f32_16x16x32_bf16 v[72:75], v[28:31], v[8:11], v[72:75]
    ds_read_b64_tr_b16 v[44:45], v3 offset:5120
    ds_read_b64_tr_b16 v[46:47], v3 offset:7680
    v_mfma_f32_16x16x32_bf16 v[76:79], v[28:31], v[12:15], v[76:79]
    ds_read_b64_tr_b16 v[48:49], v3 offset:5152
    ds_read_b64_tr_b16 v[50:51], v3 offset:7712
    s_waitcnt lgkmcnt(12)
    v_mfma_f32_16x16x32_bf16 v[80:83], v[32:35], v[8:11], v[80:83]
    ds_read_b64_tr_b16 v[52:53], v4 offset:5184
    ds_read_b64_tr_b16 v[54:55], v4 offset:7744
    v_mfma_f32_16x16x32_bf16 v[84:87], v[32:35], v[12:15], v[84:87]
    ds_read_b64_tr_b16 v[56:57], v4 offset:5216
    ds_read_b64_tr_b16 v[58:59], v4 offset:7776
    s_waitcnt lgkmcnt(14)
    v_mfma_f32_16x16x32_bf16 v[88:91], v[36:39], v[8:11], v[88:91]
    ds_read_b64_tr_b16 v[60:61], v4 offset:5248
    ds_read_b64_tr_b16 v[62:63], v4 offset:7808
    v_mfma_f32_16x16x32_bf16 v[92:95], v[36:39], v[12:15], v[92:95]
    s_waitcnt lgkmcnt(14)
    v_mfma_f32_16x16x32_bf16 v[96:99], v[40:43], v[8:11], v[96:99]
    v_mfma_f32_16x16x32_bf16 v[100:103], v[40:43], v[12:15], v[100:103]
    s_waitcnt lgkmcnt(0)
    v_add_u32 v2, 16384, v2
    v_add_u32 v3, 20480, v3
    v_add_u32 v4, 20480, v4
    v_mfma_f32_16x16x32_bf16 v[64:67], v[44:47], v[16:19], v[64:67]
    ds_read_b64 v[8:9], v2 offset:0
    ds_read_b64 v[10:11], v2 offset:512
    v_mfma_f32_16x16x32_bf16 v[68:71], v[44:47], v[20:23], v[68:71]
    ds_read_b64 v[12:13], v2 offset:2048
    ds_read_b64 v[14:15], v2 offset:2560
    v_mfma_f32_16x16x32_bf16 v[72:75], v[48:51], v[16:19], v[72:75]
    ds_read_b64_tr_b16 v[24:25], v3 offset:0
    ds_read_b64_tr_b16 v[26:27], v3 offset:2560
    v_mfma_f32_16x16x32_bf16 v[76:79], v[48:51], v[20:23], v[76:79]
    ds_read_b64_tr_b16 v[28:29], v3 offset:32
    ds_read_b64_tr_b16 v[30:31], v3 offset:2592
    v_mfma_f32_16x16x32_bf16 v[80:83], v[52:55], v[16:19], v[80:83]
    ds_read_b64_tr_b16 v[32:33], v4 offset:64
    ds_read_b64_tr_b16 v[34:35], v4 offset:2624
    v_mfma_f32_16x16x32_bf16 v[84:87], v[52:55], v[20:23], v[84:87]
    ds_read_b64_tr_b16 v[36:37], v4 offset:96
    ds_read_b64_tr_b16 v[38:39], v4 offset:2656
    v_mfma_f32_16x16x32_bf16 v[88:91], v[56:59], v[16:19], v[88:91]
    ds_read_b64_tr_b16 v[40:41], v4 offset:128
    ds_read_b64_tr_b16 v[42:43], v4 offset:2688
    v_mfma_f32_16x16x32_bf16 v[92:95], v[56:59], v[20:23], v[92:95]
    v_mfma_f32_16x16x32_bf16 v[96:99], v[60:63], v[16:19], v[96:99]
    v_mfma_f32_16x16x32_bf16 v[100:103], v[60:63], v[20:23], v[100:103]
    s_cmp_eq_u32 s53, 0
    s_cbranch_scc1 m2_kernel_wo_skipw
    ds_write_b128 v119, v[80:83] offset:0
    ds_write_b128 v119, v[84:87] offset:1024
m2_kernel_wo_skipw:
    ds_write_b128 v119, v[88:91] offset:2048
    s_nop 0
    ds_write_b128 v119, v[92:95] offset:3072
    ds_write_b128 v119, v[96:99] offset:4096
    ds_write_b128 v119, v[100:103] offset:5120
    s_waitcnt lgkmcnt(0)
    s_barrier
    ds_read_b128 v[8:11], v120 offset:0
    ds_read_b128 v[12:15], v120 offset:1024
    ds_read_b128 v[16:19], v120 offset:2048
    ds_read_b128 v[20:23], v120 offset:3072
    ds_read_b128 v[24:27], v120 offset:4096
    ds_read_b128 v[28:31], v120 offset:5120
    s_waitcnt vmcnt(0) lgkmcnt(0)
    v_mov_b32 v32, 0
    v_mov_b32 v33, 0
    v_mov_b32 v34, 0
    v_mov_b32 v35, 0
    v_mov_b32 v36, 0
    v_mov_b32 v37, 0
    v_mov_b32 v38, 0
    v_mov_b32 v39, 0
    v_pk_add_f32 v[64:65], v[64:65], v[8:9]
    v_pk_add_f32 v[66:67], v[66:67], v[10:11]
    v_lshlrev_b32 v8, 16, v104
    v_and_b32 v9, 0xffff0000, v104
    v_lshlrev_b32 v10, 16, v105
    v_and_b32 v11, 0xffff0000, v105
    v_pk_add_f32 v[64:65], v[64:65], v[8:9]
    v_pk_add_f32 v[66:67], v[66:67], v[10:11]
    v_cvt_pk_bf16_f32 v64, v64, v65
    v_cvt_pk_bf16_f32 v65, v66, v67
    s_add_u32 s34, s64, 0
    buffer_store_dwordx2 v[64:65], v116, s[44:47], s34 offen sc1
    v_lshlrev_b32 v8, 16, v64
    v_and_b32 v9, 0xffff0000, v64
    v_lshlrev_b32 v10, 16, v65
    v_and_b32 v11, 0xffff0000, v65
    v_pk_add_f32 v[32:33], v[32:33], v[8:9]
    v_pk_fma_f32 v[36:37], v[8:9], v[8:9], v[36:37]
    v_pk_add_f32 v[32:33], v[32:33], v[10:11]
    v_pk_fma_f32 v[36:37], v[10:11], v[10:11], v[36:37]
    v_pk_add_f32 v[68:69], v[68:69], v[12:13]
    v_pk_add_f32 v[70:71], v[70:71], v[14:15]
    v_lshlrev_b32 v12, 16, v106
    v_and_b32 v13, 0xffff0000, v106
    v_lshlrev_b32 v14, 16, v107
    v_and_b32 v15, 0xffff0000, v107
    v_pk_add_f32 v[68:69], v[68:69], v[12:13]
    v_pk_add_f32 v[70:71], v[70:71], v[14:15]
    v_cvt_pk_bf16_f32 v68, v68, v69
    v_cvt_pk_bf16_f32 v69, v70, v71
    s_add_u32 s34, s64, 20480
    buffer_store_dwordx2 v[68:69], v116, s[44:47], s34 offen sc1
    v_lshlrev_b32 v12, 16, v68
    v_and_b32 v13, 0xffff0000, v68
    v_lshlrev_b32 v14, 16, v69
    v_and_b32 v15, 0xffff0000, v69
    v_pk_add_f32 v[34:35], v[34:35], v[12:13]
    v_pk_fma_f32 v[38:39], v[12:13], v[12:13], v[38:39]
    v_pk_add_f32 v[34:35], v[34:35], v[14:15]
    v_pk_fma_f32 v[38:39], v[14:15], v[14:15], v[38:39]
    v_pk_add_f32 v[72:73], v[72:73], v[16:17]
    v_pk_add_f32 v[74:75], v[74:75], v[18:19]
    v_lshlrev_b32 v16, 16, v108
    v_and_b32 v17, 0xffff0000, v108
    v_lshlrev_b32 v18, 16, v109
    v_and_b32 v19, 0xffff0000, v109
    v_pk_add_f32 v[72:73], v[72:73], v[16:17]
    v_pk_add_f32 v[74:75], v[74:75], v[18:19]
    v_cvt_pk_bf16_f32 v72, v72, v73
    v_cvt_pk_bf16_f32 v73, v74, v75
    s_add_u32 s34, s65, 0
    buffer_store_dwordx2 v[72:73], v116, s[44:47], s34 offen sc1
    v_lshlrev_b32 v16, 16, v72
    v_and_b32 v17, 0xffff0000, v72
    v_lshlrev_b32 v18, 16, v73
    v_and_b32 v19, 0xffff0000, v73
    v_pk_add_f32 v[32:33], v[32:33], v[16:17]
    v_pk_fma_f32 v[36:37], v[16:17], v[16:17], v[36:37]
    v_pk_add_f32 v[32:33], v[32:33], v[18:19]
    v_pk_fma_f32 v[36:37], v[18:19], v[18:19], v[36:37]
    v_pk_add_f32 v[76:77], v[76:77], v[20:21]
    v_pk_add_f32 v[78:79], v[78:79], v[22:23]
    v_lshlrev_b32 v20, 16, v110
    v_and_b32 v21, 0xffff0000, v110
    v_lshlrev_b32 v22, 16, v111
    v_and_b32 v23, 0xffff0000, v111
    v_pk_add_f32 v[76:77], v[76:77], v[20:21]
    v_pk_add_f32 v[78:79], v[78:79], v[22:23]
    v_cvt_pk_bf16_f32 v76, v76, v77
    v_cvt_pk_bf16_f32 v77, v78, v79
    s_add_u32 s34, s65, 20480
    buffer_store_dwordx2 v[76:77], v116, s[44:47], s34 offen sc1
    v_lshlrev_b32 v20, 16, v76
    v_and_b32 v21, 0xffff0000, v76
    v_lshlrev_b32 v22, 16, v77
    v_and_b32 v23, 0xffff0000, v77
    v_pk_add_f32 v[34:35], v[34:35], v[20:21]
    v_pk_fma_f32 v[38:39], v[20:21], v[20:21], v[38:39]
    v_pk_add_f32 v[34:35], v[34:35], v[22:23]
    v_pk_fma_f32 v[38:39], v[22:23], v[22:23], v[38:39]
    s_cmp_lg_u32 s53, 0
    s_cbranch_scc1 m2_kernel_wo_skip2
    v_pk_add_f32 v[80:81], v[80:81], v[24:25]
    v_pk_add_f32 v[82:83], v[82:83], v[26:27]
    v_lshlrev_b32 v24, 16, v112
    v_and_b32 v25, 0xffff0000, v112
    v_lshlrev_b32 v26, 16, v113
    v_and_b32 v27, 0xffff0000, v113
    v_pk_add_f32 v[80:81], v[80:81], v[24:25]
    v_pk_add_f32 v[82:83], v[82:83], v[26:27]
    v_cvt_pk_bf16_f32 v80, v80, v81
    v_cvt_pk_bf16_f32 v81, v82, v83
    s_add_u32 s34, s66, 0
    buffer_store_dwordx2 v[80:81], v116, s[44:47], s34 offen sc1
    v_lshlrev_b32 v24, 16, v80
    v_and_b32 v25, 0xffff0000, v80
    v_lshlrev_b32 v26, 16, v81
    v_and_b32 v27, 0xffff0000, v81
    v_pk_add_f32 v[32:33], v[32:33], v[24:25]
    v_pk_fma_f32 v[36:37], v[24:25], v[24:25], v[36:37]
    v_pk_add_f32 v[32:33], v[32:33], v[26:27]
    v_pk_fma_f32 v[36:37], v[26:27], v[26:27], v[36:37]
    v_pk_add_f32 v[84:85], v[84:85], v[28:29]
    v_pk_add_f32 v[86:87], v[86:87], v[30:31]
    v_lshlrev_b32 v28, 16, v114
    v_and_b32 v29, 0xffff0000, v114
    v_lshlrev_b32 v30, 16, v115
    v_and_b32 v31, 0xffff0000, v115
    v_pk_add_f32 v[84:85], v[84:85], v[28:29]
    v_pk_add_f32 v[86:87], v[86:87], v[30:31]
    v_cvt_pk_bf16_f32 v84, v84, v85
    v_cvt_pk_bf16_f32 v85, v86, v87
    s_add_u32 s34, s66, 20480
    buffer_store_dwordx2 v[84:85], v116, s[44:47], s34 offen sc1
    v_lshlrev_b32 v28, 16, v84
    v_and_b32 v29, 0xffff0000, v84
    v_lshlrev_b32 v30, 16, v85
    v_and_b32 v31, 0xffff0000, v85
    v_pk_add_f32 v[34:35], v[34:35], v[28:29]
    v_pk_fma_f32 v[38:39], v[28:29], v[28:29], v[38:39]
    v_pk_add_f32 v[34:35], v[34:35], v[30:31]
    v_pk_fma_f32 v[38:39], v[30:31], v[30:31], v[38:39]
m2_kernel_wo_skip2:
    v_add_f32 v40, v32, v33
    v_add_f32 v41, v36, v37
    v_add_f32 v42, v34, v35
    v_add_f32 v43, v38, v39
    v_mov_b32 v44, v40
    v_mov_b32 v45, v41
    v_mov_b32 v46, v42
    v_mov_b32 v47, v43
    v_permlane16_swap_b32 v44, v40
    v_permlane16_swap_b32 v45, v41
    v_permlane16_swap_b32 v46, v42
    v_permlane16_swap_b32 v47, v43
    v_add_f32 v40, v40, v44
    v_add_f32 v41, v41, v45
    v_add_f32 v42, v42, v46
    v_add_f32 v43, v43, v47
    v_mov_b32 v44, v40
    v_mov_b32 v45, v41
    v_mov_b32 v46, v42
    v_mov_b32 v47, v43
    v_permlane32_swap_b32 v44, v40
    v_permlane32_swap_b32 v45, v41
    v_permlane32_swap_b32 v46, v42
    v_permlane32_swap_b32 v47, v43
    v_add_f32 v40, v40, v44
    v_add_f32 v41, v41, v45
    v_add_f32 v42, v42, v46
    v_add_f32 v43, v43, v47
    v_cmp_gt_u32 vcc, 16, v1
    s_nop 3
    s_and_saveexec_b64 s[34:35], vcc
    buffer_store_dwordx2 v[40:41], v118, s[48:51], 0 offen sc1
    buffer_store_dwordx2 v[42:43], v118, s[48:51], 0 offen offset:2048 sc1
    s_mov_b64 exec, s[34:35]
    s_waitcnt vmcnt(0)
    s_lshr_b32 s52, s22, 1
    s_and_b32 s53, s22, 1
    v_lshlrev_b32 v2, 3, v1
    v_mov_b32 v186, v2
    s_lshl_b32 s34, s52, 13
    v_add_u32 v2, s34, v2
    v_lshrrev_b32 v188, 4, v1
    v_bfe_u32 v189, v1, 2, 2
    v_and_b32 v190, 3, v1
    v_lshl_add_u32 v191, v188, 2, v189
    v_mul_u32_u24 v3, 96, v191
    v_lshl_add_u32 v3, v190, 3, v3
    s_mul_i32 s34, s53, 6144
    s_add_u32 s34, s34, 65536
    v_add_u32 v3, s34, v3
    s_barrier
    v_and_b32 v192, 15, v1
    s_lshl_b32 s34, s52, 6
    v_add_u32 v192, s34, v192
    v_lshlrev_b32 v184, 2, v192
    s_mul_i32 s34, s53, 192
    v_lshlrev_b32 v185, 4, v188
    v_add_u32 v185, s34, v185
    s_lshl_b32 s57, s26, 1
    s_and_b32 s34, s24, 1
    s_add_u32 s57, s57, s34
    s_lshr_b32 s58, s24, 1
    s_lshl_b32 s58, s58, 2
    s_add_u32 s58, s58, s25
    s_lshl_b32 s36, s57, 3
    s_lshl_b32 s37, s52, 2
    s_add_u32 s36, s36, s37
    s_mul_i32 s36, s36, 49152
    s_mul_i32 s37, s58, 6
    s_mul_i32 s35, s53, 3
    s_add_u32 s37, s37, s35
    s_lshl_b32 s37, s37, 9
    s_add_u32 s60, s36, s37
    s_mov_b32 s54, 0
    s_mov_b32 s68, 16384
    s_mov_b32 s69, 4294918144
    s_mov_b32 s70, 24576
    s_mov_b32 s71, 4294893568
    s_add_u32 s40, s20, 13107200
    s_addc_u32 s41, s21, 0
    s_mov_b32 s42, 6291456
    s_mov_b32 s43, 0x00020000
    v_mov_b32 v88, 0
    v_mov_b32 v89, 0
    v_mov_b32 v90, 0
    v_mov_b32 v91, 0
    v_mov_b32 v92, 0
    v_mov_b32 v93, 0
    v_mov_b32 v94, 0
    v_mov_b32 v95, 0
    v_mov_b32 v96, 0
    v_mov_b32 v97, 0
    v_mov_b32 v98, 0
    v_mov_b32 v99, 0
    v_mov_b32 v100, 0
    v_mov_b32 v101, 0
    v_mov_b32 v102, 0
    v_mov_b32 v103, 0
    v_mov_b32 v104, 0
    v_mov_b32 v105, 0
    v_mov_b32 v106, 0
    v_mov_b32 v107, 0
    v_mov_b32 v108, 0
    v_mov_b32 v109, 0
    v_mov_b32 v110, 0
    v_mov_b32 v111, 0
    v_mov_b32 v112, 0
    v_mov_b32 v113, 0
    v_mov_b32 v114, 0
    v_mov_b32 v115, 0
    v_mov_b32 v116, 0
    v_mov_b32 v117, 0
    v_mov_b32 v118, 0
    v_mov_b32 v119, 0
    v_mov_b32 v120, 0
    v_mov_b32 v121, 0
    v_mov_b32 v122, 0
    v_mov_b32 v123, 0
    v_mov_b32 v124, 0
    v_mov_b32 v125, 0
    v_mov_b32 v126, 0
    v_mov_b32 v127, 0
    v_mov_b32 v128, 0
    v_mov_b32 v129, 0
    v_mov_b32 v130, 0
    v_mov_b32 v131, 0
    v_mov_b32 v132, 0
    v_mov_b32 v133, 0
    v_mov_b32 v134, 0
    v_mov_b32 v135, 0
    v_mov_b32 v136, 0
    v_mov_b32 v137, 0
    v_mov_b32 v138, 0
    v_mov_b32 v139, 0
    v_mov_b32 v140, 0
    v_mov_b32 v141, 0
    v_mov_b32 v142, 0
    v_mov_b32 v143, 0
    v_mov_b32 v144, 0
    v_mov_b32 v145, 0
    v_mov_b32 v146, 0
    v_mov_b32 v147, 0
    v_mov_b32 v148, 0
    v_mov_b32 v149, 0
    v_mov_b32 v150, 0
    v_mov_b32 v151, 0
    v_mov_b32 v152, 0
    v_mov_b32 v153, 0
    v_mov_b32 v154, 0
    v_mov_b32 v155, 0
    v_mov_b32 v156, 0
    v_mov_b32 v157, 0
    v_mov_b32 v158, 0
    v_mov_b32 v159, 0
    v_mov_b32 v160, 0
    v_mov_b32 v161, 0
    v_mov_b32 v162, 0
    v_mov_b32 v163, 0
    v_mov_b32 v164, 0
    v_mov_b32 v165, 0
    v_mov_b32 v166, 0
    v_mov_b32 v167, 0
    v_mov_b32 v168, 0
    v_mov_b32 v169, 0
    v_mov_b32 v170, 0
    v_mov_b32 v171, 0
    v_mov_b32 v172, 0
    v_mov_b32 v173, 0
    v_mov_b32 v174, 0
    v_mov_b32 v175, 0
    v_mov_b32 v176, 0
    v_mov_b32 v177, 0
    v_mov_b32 v178, 0
    v_mov_b32 v179, 0
    v_mov_b32 v180, 0
    v_mov_b32 v181, 0
    v_mov_b32 v182, 0
    v_mov_b32 v183, 0
    s_barrier
    s_barrier
    ds_read_b64 v[8:9], v2 offset:0
    ds_read_b64 v[10:11], v2 offset:512
    ds_read_b64 v[12:13], v2 offset:2048
    ds_read_b64 v[14:15], v2 offset:2560
    ds_read_b64 v[16:17], v2 offset:4096
    ds_read_b64 v[18:19], v2 offset:4608
    ds_read_b64 v[20:21], v2 offset:6144
    ds_read_b64 v[22:23], v2 offset:6656
    ds_read_b64_tr_b16 v[40:41], v3 offset:0
    ds_read_b64_tr_b16 v[42:43], v3 offset:1536
    ds_read_b64_tr_b16 v[44:45], v3 offset:32
    ds_read_b64_tr_b16 v[46:47], v3 offset:1568
    ds_read_b64_tr_b16 v[48:49], v3 offset:64
    ds_read_b64_tr_b16 v[50:51], v3 offset:1600
    ds_read_b64_tr_b16 v[52:53], v3 offset:12288
    ds_read_b64_tr_b16 v[54:55], v3 offset:13824
    ds_read_b64_tr_b16 v[56:57], v3 offset:12320
    ds_read_b64_tr_b16 v[58:59], v3 offset:13856
    ds_read_b64_tr_b16 v[60:61], v3 offset:12352
    ds_read_b64_tr_b16 v[62:63], v3 offset:13888
m2_kernel_p4_loop:
    s_waitcnt lgkmcnt(15)
    v_mfma_f32_16x16x32_bf16 v[88:91], v[40:43], v[8:11], v[88:91]
    ds_read_b64_tr_b16 v[64:65], v3 offset:3072
    s_waitcnt lgkmcnt(15)
    v_mfma_f32_16x16x32_bf16 v[92:95], v[40:43], v[12:15], v[92:95]
    ds_read_b64_tr_b16 v[66:67], v3 offset:4608
    s_waitcnt lgkmcnt(14)
    v_mfma_f32_16x16x32_bf16 v[96:99], v[40:43], v[16:19], v[96:99]
    ds_read_b64 v[24:25], v2 offset:1024
    s_waitcnt lgkmcnt(13)
    v_mfma_f32_16x16x32_bf16 v[100:103], v[40:43], v[20:23], v[100:103]
    ds_read_b64 v[26:27], v2 offset:1536
    s_waitcnt lgkmcnt(12)
    v_mfma_f32_16x16x32_bf16 v[104:107], v[44:47], v[8:11], v[104:107]
    ds_read_b64 v[28:29], v2 offset:3072
    v_mfma_f32_16x16x32_bf16 v[108:111], v[44:47], v[12:15], v[108:111]
    ds_read_b64 v[30:31], v2 offset:3584
    v_mfma_f32_16x16x32_bf16 v[112:115], v[44:47], v[16:19], v[112:115]
    ds_read_b64 v[32:33], v2 offset:5120
    v_mfma_f32_16x16x32_bf16 v[116:119], v[44:47], v[20:23], v[116:119]
    ds_read_b64 v[34:35], v2 offset:5632
    s_waitcnt lgkmcnt(14)
    v_mfma_f32_16x16x32_bf16 v[120:123], v[48:51], v[8:11], v[120:123]
    ds_read_b64 v[36:37], v2 offset:7168
    v_mfma_f32_16x16x32_bf16 v[124:127], v[48:51], v[12:15], v[124:127]
    ds_read_b64 v[38:39], v2 offset:7680
    v_mfma_f32_16x16x32_bf16 v[128:131], v[48:51], v[16:19], v[128:131]
    ds_read_b64_tr_b16 v[68:69], v3 offset:3104
    v_mfma_f32_16x16x32_bf16 v[132:135], v[48:51], v[20:23], v[132:135]
    ds_read_b64_tr_b16 v[70:71], v3 offset:4640
    s_waitcnt lgkmcnt(15)
    v_mfma_f32_16x16x32_bf16 v[136:139], v[52:55], v[8:11], v[136:139]
    ds_read_b64_tr_b16 v[72:73], v3 offset:3136
    v_mfma_f32_16x16x32_bf16 v[140:143], v[52:55], v[12:15], v[140:143]
    ds_read_b64_tr_b16 v[74:75], v3 offset:4672
    v_mfma_f32_16x16x32_bf16 v[144:147], v[52:55], v[16:19], v[144:147]
    ds_read_b64_tr_b16 v[76:77], v3 offset:15360
    v_mfma_f32_16x16x32_bf16 v[148:151], v[52:55], v[20:23], v[148:151]
    ds_read_b64_tr_b16 v[78:79], v3 offset:16896
    s_waitcnt lgkmcnt(15)
    v_mfma_f32_16x16x32_bf16 v[152:155], v[56:59], v[8:11], v[152:155]
    ds_read_b64_tr_b16 v[80:81], v3 offset:15392
    v_mfma_f32_16x16x32_bf16 v[156:159], v[56:59], v[12:15], v[156:159]
    ds_read_b64_tr_b16 v[82:83], v3 offset:16928
    v_mfma_f32_16x16x32_bf16 v[160:163], v[56:59], v[16:19], v[160:163]
    ds_read_b64_tr_b16 v[84:85], v3 offset:15424
    v_mfma_f32_16x16x32_bf16 v[164:167], v[56:59], v[20:23], v[164:167]
    ds_read_b64_tr_b16 v[86:87], v3 offset:16960
    s_waitcnt lgkmcnt(15)
    v_mfma_f32_16x16x32_bf16 v[168:171], v[60:63], v[8:11], v[168:171]
    v_mfma_f32_16x16x32_bf16 v[172:175], v[60:63], v[12:15], v[172:175]
    v_mfma_f32_16x16x32_bf16 v[176:179], v[60:63], v[16:19], v[176:179]
    v_mfma_f32_16x16x32_bf16 v[180:183], v[60:63], v[20:23], v[180:183]
    s_waitcnt lgkmcnt(0)
    s_barrier
    v_add_u32 v2, 16384, v2
    v_add_u32 v3, 24576, v3
    v_mfma_f32_16x16x32_bf16 v[88:91], v[64:67], v[24:27], v[88:91]
    ds_read_b64_tr_b16 v[40:41], v3 offset:0
    v_mfma_f32_16x16x32_bf16 v[92:95], v[64:67], v[28:31], v[92:95]
    ds_read_b64_tr_b16 v[42:43], v3 offset:1536
    v_mfma_f32_16x16x32_bf16 v[96:99], v[64:67], v[32:35], v[96:99]
    ds_read_b64 v[8:9], v2 offset:0
    v_mfma_f32_16x16x32_bf16 v[100:103], v[64:67], v[36:39], v[100:103]
    ds_read_b64 v[10:11], v2 offset:512
    v_mfma_f32_16x16x32_bf16 v[104:107], v[68:71], v[24:27], v[104:107]
    ds_read_b64 v[12:13], v2 offset:2048
    v_mfma_f32_16x16x32_bf16 v[108:111], v[68:71], v[28:31], v[108:111]
    ds_read_b64 v[14:15], v2 offset:2560
    v_mfma_f32_16x16x32_bf16 v[112:115], v[68:71], v[32:35], v[112:115]
    ds_read_b64 v[16:17], v2 offset:4096
    v_mfma_f32_16x16x32_bf16 v[116:119], v[68:71], v[36:39], v[116:119]
    ds_read_b64 v[18:19], v2 offset:4608
    v_mfma_f32_16x16x32_bf16 v[120:123], v[72:75], v[24:27], v[120:123]
    ds_read_b64 v[20:21], v2 offset:6144
    v_mfma_f32_16x16x32_bf16 v[124:127], v[72:75], v[28:31], v[124:127]
    ds_read_b64 v[22:23], v2 offset:6656
    v_mfma_f32_16x16x32_bf16 v[128:131], v[72:75], v[32:35], v[128:131]
    ds_read_b64_tr_b16 v[44:45], v3 offset:32
    v_mfma_f32_16x16x32_bf16 v[132:135], v[72:75], v[36:39], v[132:135]
    ds_read_b64_tr_b16 v[46:47], v3 offset:1568
    v_mfma_f32_16x16x32_bf16 v[136:139], v[76:79], v[24:27], v[136:139]
    ds_read_b64_tr_b16 v[48:49], v3 offset:64
    v_mfma_f32_16x16x32_bf16 v[140:143], v[76:79], v[28:31], v[140:143]
    ds_read_b64_tr_b16 v[50:51], v3 offset:1600
    v_mfma_f32_16x16x32_bf16 v[144:147], v[76:79], v[32:35], v[144:147]
    ds_read_b64_tr_b16 v[52:53], v3 offset:12288
    v_mfma_f32_16x16x32_bf16 v[148:151], v[76:79], v[36:39], v[148:151]
    ds_read_b64_tr_b16 v[54:55], v3 offset:13824
    v_mfma_f32_16x16x32_bf16 v[152:155], v[80:83], v[24:27], v[152:155]
    ds_read_b64_tr_b16 v[56:57], v3 offset:12320
    v_mfma_f32_16x16x32_bf16 v[156:159], v[80:83], v[28:31], v[156:159]
    ds_read_b64_tr_b16 v[58:59], v3 offset:13856
    v_mfma_f32_16x16x32_bf16 v[160:163], v[80:83], v[32:35], v[160:163]
    ds_read_b64_tr_b16 v[60:61], v3 offset:12352
    v_mfma_f32_16x16x32_bf16 v[164:167], v[80:83], v[36:39], v[164:167]
    ds_read_b64_tr_b16 v[62:63], v3 offset:13888
    v_mfma_f32_16x16x32_bf16 v[168:171], v[84:87], v[24:27], v[168:171]
    v_mfma_f32_16x16x32_bf16 v[172:175], v[84:87], v[28:31], v[172:175]
    v_mfma_f32_16x16x32_bf16 v[176:179], v[84:87], v[32:35], v[176:179]
    v_mfma_f32_16x16x32_bf16 v[180:183], v[84:87], v[36:39], v[180:183]
    s_waitcnt lgkmcnt(15)
    v_mfma_f32_16x16x32_bf16 v[88:91], v[40:43], v[8:11], v[88:91]
    ds_read_b64_tr_b16 v[64:65], v3 offset:3072
    s_waitcnt lgkmcnt(15)
    v_mfma_f32_16x16x32_bf16 v[92:95], v[40:43], v[12:15], v[92:95]
    ds_read_b64_tr_b16 v[66:67], v3 offset:4608
    s_waitcnt lgkmcnt(14)
    v_mfma_f32_16x16x32_bf16 v[96:99], v[40:43], v[16:19], v[96:99]
    ds_read_b64 v[24:25], v2 offset:1024
    s_waitcnt lgkmcnt(13)
    v_mfma_f32_16x16x32_bf16 v[100:103], v[40:43], v[20:23], v[100:103]
    ds_read_b64 v[26:27], v2 offset:1536
    s_waitcnt lgkmcnt(12)
    v_mfma_f32_16x16x32_bf16 v[104:107], v[44:47], v[8:11], v[104:107]
    ds_read_b64 v[28:29], v2 offset:3072
    v_mfma_f32_16x16x32_bf16 v[108:111], v[44:47], v[12:15], v[108:111]
    ds_read_b64 v[30:31], v2 offset:3584
    v_mfma_f32_16x16x32_bf16 v[112:115], v[44:47], v[16:19], v[112:115]
    ds_read_b64 v[32:33], v2 offset:5120
    v_mfma_f32_16x16x32_bf16 v[116:119], v[44:47], v[20:23], v[116:119]
    ds_read_b64 v[34:35], v2 offset:5632
    s_waitcnt lgkmcnt(14)
    v_mfma_f32_16x16x32_bf16 v[120:123], v[48:51], v[8:11], v[120:123]
    ds_read_b64 v[36:37], v2 offset:7168
    v_mfma_f32_16x16x32_bf16 v[124:127], v[48:51], v[12:15], v[124:127]
    ds_read_b64 v[38:39], v2 offset:7680
    v_mfma_f32_16x16x32_bf16 v[128:131], v[48:51], v[16:19], v[128:131]
    ds_read_b64_tr_b16 v[68:69], v3 offset:3104
    v_mfma_f32_16x16x32_bf16 v[132:135], v[48:51], v[20:23], v[132:135]
    ds_read_b64_tr_b16 v[70:71], v3 offset:4640
    s_waitcnt lgkmcnt(15)
    v_mfma_f32_16x16x32_bf16 v[136:139], v[52:55], v[8:11], v[136:139]
    ds_read_b64_tr_b16 v[72:73], v3 offset:3136
    v_mfma_f32_16x16x32_bf16 v[140:143], v[52:55], v[12:15], v[140:143]
    ds_read_b64_tr_b16 v[74:75], v3 offset:4672
    v_mfma_f32_16x16x32_bf16 v[144:147], v[52:55], v[16:19], v[144:147]
    ds_read_b64_tr_b16 v[76:77], v3 offset:15360
    v_mfma_f32_16x16x32_bf16 v[148:151], v[52:55], v[20:23], v[148:151]
    ds_read_b64_tr_b16 v[78:79], v3 offset:16896
    s_waitcnt lgkmcnt(15)
    v_mfma_f32_16x16x32_bf16 v[152:155], v[56:59], v[8:11], v[152:155]
    ds_read_b64_tr_b16 v[80:81], v3 offset:15392
    v_mfma_f32_16x16x32_bf16 v[156:159], v[56:59], v[12:15], v[156:159]
    ds_read_b64_tr_b16 v[82:83], v3 offset:16928
    v_mfma_f32_16x16x32_bf16 v[160:163], v[56:59], v[16:19], v[160:163]
    ds_read_b64_tr_b16 v[84:85], v3 offset:15424
    v_mfma_f32_16x16x32_bf16 v[164:167], v[56:59], v[20:23], v[164:167]
    ds_read_b64_tr_b16 v[86:87], v3 offset:16960
    s_waitcnt lgkmcnt(15)
    v_mfma_f32_16x16x32_bf16 v[168:171], v[60:63], v[8:11], v[168:171]
    v_mfma_f32_16x16x32_bf16 v[172:175], v[60:63], v[12:15], v[172:175]
    v_mfma_f32_16x16x32_bf16 v[176:179], v[60:63], v[16:19], v[176:179]
    v_mfma_f32_16x16x32_bf16 v[180:183], v[60:63], v[20:23], v[180:183]
    s_waitcnt lgkmcnt(0)
    s_barrier
    s_bitcmp1_b32 s54, 0
    s_cselect_b32 s55, s69, s68
    s_cselect_b32 s56, s71, s70
    v_add_u32 v2, s55, v2
    v_add_u32 v3, s56, v3
    v_mfma_f32_16x16x32_bf16 v[88:91], v[64:67], v[24:27], v[88:91]
    ds_read_b64_tr_b16 v[40:41], v3 offset:0
    v_mfma_f32_16x16x32_bf16 v[92:95], v[64:67], v[28:31], v[92:95]
    ds_read_b64_tr_b16 v[42:43], v3 offset:1536
    v_mfma_f32_16x16x32_bf16 v[96:99], v[64:67], v[32:35], v[96:99]
    ds_read_b64 v[8:9], v2 offset:0
    v_mfma_f32_16x16x32_bf16 v[100:103], v[64:67], v[36:39], v[100:103]
    ds_read_b64 v[10:11], v2 offset:512
    v_mfma_f32_16x16x32_bf16 v[104:107], v[68:71], v[24:27], v[104:107]
    ds_read_b64 v[12:13], v2 offset:2048
    v_mfma_f32_16x16x32_bf16 v[108:111], v[68:71], v[28:31], v[108:111]
    ds_read_b64 v[14:15], v2 offset:2560
    v_mfma_f32_16x16x32_bf16 v[112:115], v[68:71], v[32:35], v[112:115]
    ds_read_b64 v[16:17], v2 offset:4096
    v_mfma_f32_16x16x32_bf16 v[116:119], v[68:71], v[36:39], v[116:119]
    ds_read_b64 v[18:19], v2 offset:4608
    v_mfma_f32_16x16x32_bf16 v[120:123], v[72:75], v[24:27], v[120:123]
    ds_read_b64 v[20:21], v2 offset:6144
    v_mfma_f32_16x16x32_bf16 v[124:127], v[72:75], v[28:31], v[124:127]
    ds_read_b64 v[22:23], v2 offset:6656
    v_mfma_f32_16x16x32_bf16 v[128:131], v[72:75], v[32:35], v[128:131]
    ds_read_b64_tr_b16 v[44:45], v3 offset:32
    v_mfma_f32_16x16x32_bf16 v[132:135], v[72:75], v[36:39], v[132:135]
    ds_read_b64_tr_b16 v[46:47], v3 offset:1568
    v_mfma_f32_16x16x32_bf16 v[136:139], v[76:79], v[24:27], v[136:139]
    ds_read_b64_tr_b16 v[48:49], v3 offset:64
    v_mfma_f32_16x16x32_bf16 v[140:143], v[76:79], v[28:31], v[140:143]
    ds_read_b64_tr_b16 v[50:51], v3 offset:1600
    v_mfma_f32_16x16x32_bf16 v[144:147], v[76:79], v[32:35], v[144:147]
    ds_read_b64_tr_b16 v[52:53], v3 offset:12288
    v_mfma_f32_16x16x32_bf16 v[148:151], v[76:79], v[36:39], v[148:151]
    ds_read_b64_tr_b16 v[54:55], v3 offset:13824
    v_mfma_f32_16x16x32_bf16 v[152:155], v[80:83], v[24:27], v[152:155]
    ds_read_b64_tr_b16 v[56:57], v3 offset:12320
    v_mfma_f32_16x16x32_bf16 v[156:159], v[80:83], v[28:31], v[156:159]
    ds_read_b64_tr_b16 v[58:59], v3 offset:13856
    v_mfma_f32_16x16x32_bf16 v[160:163], v[80:83], v[32:35], v[160:163]
    ds_read_b64_tr_b16 v[60:61], v3 offset:12352
    v_mfma_f32_16x16x32_bf16 v[164:167], v[80:83], v[36:39], v[164:167]
    ds_read_b64_tr_b16 v[62:63], v3 offset:13888
    v_mfma_f32_16x16x32_bf16 v[168:171], v[84:87], v[24:27], v[168:171]
    v_mfma_f32_16x16x32_bf16 v[172:175], v[84:87], v[28:31], v[172:175]
    v_mfma_f32_16x16x32_bf16 v[176:179], v[84:87], v[32:35], v[176:179]
    v_mfma_f32_16x16x32_bf16 v[180:183], v[84:87], v[36:39], v[180:183]
    s_add_u32 s54, s54, 1
    s_cmp_lt_u32 s54, 5
    s_cbranch_scc1 m2_kernel_p4_loop
    s_waitcnt lgkmcnt(0)
    ds_read_b32 v8, v184 offset:0
    ds_read_b32 v10, v184 offset:512
    ds_read_b32 v12, v184 offset:64
    ds_read_b32 v14, v184 offset:576
    ds_read_b32 v16, v184 offset:128
    ds_read_b32 v18, v184 offset:640
    ds_read_b32 v20, v184 offset:192
    ds_read_b32 v22, v184 offset:704
    ds_read_b128 v[40:43], v185 offset:1024
    ds_read_b128 v[44:47], v185 offset:1088
    ds_read_b128 v[48:51], v185 offset:1152
    ds_read_b128 v[52:55], v185 offset:1408
    ds_read_b128 v[56:59], v185 offset:1472
    ds_read_b128 v[60:63], v185 offset:1536
    v_mov_b32 v196, 0xc0135761
    v_mov_b32 v197, 0xc0135761
    v_mov_b32 v198, 0xbdd2d3e8
    v_mov_b32 v199, 0xbdd2d3e8
    v_mov_b32 v200, 1.0
    v_mov_b32 v201, 1.0
    s_waitcnt lgkmcnt(0)
    v_pk_mul_f32 v[88:89], v[88:89], v[8:9] op_sel_hi:[1,0]
    v_pk_fma_f32 v[88:89], v[10:11], v[40:41], v[88:89] op_sel_hi:[0,1,1] neg_lo:[1,0,0] neg_hi:[1,0,0]
    v_pk_mul_f32 v[136:137], v[136:137], v[8:9] op_sel_hi:[1,0]
    v_pk_fma_f32 v[136:137], v[10:11], v[52:53], v[136:137] op_sel_hi:[0,1,1] neg_lo:[1,0,0] neg_hi:[1,0,0]
    v_pk_mul_f32 v[90:91], v[90:91], v[8:9] op_sel_hi:[1,0]
    v_pk_fma_f32 v[90:91], v[10:11], v[42:43], v[90:91] op_sel_hi:[0,1,1] neg_lo:[1,0,0] neg_hi:[1,0,0]
    v_pk_mul_f32 v[138:139], v[138:139], v[8:9] op_sel_hi:[1,0]
    v_pk_fma_f32 v[138:139], v[10:11], v[54:55], v[138:139] op_sel_hi:[0,1,1] neg_lo:[1,0,0] neg_hi:[1,0,0]
    v_pk_mul_f32 v[64:65], v[88:89], v[88:89]
    v_pk_mul_f32 v[66:67], v[90:91], v[90:91]
    v_pk_fma_f32 v[64:65], v[64:65], v[198:199], v[196:197]
    v_pk_fma_f32 v[66:67], v[66:67], v[198:199], v[196:197]
    v_pk_mul_f32 v[64:65], v[64:65], v[88:89]
    v_pk_mul_f32 v[66:67], v[66:67], v[90:91]
    v_exp_f32 v64, v64
    v_exp_f32 v65, v65
    v_exp_f32 v66, v66
    v_exp_f32 v67, v67
    v_pk_mul_f32 v[88:89], v[88:89], v[136:137]
    v_pk_mul_f32 v[90:91], v[90:91], v[138:139]
    v_pk_add_f32 v[64:65], v[64:65], v[200:201]
    v_pk_add_f32 v[66:67], v[66:67], v[200:201]
    v_rcp_f32 v64, v64
    v_rcp_f32 v65, v65
    v_rcp_f32 v66, v66
    v_rcp_f32 v67, v67
    v_pk_mul_f32 v[88:89], v[88:89], v[64:65]
    v_pk_mul_f32 v[90:91], v[90:91], v[66:67]
    v_cvt_pk_bf16_f32 v88, v88, v89
    v_cvt_pk_bf16_f32 v89, v90, v91
    s_add_u32 s36, s60, 0
    buffer_store_dwordx2 v[88:89], v186, s[40:43], s36 offen sc1
    v_pk_mul_f32 v[92:93], v[92:93], v[12:13] op_sel_hi:[1,0]
    v_pk_fma_f32 v[92:93], v[14:15], v[40:41], v[92:93] op_sel_hi:[0,1,1] neg_lo:[1,0,0] neg_hi:[1,0,0]
    v_pk_mul_f32 v[140:141], v[140:141], v[12:13] op_sel_hi:[1,0]
    v_pk_fma_f32 v[140:141], v[14:15], v[52:53], v[140:141] op_sel_hi:[0,1,1] neg_lo:[1,0,0] neg_hi:[1,0,0]
    v_pk_mul_f32 v[94:95], v[94:95], v[12:13] op_sel_hi:[1,0]
    v_pk_fma_f32 v[94:95], v[14:15], v[42:43], v[94:95] op_sel_hi:[0,1,1] neg_lo:[1,0,0] neg_hi:[1,0,0]
    v_pk_mul_f32 v[142:143], v[142:143], v[12:13] op_sel_hi:[1,0]
    v_pk_fma_f32 v[142:143], v[14:15], v[54:55], v[142:143] op_sel_hi:[0,1,1] neg_lo:[1,0,0] neg_hi:[1,0,0]
    v_pk_mul_f32 v[68:69], v[92:93], v[92:93]
    v_pk_mul_f32 v[70:71], v[94:95], v[94:95]
    v_pk_fma_f32 v[68:69], v[68:69], v[198:199], v[196:197]
    v_pk_fma_f32 v[70:71], v[70:71], v[198:199], v[196:197]
    v_pk_mul_f32 v[68:69], v[68:69], v[92:93]
    v_pk_mul_f32 v[70:71], v[70:71], v[94:95]
    v_exp_f32 v68, v68
    v_exp_f32 v69, v69
    v_exp_f32 v70, v70
    v_exp_f32 v71, v71
    v_pk_mul_f32 v[92:93], v[92:93], v[140:141]
    v_pk_mul_f32 v[94:95], v[94:95], v[142:143]
    v_pk_add_f32 v[68:69], v[68:69], v[200:201]
    v_pk_add_f32 v[70:71], v[70:71], v[200:201]
    v_rcp_f32 v68, v68
    v_rcp_f32 v69, v69
    v_rcp_f32 v70, v70
    v_rcp_f32 v71, v71
    v_pk_mul_f32 v[92:93], v[92:93], v[68:69]
    v_pk_mul_f32 v[94:95], v[94:95], v[70:71]
    v_cvt_pk_bf16_f32 v92, v92, v93
    v_cvt_pk_bf16_f32 v93, v94, v95
    s_add_u32 s36, s60, 49152
    buffer_store_dwordx2 v[92:93], v186, s[40:43], s36 offen sc1
    v_pk_mul_f32 v[96:97], v[96:97], v[16:17] op_sel_hi:[1,0]
    v_pk_fma_f32 v[96:97], v[18:19], v[40:41], v[96:97] op_sel_hi:[0,1,1] neg_lo:[1,0,0] neg_hi:[1,0,0]
    v_pk_mul_f32 v[144:145], v[144:145], v[16:17] op_sel_hi:[1,0]
    v_pk_fma_f32 v[144:145], v[18:19], v[52:53], v[144:145] op_sel_hi:[0,1,1] neg_lo:[1,0,0] neg_hi:[1,0,0]
    v_pk_mul_f32 v[98:99], v[98:99], v[16:17] op_sel_hi:[1,0]
    v_pk_fma_f32 v[98:99], v[18:19], v[42:43], v[98:99] op_sel_hi:[0,1,1] neg_lo:[1,0,0] neg_hi:[1,0,0]
    v_pk_mul_f32 v[146:147], v[146:147], v[16:17] op_sel_hi:[1,0]
    v_pk_fma_f32 v[146:147], v[18:19], v[54:55], v[146:147] op_sel_hi:[0,1,1] neg_lo:[1,0,0] neg_hi:[1,0,0]
    v_pk_mul_f32 v[72:73], v[96:97], v[96:97]
    v_pk_mul_f32 v[74:75], v[98:99], v[98:99]
    v_pk_fma_f32 v[72:73], v[72:73], v[198:199], v[196:197]
    v_pk_fma_f32 v[74:75], v[74:75], v[198:199], v[196:197]
    v_pk_mul_f32 v[72:73], v[72:73], v[96:97]
    v_pk_mul_f32 v[74:75], v[74:75], v[98:99]
    v_exp_f32 v72, v72
    v_exp_f32 v73, v73
    v_exp_f32 v74, v74
    v_exp_f32 v75, v75
    v_pk_mul_f32 v[96:97], v[96:97], v[144:145]
    v_pk_mul_f32 v[98:99], v[98:99], v[146:147]
    v_pk_add_f32 v[72:73], v[72:73], v[200:201]
    v_pk_add_f32 v[74:75], v[74:75], v[200:201]
    v_rcp_f32 v72, v72
    v_rcp_f32 v73, v73
    v_rcp_f32 v74, v74
    v_rcp_f32 v75, v75
    v_pk_mul_f32 v[96:97], v[96:97], v[72:73]
    v_pk_mul_f32 v[98:99], v[98:99], v[74:75]
    v_cvt_pk_bf16_f32 v96, v96, v97
    v_cvt_pk_bf16_f32 v97, v98, v99
    s_add_u32 s36, s60, 98304
    buffer_store_dwordx2 v[96:97], v186, s[40:43], s36 offen sc1
    v_pk_mul_f32 v[100:101], v[100:101], v[20:21] op_sel_hi:[1,0]
    v_pk_fma_f32 v[100:101], v[22:23], v[40:41], v[100:101] op_sel_hi:[0,1,1] neg_lo:[1,0,0] neg_hi:[1,0,0]
    v_pk_mul_f32 v[148:149], v[148:149], v[20:21] op_sel_hi:[1,0]
    v_pk_fma_f32 v[148:149], v[22:23], v[52:53], v[148:149] op_sel_hi:[0,1,1] neg_lo:[1,0,0] neg_hi:[1,0,0]
    v_pk_mul_f32 v[102:103], v[102:103], v[20:21] op_sel_hi:[1,0]
    v_pk_fma_f32 v[102:103], v[22:23], v[42:43], v[102:103] op_sel_hi:[0,1,1] neg_lo:[1,0,0] neg_hi:[1,0,0]
    v_pk_mul_f32 v[150:151], v[150:151], v[20:21] op_sel_hi:[1,0]
    v_pk_fma_f32 v[150:151], v[22:23], v[54:55], v[150:151] op_sel_hi:[0,1,1] neg_lo:[1,0,0] neg_hi:[1,0,0]
    v_pk_mul_f32 v[76:77], v[100:101], v[100:101]
    v_pk_mul_f32 v[78:79], v[102:103], v[102:103]
    v_pk_fma_f32 v[76:77], v[76:77], v[198:199], v[196:197]
    v_pk_fma_f32 v[78:79], v[78:79], v[198:199], v[196:197]
    v_pk_mul_f32 v[76:77], v[76:77], v[100:101]
    v_pk_mul_f32 v[78:79], v[78:79], v[102:103]
    v_exp_f32 v76, v76
    v_exp_f32 v77, v77
    v_exp_f32 v78, v78
    v_exp_f32 v79, v79
    v_pk_mul_f32 v[100:101], v[100:101], v[148:149]
    v_pk_mul_f32 v[102:103], v[102:103], v[150:151]
    v_pk_add_f32 v[76:77], v[76:77], v[200:201]
    v_pk_add_f32 v[78:79], v[78:79], v[200:201]
    v_rcp_f32 v76, v76
    v_rcp_f32 v77, v77
    v_rcp_f32 v78, v78
    v_rcp_f32 v79, v79
    v_pk_mul_f32 v[100:101], v[100:101], v[76:77]
    v_pk_mul_f32 v[102:103], v[102:103], v[78:79]
    v_cvt_pk_bf16_f32 v100, v100, v101
    v_cvt_pk_bf16_f32 v101, v102, v103
    s_add_u32 s36, s60, 147456
    buffer_store_dwordx2 v[100:101], v186, s[40:43], s36 offen sc1
    v_pk_mul_f32 v[104:105], v[104:105], v[8:9] op_sel_hi:[1,0]
    v_pk_fma_f32 v[104:105], v[10:11], v[44:45], v[104:105] op_sel_hi:[0,1,1] neg_lo:[1,0,0] neg_hi:[1,0,0]
    v_pk_mul_f32 v[152:153], v[152:153], v[8:9] op_sel_hi:[1,0]
    v_pk_fma_f32 v[152:153], v[10:11], v[56:57], v[152:153] op_sel_hi:[0,1,1] neg_lo:[1,0,0] neg_hi:[1,0,0]
    v_pk_mul_f32 v[106:107], v[106:107], v[8:9] op_sel_hi:[1,0]
    v_pk_fma_f32 v[106:107], v[10:11], v[46:47], v[106:107] op_sel_hi:[0,1,1] neg_lo:[1,0,0] neg_hi:[1,0,0]
    v_pk_mul_f32 v[154:155], v[154:155], v[8:9] op_sel_hi:[1,0]
    v_pk_fma_f32 v[154:155], v[10:11], v[58:59], v[154:155] op_sel_hi:[0,1,1] neg_lo:[1,0,0] neg_hi:[1,0,0]
    v_pk_mul_f32 v[64:65], v[104:105], v[104:105]
    v_pk_mul_f32 v[66:67], v[106:107], v[106:107]
    v_pk_fma_f32 v[64:65], v[64:65], v[198:199], v[196:197]
    v_pk_fma_f32 v[66:67], v[66:67], v[198:199], v[196:197]
    v_pk_mul_f32 v[64:65], v[64:65], v[104:105]
    v_pk_mul_f32 v[66:67], v[66:67], v[106:107]
    v_exp_f32 v64, v64
    v_exp_f32 v65, v65
    v_exp_f32 v66, v66
    v_exp_f32 v67, v67
    v_pk_mul_f32 v[104:105], v[104:105], v[152:153]
    v_pk_mul_f32 v[106:107], v[106:107], v[154:155]
    v_pk_add_f32 v[64:65], v[64:65], v[200:201]
    v_pk_add_f32 v[66:67], v[66:67], v[200:201]
    v_rcp_f32 v64, v64
    v_rcp_f32 v65, v65
    v_rcp_f32 v66, v66
    v_rcp_f32 v67, v67
    v_pk_mul_f32 v[104:105], v[104:105], v[64:65]
    v_pk_mul_f32 v[106:107], v[106:107], v[66:67]
    v_cvt_pk_bf16_f32 v104, v104, v105
    v_cvt_pk_bf16_f32 v105, v106, v107
    s_add_u32 s36, s60, 512
    buffer_store_dwordx2 v[104:105], v186, s[40:43], s36 offen sc1
    v_pk_mul_f32 v[108:109], v[108:109], v[12:13] op_sel_hi:[1,0]
    v_pk_fma_f32 v[108:109], v[14:15], v[44:45], v[108:109] op_sel_hi:[0,1,1] neg_lo:[1,0,0] neg_hi:[1,0,0]
    v_pk_mul_f32 v[156:157], v[156:157], v[12:13] op_sel_hi:[1,0]
    v_pk_fma_f32 v[156:157], v[14:15], v[56:57], v[156:157] op_sel_hi:[0,1,1] neg_lo:[1,0,0] neg_hi:[1,0,0]
    v_pk_mul_f32 v[110:111], v[110:111], v[12:13] op_sel_hi:[1,0]
    v_pk_fma_f32 v[110:111], v[14:15], v[46:47], v[110:111] op_sel_hi:[0,1,1] neg_lo:[1,0,0] neg_hi:[1,0,0]
    v_pk_mul_f32 v[158:159], v[158:159], v[12:13] op_sel_hi:[1,0]
    v_pk_fma_f32 v[158:159], v[14:15], v[58:59], v[158:159] op_sel_hi:[0,1,1] neg_lo:[1,0,0] neg_hi:[1,0,0]
    v_pk_mul_f32 v[68:69], v[108:109], v[108:109]
    v_pk_mul_f32 v[70:71], v[110:111], v[110:111]
    v_pk_fma_f32 v[68:69], v[68:69], v[198:199], v[196:197]
    v_pk_fma_f32 v[70:71], v[70:71], v[198:199], v[196:197]
    v_pk_mul_f32 v[68:69], v[68:69], v[108:109]
    v_pk_mul_f32 v[70:71], v[70:71], v[110:111]
    v_exp_f32 v68, v68
    v_exp_f32 v69, v69
    v_exp_f32 v70, v70
    v_exp_f32 v71, v71
    v_pk_mul_f32 v[108:109], v[108:109], v[156:157]
    v_pk_mul_f32 v[110:111], v[110:111], v[158:159]
    v_pk_add_f32 v[68:69], v[68:69], v[200:201]
    v_pk_add_f32 v[70:71], v[70:71], v[200:201]
    v_rcp_f32 v68, v68
    v_rcp_f32 v69, v69
    v_rcp_f32 v70, v70
    v_rcp_f32 v71, v71
    v_pk_mul_f32 v[108:109], v[108:109], v[68:69]
    v_pk_mul_f32 v[110:111], v[110:111], v[70:71]
    v_cvt_pk_bf16_f32 v108, v108, v109
    v_cvt_pk_bf16_f32 v109, v110, v111
    s_add_u32 s36, s60, 49664
    buffer_store_dwordx2 v[108:109], v186, s[40:43], s36 offen sc1
    v_pk_mul_f32 v[112:113], v[112:113], v[16:17] op_sel_hi:[1,0]
    v_pk_fma_f32 v[112:113], v[18:19], v[44:45], v[112:113] op_sel_hi:[0,1,1] neg_lo:[1,0,0] neg_hi:[1,0,0]
    v_pk_mul_f32 v[160:161], v[160:161], v[16:17] op_sel_hi:[1,0]
    v_pk_fma_f32 v[160:161], v[18:19], v[56:57], v[160:161] op_sel_hi:[0,1,1] neg_lo:[1,0,0] neg_hi:[1,0,0]
    v_pk_mul_f32 v[114:115], v[114:115], v[16:17] op_sel_hi:[1,0]
    v_pk_fma_f32 v[114:115], v[18:19], v[46:47], v[114:115] op_sel_hi:[0,1,1] neg_lo:[1,0,0] neg_hi:[1,0,0]
    v_pk_mul_f32 v[162:163], v[162:163], v[16:17] op_sel_hi:[1,0]
    v_pk_fma_f32 v[162:163], v[18:19], v[58:59], v[162:163] op_sel_hi:[0,1,1] neg_lo:[1,0,0] neg_hi:[1,0,0]
    v_pk_mul_f32 v[72:73], v[112:113], v[112:113]
    v_pk_mul_f32 v[74:75], v[114:115], v[114:115]
    v_pk_fma_f32 v[72:73], v[72:73], v[198:199], v[196:197]
    v_pk_fma_f32 v[74:75], v[74:75], v[198:199], v[196:197]
    v_pk_mul_f32 v[72:73], v[72:73], v[112:113]
    v_pk_mul_f32 v[74:75], v[74:75], v[114:115]
    v_exp_f32 v72, v72
    v_exp_f32 v73, v73
    v_exp_f32 v74, v74
    v_exp_f32 v75, v75
    v_pk_mul_f32 v[112:113], v[112:113], v[160:161]
    v_pk_mul_f32 v[114:115], v[114:115], v[162:163]
    v_pk_add_f32 v[72:73], v[72:73], v[200:201]
    v_pk_add_f32 v[74:75], v[74:75], v[200:201]
    v_rcp_f32 v72, v72
    v_rcp_f32 v73, v73
    v_rcp_f32 v74, v74
    v_rcp_f32 v75, v75
    v_pk_mul_f32 v[112:113], v[112:113], v[72:73]
    v_pk_mul_f32 v[114:115], v[114:115], v[74:75]
    v_cvt_pk_bf16_f32 v112, v112, v113
    v_cvt_pk_bf16_f32 v113, v114, v115
    s_add_u32 s36, s60, 98816
    buffer_store_dwordx2 v[112:113], v186, s[40:43], s36 offen sc1
    v_pk_mul_f32 v[116:117], v[116:117], v[20:21] op_sel_hi:[1,0]
    v_pk_fma_f32 v[116:117], v[22:23], v[44:45], v[116:117] op_sel_hi:[0,1,1] neg_lo:[1,0,0] neg_hi:[1,0,0]
    v_pk_mul_f32 v[164:165], v[164:165], v[20:21] op_sel_hi:[1,0]
    v_pk_fma_f32 v[164:165], v[22:23], v[56:57], v[164:165] op_sel_hi:[0,1,1] neg_lo:[1,0,0] neg_hi:[1,0,0]
    v_pk_mul_f32 v[118:119], v[118:119], v[20:21] op_sel_hi:[1,0]
    v_pk_fma_f32 v[118:119], v[22:23], v[46:47], v[118:119] op_sel_hi:[0,1,1] neg_lo:[1,0,0] neg_hi:[1,0,0]
    v_pk_mul_f32 v[166:167], v[166:167], v[20:21] op_sel_hi:[1,0]
    v_pk_fma_f32 v[166:167], v[22:23], v[58:59], v[166:167] op_sel_hi:[0,1,1] neg_lo:[1,0,0] neg_hi:[1,0,0]
    v_pk_mul_f32 v[76:77], v[116:117], v[116:117]
    v_pk_mul_f32 v[78:79], v[118:119], v[118:119]
    v_pk_fma_f32 v[76:77], v[76:77], v[198:199], v[196:197]
    v_pk_fma_f32 v[78:79], v[78:79], v[198:199], v[196:197]
    v_pk_mul_f32 v[76:77], v[76:77], v[116:117]
    v_pk_mul_f32 v[78:79], v[78:79], v[118:119]
    v_exp_f32 v76, v76
    v_exp_f32 v77, v77
    v_exp_f32 v78, v78
    v_exp_f32 v79, v79
    v_pk_mul_f32 v[116:117], v[116:117], v[164:165]
    v_pk_mul_f32 v[118:119], v[118:119], v[166:167]
    v_pk_add_f32 v[76:77], v[76:77], v[200:201]
    v_pk_add_f32 v[78:79], v[78:79], v[200:201]
    v_rcp_f32 v76, v76
    v_rcp_f32 v77, v77
    v_rcp_f32 v78, v78
    v_rcp_f32 v79, v79
    v_pk_mul_f32 v[116:117], v[116:117], v[76:77]
    v_pk_mul_f32 v[118:119], v[118:119], v[78:79]
    v_cvt_pk_bf16_f32 v116, v116, v117
    v_cvt_pk_bf16_f32 v117, v118, v119
    s_add_u32 s36, s60, 147968
    buffer_store_dwordx2 v[116:117], v186, s[40:43], s36 offen sc1
    v_pk_mul_f32 v[120:121], v[120:121], v[8:9] op_sel_hi:[1,0]
    v_pk_fma_f32 v[120:121], v[10:11], v[48:49], v[120:121] op_sel_hi:[0,1,1] neg_lo:[1,0,0] neg_hi:[1,0,0]
    v_pk_mul_f32 v[168:169], v[168:169], v[8:9] op_sel_hi:[1,0]
    v_pk_fma_f32 v[168:169], v[10:11], v[60:61], v[168:169] op_sel_hi:[0,1,1] neg_lo:[1,0,0] neg_hi:[1,0,0]
    v_pk_mul_f32 v[122:123], v[122:123], v[8:9] op_sel_hi:[1,0]
    v_pk_fma_f32 v[122:123], v[10:11], v[50:51], v[122:123] op_sel_hi:[0,1,1] neg_lo:[1,0,0] neg_hi:[1,0,0]
    v_pk_mul_f32 v[170:171], v[170:171], v[8:9] op_sel_hi:[1,0]
    v_pk_fma_f32 v[170:171], v[10:11], v[62:63], v[170:171] op_sel_hi:[0,1,1] neg_lo:[1,0,0] neg_hi:[1,0,0]
    v_pk_mul_f32 v[64:65], v[120:121], v[120:121]
    v_pk_mul_f32 v[66:67], v[122:123], v[122:123]
    v_pk_fma_f32 v[64:65], v[64:65], v[198:199], v[196:197]
    v_pk_fma_f32 v[66:67], v[66:67], v[198:199], v[196:197]
    v_pk_mul_f32 v[64:65], v[64:65], v[120:121]
    v_pk_mul_f32 v[66:67], v[66:67], v[122:123]
    v_exp_f32 v64, v64
    v_exp_f32 v65, v65
    v_exp_f32 v66, v66
    v_exp_f32 v67, v67
    v_pk_mul_f32 v[120:121], v[120:121], v[168:169]
    v_pk_mul_f32 v[122:123], v[122:123], v[170:171]
    v_pk_add_f32 v[64:65], v[64:65], v[200:201]
    v_pk_add_f32 v[66:67], v[66:67], v[200:201]
    v_rcp_f32 v64, v64
    v_rcp_f32 v65, v65
    v_rcp_f32 v66, v66
    v_rcp_f32 v67, v67
    v_pk_mul_f32 v[120:121], v[120:121], v[64:65]
    v_pk_mul_f32 v[122:123], v[122:123], v[66:67]
    v_cvt_pk_bf16_f32 v120, v120, v121
    v_cvt_pk_bf16_f32 v121, v122, v123
    s_add_u32 s36, s60, 1024
    buffer_store_dwordx2 v[120:121], v186, s[40:43], s36 offen sc1
    v_pk_mul_f32 v[124:125], v[124:125], v[12:13] op_sel_hi:[1,0]
    v_pk_fma_f32 v[124:125], v[14:15], v[48:49], v[124:125] op_sel_hi:[0,1,1] neg_lo:[1,0,0] neg_hi:[1,0,0]
    v_pk_mul_f32 v[172:173], v[172:173], v[12:13] op_sel_hi:[1,0]
    v_pk_fma_f32 v[172:173], v[14:15], v[60:61], v[172:173] op_sel_hi:[0,1,1] neg_lo:[1,0,0] neg_hi:[1,0,0]
    v_pk_mul_f32 v[126:127], v[126:127], v[12:13] op_sel_hi:[1,0]
    v_pk_fma_f32 v[126:127], v[14:15], v[50:51], v[126:127] op_sel_hi:[0,1,1] neg_lo:[1,0,0] neg_hi:[1,0,0]
    v_pk_mul_f32 v[174:175], v[174:175], v[12:13] op_sel_hi:[1,0]
    v_pk_fma_f32 v[174:175], v[14:15], v[62:63], v[174:175] op_sel_hi:[0,1,1] neg_lo:[1,0,0] neg_hi:[1,0,0]
    v_pk_mul_f32 v[68:69], v[124:125], v[124:125]
    v_pk_mul_f32 v[70:71], v[126:127], v[126:127]
    v_pk_fma_f32 v[68:69], v[68:69], v[198:199], v[196:197]
    v_pk_fma_f32 v[70:71], v[70:71], v[198:199], v[196:197]
    v_pk_mul_f32 v[68:69], v[68:69], v[124:125]
    v_pk_mul_f32 v[70:71], v[70:71], v[126:127]
    v_exp_f32 v68, v68
    v_exp_f32 v69, v69
    v_exp_f32 v70, v70
    v_exp_f32 v71, v71
    v_pk_mul_f32 v[124:125], v[124:125], v[172:173]
    v_pk_mul_f32 v[126:127], v[126:127], v[174:175]
    v_pk_add_f32 v[68:69], v[68:69], v[200:201]
    v_pk_add_f32 v[70:71], v[70:71], v[200:201]
    v_rcp_f32 v68, v68
    v_rcp_f32 v69, v69
    v_rcp_f32 v70, v70
    v_rcp_f32 v71, v71
    v_pk_mul_f32 v[124:125], v[124:125], v[68:69]
    v_pk_mul_f32 v[126:127], v[126:127], v[70:71]
    v_cvt_pk_bf16_f32 v124, v124, v125
    v_cvt_pk_bf16_f32 v125, v126, v127
    s_add_u32 s36, s60, 50176
    buffer_store_dwordx2 v[124:125], v186, s[40:43], s36 offen sc1
    v_pk_mul_f32 v[128:129], v[128:129], v[16:17] op_sel_hi:[1,0]
    v_pk_fma_f32 v[128:129], v[18:19], v[48:49], v[128:129] op_sel_hi:[0,1,1] neg_lo:[1,0,0] neg_hi:[1,0,0]
    v_pk_mul_f32 v[176:177], v[176:177], v[16:17] op_sel_hi:[1,0]
    v_pk_fma_f32 v[176:177], v[18:19], v[60:61], v[176:177] op_sel_hi:[0,1,1] neg_lo:[1,0,0] neg_hi:[1,0,0]
    v_pk_mul_f32 v[130:131], v[130:131], v[16:17] op_sel_hi:[1,0]
    v_pk_fma_f32 v[130:131], v[18:19], v[50:51], v[130:131] op_sel_hi:[0,1,1] neg_lo:[1,0,0] neg_hi:[1,0,0]
    v_pk_mul_f32 v[178:179], v[178:179], v[16:17] op_sel_hi:[1,0]
    v_pk_fma_f32 v[178:179], v[18:19], v[62:63], v[178:179] op_sel_hi:[0,1,1] neg_lo:[1,0,0] neg_hi:[1,0,0]
    v_pk_mul_f32 v[72:73], v[128:129], v[128:129]
    v_pk_mul_f32 v[74:75], v[130:131], v[130:131]
    v_pk_fma_f32 v[72:73], v[72:73], v[198:199], v[196:197]
    v_pk_fma_f32 v[74:75], v[74:75], v[198:199], v[196:197]
    v_pk_mul_f32 v[72:73], v[72:73], v[128:129]
    v_pk_mul_f32 v[74:75], v[74:75], v[130:131]
    v_exp_f32 v72, v72
    v_exp_f32 v73, v73
    v_exp_f32 v74, v74
    v_exp_f32 v75, v75
    v_pk_mul_f32 v[128:129], v[128:129], v[176:177]
    v_pk_mul_f32 v[130:131], v[130:131], v[178:179]
    v_pk_add_f32 v[72:73], v[72:73], v[200:201]
    v_pk_add_f32 v[74:75], v[74:75], v[200:201]
    v_rcp_f32 v72, v72
    v_rcp_f32 v73, v73
    v_rcp_f32 v74, v74
    v_rcp_f32 v75, v75
    v_pk_mul_f32 v[128:129], v[128:129], v[72:73]
    v_pk_mul_f32 v[130:131], v[130:131], v[74:75]
    v_cvt_pk_bf16_f32 v128, v128, v129
    v_cvt_pk_bf16_f32 v129, v130, v131
    s_add_u32 s36, s60, 99328
    buffer_store_dwordx2 v[128:129], v186, s[40:43], s36 offen sc1
    v_pk_mul_f32 v[132:133], v[132:133], v[20:21] op_sel_hi:[1,0]
    v_pk_fma_f32 v[132:133], v[22:23], v[48:49], v[132:133] op_sel_hi:[0,1,1] neg_lo:[1,0,0] neg_hi:[1,0,0]
    v_pk_mul_f32 v[180:181], v[180:181], v[20:21] op_sel_hi:[1,0]
    v_pk_fma_f32 v[180:181], v[22:23], v[60:61], v[180:181] op_sel_hi:[0,1,1] neg_lo:[1,0,0] neg_hi:[1,0,0]
    v_pk_mul_f32 v[134:135], v[134:135], v[20:21] op_sel_hi:[1,0]
    v_pk_fma_f32 v[134:135], v[22:23], v[50:51], v[134:135] op_sel_hi:[0,1,1] neg_lo:[1,0,0] neg_hi:[1,0,0]
    v_pk_mul_f32 v[182:183], v[182:183], v[20:21] op_sel_hi:[1,0]
    v_pk_fma_f32 v[182:183], v[22:23], v[62:63], v[182:183] op_sel_hi:[0,1,1] neg_lo:[1,0,0] neg_hi:[1,0,0]
    v_pk_mul_f32 v[76:77], v[132:133], v[132:133]
    v_pk_mul_f32 v[78:79], v[134:135], v[134:135]
    v_pk_fma_f32 v[76:77], v[76:77], v[198:199], v[196:197]
    v_pk_fma_f32 v[78:79], v[78:79], v[198:199], v[196:197]
    v_pk_mul_f32 v[76:77], v[76:77], v[132:133]
    v_pk_mul_f32 v[78:79], v[78:79], v[134:135]
    v_exp_f32 v76, v76
    v_exp_f32 v77, v77
    v_exp_f32 v78, v78
    v_exp_f32 v79, v79
    v_pk_mul_f32 v[132:133], v[132:133], v[180:181]
    v_pk_mul_f32 v[134:135], v[134:135], v[182:183]
    v_pk_add_f32 v[76:77], v[76:77], v[200:201]
    v_pk_add_f32 v[78:79], v[78:79], v[200:201]
    v_rcp_f32 v76, v76
    v_rcp_f32 v77, v77
    v_rcp_f32 v78, v78
    v_rcp_f32 v79, v79
    v_pk_mul_f32 v[132:133], v[132:133], v[76:77]
    v_pk_mul_f32 v[134:135], v[134:135], v[78:79]
    v_cvt_pk_bf16_f32 v132, v132, v133
    v_cvt_pk_bf16_f32 v133, v134, v135
    s_add_u32 s36, s60, 148480
    buffer_store_dwordx2 v[132:133], v186, s[40:43], s36 offen sc1
    s_waitcnt vmcnt(0)
    s_lshr_b32 s52, s22, 1
    s_and_b32 s53, s22, 1
    v_lshlrev_b32 v2, 3, v1
    s_lshl_b32 s34, s53, 13
    s_lshl_b32 s35, s52, 12
    s_add_u32 s34, s34, s35
    v_add_u32 v2, s34, v2
    v_lshrrev_b32 v124, 4, v1
    v_bfe_u32 v125, v1, 2, 2
    v_and_b32 v126, 3, v1
    v_lshl_add_u32 v127, v124, 2, v125
    v_mul_u32_u24 v127, 160, v127
    v_lshl_add_u32 v127, v126, 3, v127
    s_mul_i32 s34, s53, 10336
    s_add_u32 s34, s34, 65536
    v_add_u32 v3, s34, v127
    s_mul_i32 s34, s53, 10176
    s_add_u32 s34, s34, 65536
    v_add_u32 v4, s34, v127
    v_and_b32 v128, 15, v1
    s_lshl_b32 s34, s26, 2
    s_and_b32 s35, s24, 3
    s_add_u32 s34, s34, s35
    s_lshl_b32 s34, s34, 6
    s_lshl_b32 s35, s52, 5
    s_add_u32 s34, s34, s35
    v_add_u32 v129, s34, v128
    v_mul_u32_u24 v130, 1280, v129
    v_lshl_add_u32 v130, v124, 3, v130
    s_mul_i32 s35, s27, 160
    v_add_u32 v130, s35, v130
    v_lshlrev_b32 v131, 3, v1
    s_lshr_b32 s35, s34, 4
    s_mul_i32 s35, s35, 20480
    v_add_u32 v131, s35, v131
    s_mul_i32 s36, s27, 5
    s_add_u32 s40, s20, 10485760
    s_addc_u32 s41, s21, 0
    s_mov_b32 s42, 2621440
    s_mov_b32 s43, 0x00020000
    s_mov_b32 s44, s18
    s_mov_b32 s45, s19
    s_mov_b32 s46, 2621440
    s_mov_b32 s47, 0x00020000
    v_mov_b32 v117, v131
    v_mov_b32 v116, v130
    s_mul_i32 s34, s53, 3
    s_add_u32 s34, s34, 0
    s_lshl_b32 s60, s34, 5
    s_add_u32 s34, s34, s36
    s_lshl_b32 s64, s34, 9
    s_mul_i32 s34, s53, 3
    s_add_u32 s34, s34, 1
    s_lshl_b32 s61, s34, 5
    s_add_u32 s34, s34, s36
    s_lshl_b32 s65, s34, 9
    s_mul_i32 s34, s53, 3
    s_add_u32 s34, s34, 2
    s_lshl_b32 s62, s34, 5
    s_add_u32 s34, s34, s36
    s_lshl_b32 s66, s34, 9
    s_mul_i32 s34, s52, 10240
    s_add_u32 s34, s34, 106496
    s_cmp_eq_u32 s53, 0
    s_movk_i32 s33, 4096
    s_cselect_b32 s35, 4294965248, s33
    s_cselect_b32 s33, 4096, 0
    s_add_u32 s35, s35, s34
    s_add_u32 s33, s33, s34
    v_lshlrev_b32 v124, 4, v1
    v_add_u32 v119, s35, v124
    v_add_u32 v120, s33, v124
    v_lshlrev_b32 v118, 7, v129
    s_lshl_b32 s34, s27, 4
    s_lshl_b32 s35, s53, 3
    s_add_u32 s34, s34, s35
    v_add_u32 v118, s34, v118
    s_mov_b32 s54, 0
    s_mov_b32 s68, 16384
    s_mov_b32 s69, 4294918144
    s_mov_b32 s70, 20480
    s_mov_b32 s71, 4294905856
    v_mov_b32 v64, 0
    v_mov_b32 v65, 0
    v_mov_b32 v66, 0
    v_mov_b32 v67, 0
    v_mov_b32 v68, 0
    v_mov_b32 v69, 0
    v_mov_b32 v70, 0
    v_mov_b32 v71, 0
    v_mov_b32 v72, 0
    v_mov_b32 v73, 0
    v_mov_b32 v74, 0
    v_mov_b32 v75, 0
    v_mov_b32 v76, 0
    v_mov_b32 v77, 0
    v_mov_b32 v78, 0
    v_mov_b32 v79, 0
    v_mov_b32 v80, 0
    v_mov_b32 v81, 0
    v_mov_b32 v82, 0
    v_mov_b32 v83, 0
    v_mov_b32 v84, 0
    v_mov_b32 v85, 0
    v_mov_b32 v86, 0
    v_mov_b32 v87, 0
    v_mov_b32 v88, 0
    v_mov_b32 v89, 0
    v_mov_b32 v90, 0
    v_mov_b32 v91, 0
    v_mov_b32 v92, 0
    v_mov_b32 v93, 0
    v_mov_b32 v94, 0
    v_mov_b32 v95, 0
    v_mov_b32 v96, 0
    v_mov_b32 v97, 0
    v_mov_b32 v98, 0
    v_mov_b32 v99, 0
    v_mov_b32 v100, 0
    v_mov_b32 v101, 0
    v_mov_b32 v102, 0
    v_mov_b32 v103, 0
    s_waitcnt vmcnt(0)
    s_barrier
    s_add_u32 s34, s64, 0
    buffer_load_dwordx2 v[104:105], v117, s[40:43], s34 offen sc1
    s_add_u32 s34, s64, 20480
    buffer_load_dwordx2 v[106:107], v117, s[40:43], s34 offen sc1
    s_add_u32 s34, s65, 0
    buffer_load_dwordx2 v[108:109], v117, s[40:43], s34 offen sc1
    s_add_u32 s34, s65, 20480
    buffer_load_dwordx2 v[110:111], v117, s[40:43], s34 offen sc1
    s_add_u32 s34, s66, 0
    buffer_load_dwordx2 v[112:113], v117, s[40:43], s34 offen sc1
    s_add_u32 s34, s66, 20480
    buffer_load_dwordx2 v[114:115], v117, s[40:43], s34 offen sc1
    s_barrier
    s_barrier
    ds_read_b64 v[8:9], v2 offset:0
    ds_read_b64 v[10:11], v2 offset:512
    ds_read_b64 v[12:13], v2 offset:2048
    ds_read_b64 v[14:15], v2 offset:2560
    ds_read_b64_tr_b16 v[24:25], v3 offset:0
    ds_read_b64_tr_b16 v[26:27], v3 offset:2560
    ds_read_b64_tr_b16 v[28:29], v3 offset:32
    ds_read_b64_tr_b16 v[30:31], v3 offset:2592
    ds_read_b64_tr_b16 v[32:33], v4 offset:64
    ds_read_b64_tr_b16 v[34:35], v4 offset:2624
    ds_read_b64_tr_b16 v[36:37], v4 offset:96
    ds_read_b64_tr_b16 v[38:39], v4 offset:2656
    ds_read_b64_tr_b16 v[40:41], v4 offset:128
    ds_read_b64_tr_b16 v[42:43], v4 offset:2688
m2_kernel_wd_loop:
    s_waitcnt lgkmcnt(8)
    v_mfma_f32_16x16x32_bf16 v[64:67], v[24:27], v[8:11], v[64:67]
    ds_read_b64 v[16:17], v2 offset:1024
    ds_read_b64 v[18:19], v2 offset:1536
    v_mfma_f32_16x16x32_bf16 v[68:71], v[24:27], v[12:15], v[68:71]
    ds_read_b64 v[20:21], v2 offset:3072
    ds_read_b64 v[22:23], v2 offset:3584
    s_waitcnt lgkmcnt(10)
    v_mfma_f32_16x16x32_bf16 v[72:75], v[28:31], v[8:11], v[72:75]
    ds_read_b64_tr_b16 v[44:45], v3 offset:5120
    ds_read_b64_tr_b16 v[46:47], v3 offset:7680
    v_mfma_f32_16x16x32_bf16 v[76:79], v[28:31], v[12:15], v[76:79]
    ds_read_b64_tr_b16 v[48:49], v3 offset:5152
    ds_read_b64_tr_b16 v[50:51], v3 offset:7712
    s_waitcnt lgkmcnt(12)
    v_mfma_f32_16x16x32_bf16 v[80:83], v[32:35], v[8:11], v[80:83]
    ds_read_b64_tr_b16 v[52:53], v4 offset:5184
    ds_read_b64_tr_b16 v[54:55], v4 offset:7744
    v_mfma_f32_16x16x32_bf16 v[84:87], v[32:35], v[12:15], v[84:87]
    ds_read_b64_tr_b16 v[56:57], v4 offset:5216
    ds_read_b64_tr_b16 v[58:59], v4 offset:7776
    s_waitcnt lgkmcnt(14)
    v_mfma_f32_16x16x32_bf16 v[88:91], v[36:39], v[8:11], v[88:91]
    ds_read_b64_tr_b16 v[60:61], v4 offset:5248
    ds_read_b64_tr_b16 v[62:63], v4 offset:7808
    v_mfma_f32_16x16x32_bf16 v[92:95], v[36:39], v[12:15], v[92:95]
    s_waitcnt lgkmcnt(14)
    v_mfma_f32_16x16x32_bf16 v[96:99], v[40:43], v[8:11], v[96:99]
    v_mfma_f32_16x16x32_bf16 v[100:103], v[40:43], v[12:15], v[100:103]
    s_waitcnt lgkmcnt(0)
    s_barrier
    v_add_u32 v2, 16384, v2
    v_add_u32 v3, 20480, v3
    v_add_u32 v4, 20480, v4
    v_mfma_f32_16x16x32_bf16 v[64:67], v[44:47], v[16:19], v[64:67]
    ds_read_b64 v[8:9], v2 offset:0
    ds_read_b64 v[10:11], v2 offset:512
    v_mfma_f32_16x16x32_bf16 v[68:71], v[44:47], v[20:23], v[68:71]
    ds_read_b64 v[12:13], v2 offset:2048
    ds_read_b64 v[14:15], v2 offset:2560
    v_mfma_f32_16x16x32_bf16 v[72:75], v[48:51], v[16:19], v[72:75]
    ds_read_b64_tr_b16 v[24:25], v3 offset:0
    ds_read_b64_tr_b16 v[26:27], v3 offset:2560
    v_mfma_f32_16x16x32_bf16 v[76:79], v[48:51], v[20:23], v[76:79]
    ds_read_b64_tr_b16 v[28:29], v3 offset:32
    ds_read_b64_tr_b16 v[30:31], v3 offset:2592
    v_mfma_f32_16x16x32_bf16 v[80:83], v[52:55], v[16:19], v[80:83]
    ds_read_b64_tr_b16 v[32:33], v4 offset:64
    ds_read_b64_tr_b16 v[34:35], v4 offset:2624
    v_mfma_f32_16x16x32_bf16 v[84:87], v[52:55], v[20:23], v[84:87]
    ds_read_b64_tr_b16 v[36:37], v4 offset:96
    ds_read_b64_tr_b16 v[38:39], v4 offset:2656
    v_mfma_f32_16x16x32_bf16 v[88:91], v[56:59], v[16:19], v[88:91]
    ds_read_b64_tr_b16 v[40:41], v4 offset:128
    ds_read_b64_tr_b16 v[42:43], v4 offset:2688
    v_mfma_f32_16x16x32_bf16 v[92:95], v[56:59], v[20:23], v[92:95]
    v_mfma_f32_16x16x32_bf16 v[96:99], v[60:63], v[16:19], v[96:99]
    v_mfma_f32_16x16x32_bf16 v[100:103], v[60:63], v[20:23], v[100:103]
    s_waitcnt lgkmcnt(8)
    v_mfma_f32_16x16x32_bf16 v[64:67], v[24:27], v[8:11], v[64:67]
    ds_read_b64 v[16:17], v2 offset:1024
    ds_read_b64 v[18:19], v2 offset:1536
    v_mfma_f32_16x16x32_bf16 v[68:71], v[24:27], v[12:15], v[68:71]
    ds_read_b64 v[20:21], v2 offset:3072
    ds_read_b64 v[22:23], v2 offset:3584
    s_waitcnt lgkmcnt(10)
    v_mfma_f32_16x16x32_bf16 v[72:75], v[28:31], v[8:11], v[72:75]
    ds_read_b64_tr_b16 v[44:45], v3 offset:5120
    ds_read_b64_tr_b16 v[46:47], v3 offset:7680
    v_mfma_f32_16x16x32_bf16 v[76:79], v[28:31], v[12:15], v[76:79]
    ds_read_b64_tr_b16 v[48:49], v3 offset:5152
    ds_read_b64_tr_b16 v[50:51], v3 offset:7712
    s_waitcnt lgkmcnt(12)
    v_mfma_f32_16x16x32_bf16 v[80:83], v[32:35], v[8:11], v[80:83]
    ds_read_b64_tr_b16 v[52:53], v4 offset:5184
    ds_read_b64_tr_b16 v[54:55], v4 offset:7744
    v_mfma_f32_16x16x32_bf16 v[84:87], v[32:35], v[12:15], v[84:87]
    ds_read_b64_tr_b16 v[56:57], v4 offset:5216
    ds_read_b64_tr_b16 v[58:59], v4 offset:7776
    s_waitcnt lgkmcnt(14)
    v_mfma_f32_16x16x32_bf16 v[88:91], v[36:39], v[8:11], v[88:91]
    ds_read_b64_tr_b16 v[60:61], v4 offset:5248
    ds_read_b64_tr_b16 v[62:63], v4 offset:7808
    v_mfma_f32_16x16x32_bf16 v[92:95], v[36:39], v[12:15], v[92:95]
    s_waitcnt lgkmcnt(14)
    v_mfma_f32_16x16x32_bf16 v[96:99], v[40:43], v[8:11], v[96:99]
    v_mfma_f32_16x16x32_bf16 v[100:103], v[40:43], v[12:15], v[100:103]
    s_waitcnt lgkmcnt(0)
    s_cmp_eq_u32 s54, 5
    s_cbranch_scc1 m2_kernel_wd_nob
    s_barrier
m2_kernel_wd_nob:
    s_bitcmp1_b32 s54, 0
    s_cselect_b32 s55, s69, s68
    s_cselect_b32 s56, s71, s70
    v_add_u32 v2, s55, v2
    v_add_u32 v3, s56, v3
    v_add_u32 v4, s56, v4
    v_mfma_f32_16x16x32_bf16 v[64:67], v[44:47], v[16:19], v[64:67]
    ds_read_b64 v[8:9], v2 offset:0
    ds_read_b64 v[10:11], v2 offset:512
    v_mfma_f32_16x16x32_bf16 v[68:71], v[44:47], v[20:23], v[68:71]
    ds_read_b64 v[12:13], v2 offset:2048
    ds_read_b64 v[14:15], v2 offset:2560
    v_mfma_f32_16x16x32_bf16 v[72:75], v[48:51], v[16:19], v[72:75]
    ds_read_b64_tr_b16 v[24:25], v3 offset:0
    ds_read_b64_tr_b16 v[26:27], v3 offset:2560
    v_mfma_f32_16x16x32_bf16 v[76:79], v[48:51], v[20:23], v[76:79]
    ds_read_b64_tr_b16 v[28:29], v3 offset:32
    ds_read_b64_tr_b16 v[30:31], v3 offset:2592
    v_mfma_f32_16x16x32_bf16 v[80:83], v[52:55], v[16:19], v[80:83]
    ds_read_b64_tr_b16 v[32:33], v4 offset:64
    ds_read_b64_tr_b16 v[34:35], v4 offset:2624
    v_mfma_f32_16x16x32_bf16 v[84:87], v[52:55], v[20:23], v[84:87]
    ds_read_b64_tr_b16 v[36:37], v4 offset:96
    ds_read_b64_tr_b16 v[38:39], v4 offset:2656
    v_mfma_f32_16x16x32_bf16 v[88:91], v[56:59], v[16:19], v[88:91]
    ds_read_b64_tr_b16 v[40:41], v4 offset:128
    ds_read_b64_tr_b16 v[42:43], v4 offset:2688
    v_mfma_f32_16x16x32_bf16 v[92:95], v[56:59], v[20:23], v[92:95]
    v_mfma_f32_16x16x32_bf16 v[96:99], v[60:63], v[16:19], v[96:99]
    v_mfma_f32_16x16x32_bf16 v[100:103], v[60:63], v[20:23], v[100:103]
    s_add_u32 s54, s54, 1
    s_cmp_lt_u32 s54, 6
    s_cbranch_scc1 m2_kernel_wd_loop
    s_cmp_eq_u32 s53, 0
    s_cbranch_scc1 m2_kernel_wd_skipw
    ds_write_b128 v119, v[80:83] offset:0
    ds_write_b128 v119, v[84:87] offset:1024
m2_kernel_wd_skipw:
    ds_write_b128 v119, v[88:91] offset:2048
    ds_write_b128 v119, v[92:95] offset:3072
    ds_write_b128 v119, v[96:99] offset:4096
    ds_write_b128 v119, v[100:103] offset:5120
    s_waitcnt lgkmcnt(0)
    s_barrier
    ds_read_b128 v[8:11], v120 offset:0
    ds_read_b128 v[12:15], v120 offset:1024
    ds_read_b128 v[16:19], v120 offset:2048
    ds_read_b128 v[20:23], v120 offset:3072
    ds_read_b128 v[24:27], v120 offset:4096
    ds_read_b128 v[28:31], v120 offset:5120
    s_waitcnt vmcnt(0) lgkmcnt(0)
    v_pk_add_f32 v[64:65], v[64:65], v[8:9]
    v_pk_add_f32 v[66:67], v[66:67], v[10:11]
    v_lshlrev_b32 v8, 16, v104
    v_and_b32 v9, 0xffff0000, v104
    v_lshlrev_b32 v10, 16, v105
    v_and_b32 v11, 0xffff0000, v105
    v_pk_add_f32 v[64:65], v[64:65], v[8:9]
    v_pk_add_f32 v[66:67], v[66:67], v[10:11]
    v_cvt_pk_bf16_f32 v64, v64, v65
    v_cvt_pk_bf16_f32 v65, v66, v67
    s_add_u32 s34, s60, 0
    buffer_store_dwordx2 v[64:65], v116, s[44:47], s34 offen
    v_pk_add_f32 v[68:69], v[68:69], v[12:13]
    v_pk_add_f32 v[70:71], v[70:71], v[14:15]
    v_lshlrev_b32 v12, 16, v106
    v_and_b32 v13, 0xffff0000, v106
    v_lshlrev_b32 v14, 16, v107
    v_and_b32 v15, 0xffff0000, v107
    v_pk_add_f32 v[68:69], v[68:69], v[12:13]
    v_pk_add_f32 v[70:71], v[70:71], v[14:15]
    v_cvt_pk_bf16_f32 v68, v68, v69
    v_cvt_pk_bf16_f32 v69, v70, v71
    s_add_u32 s34, s60, 20480
    buffer_store_dwordx2 v[68:69], v116, s[44:47], s34 offen
    v_pk_add_f32 v[72:73], v[72:73], v[16:17]
    v_pk_add_f32 v[74:75], v[74:75], v[18:19]
    v_lshlrev_b32 v16, 16, v108
    v_and_b32 v17, 0xffff0000, v108
    v_lshlrev_b32 v18, 16, v109
    v_and_b32 v19, 0xffff0000, v109
    v_pk_add_f32 v[72:73], v[72:73], v[16:17]
    v_pk_add_f32 v[74:75], v[74:75], v[18:19]
    v_cvt_pk_bf16_f32 v72, v72, v73
    v_cvt_pk_bf16_f32 v73, v74, v75
    s_add_u32 s34, s61, 0
    buffer_store_dwordx2 v[72:73], v116, s[44:47], s34 offen
    v_pk_add_f32 v[76:77], v[76:77], v[20:21]
    v_pk_add_f32 v[78:79], v[78:79], v[22:23]
    v_lshlrev_b32 v20, 16, v110
    v_and_b32 v21, 0xffff0000, v110
    v_lshlrev_b32 v22, 16, v111
    v_and_b32 v23, 0xffff0000, v111
    v_pk_add_f32 v[76:77], v[76:77], v[20:21]
    v_pk_add_f32 v[78:79], v[78:79], v[22:23]
    v_cvt_pk_bf16_f32 v76, v76, v77
    v_cvt_pk_bf16_f32 v77, v78, v79
    s_add_u32 s34, s61, 20480
    buffer_store_dwordx2 v[76:77], v116, s[44:47], s34 offen
    s_cmp_lg_u32 s53, 0
    s_cbranch_scc1 m2_kernel_wd_skip2
    v_pk_add_f32 v[80:81], v[80:81], v[24:25]
    v_pk_add_f32 v[82:83], v[82:83], v[26:27]
    v_lshlrev_b32 v24, 16, v112
    v_and_b32 v25, 0xffff0000, v112
    v_lshlrev_b32 v26, 16, v113
    v_and_b32 v27, 0xffff0000, v113
    v_pk_add_f32 v[80:81], v[80:81], v[24:25]
    v_pk_add_f32 v[82:83], v[82:83], v[26:27]
    v_cvt_pk_bf16_f32 v80, v80, v81
    v_cvt_pk_bf16_f32 v81, v82, v83
    s_add_u32 s34, s62, 0
    buffer_store_dwordx2 v[80:81], v116, s[44:47], s34 offen
    v_pk_add_f32 v[84:85], v[84:85], v[28:29]
    v_pk_add_f32 v[86:87], v[86:87], v[30:31]
    v_lshlrev_b32 v28, 16, v114
    v_and_b32 v29, 0xffff0000, v114
    v_lshlrev_b32 v30, 16, v115
    v_and_b32 v31, 0xffff0000, v115
    v_pk_add_f32 v[84:85], v[84:85], v[28:29]
    v_pk_add_f32 v[86:87], v[86:87], v[30:31]
    v_cvt_pk_bf16_f32 v84, v84, v85
    v_cvt_pk_bf16_f32 v85, v86, v87
    s_add_u32 s34, s62, 20480
    buffer_store_dwordx2 v[84:85], v116, s[44:47], s34 offen
m2_kernel_wd_skip2:
    s_waitcnt vmcnt(0)
    s_barrier
m2_kernel_end:
    s_endpgm

.section .rodata,"a"
.p2align 6
.amdhsa_kernel m2_kernel
  .amdhsa_next_free_vgpr 208
  .amdhsa_next_free_sgpr 102
  .amdhsa_accum_offset 208
  .amdhsa_group_segment_fixed_size 0
  .amdhsa_kernarg_size 80
  .amdhsa_user_sgpr_count 2
  .amdhsa_user_sgpr_kernarg_segment_ptr 1
  .amdhsa_system_sgpr_workgroup_id_x 1
.end_amdhsa_kernel

.text
text_end:
    s_endpgm
```
